```python
import torch

def _softmax(x, axis=-1):
    return torch.softmax(x, dim=axis)
def _gelu(x):
    return torch.nn.functional.gelu(x, approximate="tanh")
def _silu(x):
    return torch.nn.functional.silu(x)
def _sigmoid(x):
    return torch.sigmoid(x)
def _layernorm(x, axis=-1, eps=1e-5):
    m = x.mean(dim=axis, keepdim=True)
    v = x.var(dim=axis, keepdim=True, unbiased=False)
    return (x - m) / torch.sqrt(v + eps)
def _scatter_add(tgt, idx, src, axis=0):
    return tgt.clone().index_add_(axis, idx, src)
def _segment_sum(src, seg, n):
    out = torch.zeros((n,) + src.shape[1:], dtype=src.dtype)
    return out.index_add_(0, seg, src)
def _pad(x, pw):
    flat = tuple(v for pair in reversed(pw) for v in pair)
    return torch.nn.functional.pad(x, flat)

kernel_name = 'gated_mix__mha_block__spectral_fnet__prompt'

def setup_inputs():

    _w = (lambda a: (lambda t: t.to(torch.bfloat16) if t.is_floating_point() else t)(torch.as_tensor(a)))
    def _A_setup():
        B, S, D, H = 1, 2048, 1024, 32
        return {
            "x": _w((lambda *s: torch.randn(*s, dtype=torch.bfloat16) * 0.05)(B, S, D)),
            "wqkv": _w((lambda *s: torch.randn(*s, dtype=torch.bfloat16) * 1.6)(D, 3 * D)),
            "wo": _w((lambda *s: torch.randn(*s, dtype=torch.bfloat16) * 0.2)(D, D)),
        }
    _A_in = _A_setup()

    def _B_setup():
        B, S, D = 1, 2048, 1024
        ns = torch.arange(S)[:, None] * torch.arange(S)[None, :]
        nd = torch.arange(D)[:, None] * torch.arange(D)[None, :]
        Ws_re = torch.cos(-2.0 * torch.pi * ns / S).to(float)
        Ws_im = torch.sin(-2.0 * torch.pi * ns / S).to(float)
        Wd_re = torch.cos(-2.0 * torch.pi * nd / D).to(float)
        Wd_im = torch.sin(-2.0 * torch.pi * nd / D).to(float)
        return {
            "x": _w((lambda *s: torch.randn(*s, dtype=torch.bfloat16) * 0.05)(B, S, D)),
            "dft_seq_re": _w(Ws_re),
            "dft_seq_im": _w(Ws_im),
            "dft_hid_re": _w(Wd_re),
            "dft_hid_im": _w(Wd_im),
        }
    _B_in = _B_setup()

    return {
        "A_x": _A_in["x"],
        "A_wqkv": _A_in["wqkv"],
        "A_wo": _A_in["wo"],
        "B_x": _B_in["x"],
        "B_dft_seq_re": _B_in["dft_seq_re"],
        "B_dft_seq_im": _B_in["dft_seq_im"],
        "B_dft_hid_re": _B_in["dft_hid_re"],
        "B_dft_hid_im": _B_in["dft_hid_im"],
        "gate_w": _w((lambda *s: torch.randn(*s, dtype=torch.bfloat16) * 0.05)(1024) * 16.0),
    }

def reference(A_x, A_wqkv, A_wo, B_x, B_dft_seq_re, B_dft_seq_im, B_dft_hid_re, B_dft_hid_im, gate_w):
    def _A_ref(x, wqkv, wo):
        B, S, D = x.shape
        H = 32
        Dh = D // H
        qkv = (lambda x, *d: x.permute(*d))((x @ wqkv).reshape(B, S, 3, H, Dh), 2, 0, 3, 1, 4)
        q, k, v = qkv[0], qkv[1], qkv[2]
        scores = torch.einsum("bhqd,bhkd->bhqk", q, k) * (Dh ** -0.5)
        p = _softmax(scores, axis=-1)
        o = torch.einsum("bhqk,bhkd->bhqd", p, v)
        return (lambda x, *d: x.permute(*d))(o, 0, 2, 1, 3).reshape(B, S, D) @ wo

    def _B_ref(x, dft_seq_re, dft_seq_im, dft_hid_re, dft_hid_im):
        a = torch.einsum("bsd,ed->bse", x, dft_hid_re)
        b = torch.einsum("bsd,ed->bse", x, dft_hid_im)
        y = torch.einsum("ts,bse->bte", dft_seq_re, a) - torch.einsum("ts,bse->bte", dft_seq_im, b)
        return y

    x = A_x
    g = _sigmoid((x * gate_w).sum(-1, keepdims=True))
    a = _A_ref(x, A_wqkv, A_wo)
    b = _B_ref(x, B_dft_seq_re, B_dft_seq_im, B_dft_hid_re, B_dft_hid_im)
    return g * a + (1 - g) * b
```

```asm
; @launch grid=(256,1,1) block=(256,1,1) lds=163840
.amdgcn_target "amdgcn-amd-amdhsa--gfx950"
.text
.globl gated_mix__mha_block__spectral_fnet__prompt_kernel
.p2align 8
.type gated_mix__mha_block__spectral_fnet__prompt_kernel,@function
gated_mix__mha_block__spectral_fnet__prompt_kernel:
    s_load_dwordx2 s[4:5], s[0:1], 0
    s_load_dwordx2 s[8:9], s[0:1], 8
    s_load_dwordx2 s[12:13], s[0:1], 88
    s_load_dwordx2 s[28:29], s[0:1], 80
    s_load_dwordx2 s[20:21], s[0:1], 64
    s_load_dwordx2 s[16:17], s[0:1], 16
    s_load_dwordx2 s[24:25], s[0:1], 72
    s_cmp_ge_u32 s2, 256
    s_cbranch_scc1 L_exit
    s_getpc_b64 s[36:37]
    s_mov_b32 s38, L_exit-gated_mix__mha_block__spectral_fnet__prompt_kernel
    s_mov_b32 s39, 0x00020000
    v_lshrrev_b32 v1, 6, v0
    v_and_b32 v0, 63, v0
    s_lshr_b32 s44, s2, 3
    v_lshlrev_b32 v42, 14, v0
    v_lshl_add_u32 v42, v1, 7, v42
    s_lshl_b32 s56, s44, 9
    buffer_load_dword v3, v42, s[36:39], s56 offen
    v_readfirstlane_b32 s40, v1
    s_mov_b32 s6, 4194304
    s_mov_b32 s7, 0x00020000
    s_mov_b32 s10, 6291456
    s_mov_b32 s11, 0x00020000
    s_and_b32 s43, s2, 7
    s_lshr_b32 s50, s43, 1
    s_mul_i32 s51, s50, 4
    s_and_b32 s55, s43, 1
    s_lshl_b32 s45, s55, 3
    s_and_b32 s55, s44, 7
    s_add_u32 s41, s45, s55
    s_mul_i32 s57, s55, 4
    s_add_u32 s51, s51, s57
    s_lshl_b32 s42, s50, 2
    s_lshr_b32 s49, s44, 3
    s_add_u32 s42, s42, s49
    s_and_b32 s51, s51, 15
    s_and_b32 s48, s40, 1
    s_lshr_b32 s47, s40, 1
    s_mul_i32 s52, s40, 10240
    v_lshlrev_b32 v4, 4, v0
    v_lshrrev_b32 v1, 3, v0
    v_and_b32 v2, 7, v0
    v_lshrrev_b32 v5, 4, v0
    s_lshl_b32 s55, s47, 4
    s_add_u32 s55, s55, s41
    s_lshl_b32 s57, s48, 10
    s_add_u32 s55, s55, s57
    s_lshl_b32 s55, s55, 11
    v_xor_b32 v6, v2, v5
    v_lshlrev_b32 v6, 4, v6
    v_lshl_add_u32 v6, v1, 16, v6
    v_add_u32 v6, s55, v6
    v_xor_b32 v7, 64, v6
    v_add_u32 v8, 0, v6
    v_add_u32 v9, 523264, v7
    v_add_u32 v10, 1046528, v6
    v_add_u32 v11, 1569792, v7
    s_mul_i32 s55, s40, 98304
    s_lshl_b32 s57, s42, 7
    s_add_u32 s55, s55, s57
    v_and_b32 v6, 1, v5
    v_lshlrev_b32 v6, 1, v6
    v_xor_b32 v6, v2, v6
    v_lshlrev_b32 v6, 4, v6
    v_mul_u32_u24 v7, 6144, v1
    v_add3_u32 v6, v6, v7, s55
    v_xor_b32 v7, 64, v6
    v_add_u32 v12, 0, v6
    v_add_u32 v13, 48128, v7
    v_add_u32 v14, 0, v6
    v_add_u32 v15, 48128, v7
    v_add_u32 v16, 4096, v6
    v_add_u32 v17, 52224, v7
    s_waitcnt lgkmcnt(0)
    s_lshl_b32 s53, s51, 7
    s_mul_i32 s54, s51, 393216
    s_add_u32 m0, s52, 40960
    s_add_u32 s51, s51, 1
    buffer_load_dwordx4 v8, s[4:7], s53 offen offset:0 lds
    buffer_load_dwordx4 v9, s[4:7], s53 offen offset:1024 lds
    buffer_load_dwordx4 v10, s[4:7], s53 offen offset:2048 lds
    buffer_load_dwordx4 v11, s[4:7], s53 offen offset:3072 lds
    s_mov_b32 s14, 33554432
    s_mov_b32 s15, 0x00020000
    s_mov_b32 s30, 208
    s_mov_b32 s31, 0x00020000
    s_mov_b32 s22, 2048
    s_mov_b32 s23, 0x00020000
    s_mov_b32 s18, 2097152
    s_mov_b32 s19, 0x00020000
    s_mov_b32 s26, 4194304
    s_mov_b32 s27, 0x00020000
    v_mov_b32 v36, 0
    v_mov_b32 v37, 0
    v_mov_b32 v38, 0
    v_mov_b32 v39, 0
    v_mov_b32 v30, 1
    v_lshlrev_b32 v31, 20, v0
    s_add_u32 s32, s12, 25165824
    s_addc_u32 s33, s13, 0
    s_mov_b32 s34, 282624
    s_mov_b32 s35, 0x00020000
    s_lshl_b32 s58, s2, 2
    s_add_u32 s58, s58, s40
    s_lshl_b32 s57, s58, 10
    s_lshl_b32 s55, s58, 13
    s_add_u32 s55, s55, 4294823936
    s_cmp_lt_u32 s58, 20
    s_cselect_b32 s57, s57, s55
    s_cselect_b32 s55, 4, 7
    s_cselect_b32 s56, 7, 10
    v_lshlrev_b32 v43, s55, v2
    v_lshlrev_b32 v44, s56, v1
    v_add_u32 v43, v43, v44
    s_lshl_b32 s58, s58, 2
    v_lshlrev_b32 v45, 1, v0
    s_bfm_b64 exec, 3, 0
    v_mov_b32 v40, s8
    v_mov_b32 v41, s9
    v_subrev_u32 v42, -1, v45
    s_bfm_b64 exec, 13, 3
    v_mov_b32 v40, s12
    v_mov_b32 v41, s13
    v_subrev_u32 v42, 5, v45
    s_bfm_b64 exec, 2, 16
    v_mov_b32 v40, s24
    v_mov_b32 v41, s25
    v_subrev_u32 v42, 31, v45
    s_bfm_b64 exec, 1, 18
    v_mov_b32 v40, s16
    v_mov_b32 v41, s17
    v_subrev_u32 v42, 35, v45
    s_bfm_b64 exec, 1, 19
    v_mov_b32 v40, s20
    v_mov_b32 v41, s21
    v_subrev_u32 v42, 38, v45
    s_bfm_b64 exec, 1, 20
    v_mov_b32 v40, s28
    v_mov_b32 v41, s29
    v_subrev_u32 v42, 40, v45
    s_bfm_b64 exec, 21, 0
    v_lshlrev_b32 v42, 20, v42
    v_add_co_u32 v40, vcc, v40, v42
    s_nop 1
    v_addc_co_u32 v41, vcc, 0, v41, vcc
    s_mov_b64 exec, -1
    s_mul_i32 s55, s48, 20480
    v_and_b32 v6, 15, v0
    v_bfe_u32 v7, v0, 1, 3
    v_xor_b32 v7, v5, v7
    v_lshlrev_b32 v7, 4, v7
    v_lshl_add_u32 v7, v6, 7, v7
    v_add_u32 v18, s55, v7
    v_xor_b32 v19, 64, v18
    s_and_b32 s55, s40, 2
    v_bfe_u32 v6, v0, 3, 2
    v_xor_b32 v6, s55, v6
    v_lshlrev_b32 v6, 5, v6
    v_and_b32 v7, 3, v0
    v_lshl_add_u32 v6, v7, 3, v6
    v_bfe_u32 v7, v0, 2, 2
    v_lshl_add_u32 v6, v7, 7, v6
    v_bfe_u32 v7, v0, 4, 1
    v_lshl_add_u32 v6, v7, 10, v6
    v_lshrrev_b32 v7, 5, v0
    v_mul_u32_u24 v7, 10240, v7
    v_add_u32 v6, v6, v7
    v_add_u32 v20, 4096, v6
    v_xor_b32 v21, 32, v20
    s_and_b32 s55, s50, 1
    s_mul_i32 s55, s55, 20480
    s_lshr_b32 s56, s50, 1
    s_lshl_b32 s56, s56, 7
    s_add_u32 s55, s55, s56
    s_lshl_b32 s56, s40, 1
    v_bfe_u32 v6, v0, 1, 1
    v_add_u32 v6, s56, v6
    v_bfe_u32 v7, v0, 2, 3
    v_xor_b32 v6, v6, v7
    v_lshlrev_b32 v6, 1, v6
    v_and_or_b32 v6, v0, 1, v6
    v_lshl_add_u32 v6, v6, 3, s55
    v_lshrrev_b32 v7, 2, v0
    v_lshl_add_u32 v32, v7, 8, v6
    v_add_u32 v254, 81920, v32
    v_add_u32 v22, 40960, v18
    v_add_u32 v23, 40960, v19
    v_add_u32 v24, 40960, v20
    v_add_u32 v25, 40960, v21
    v_add_u32 v26, 81920, v18
    v_add_u32 v27, 81920, v19
    v_add_u32 v28, 81920, v20
    v_add_u32 v29, 81920, v21
    s_add_u32 m0, s52, 45056
    s_and_b32 s51, s51, 15
    buffer_load_dwordx4 v12, s[8:11], s54 offen offset:0 lds
    buffer_load_dwordx4 v13, s[8:11], s54 offen offset:1024 lds
    buffer_load_dwordx4 v14, s[8:11], s54 offen offset:2048 lds
    buffer_load_dwordx4 v15, s[8:11], s54 offen offset:3072 lds
    s_add_u32 m0, s52, 49152
    s_nop 0
    buffer_load_dwordx4 v16, s[8:11], s54 offen offset:0 lds
    buffer_load_dwordx4 v17, s[8:11], s54 offen offset:1024 lds
    buffer_store_dwordx4 v[36:39], v43, s[32:35], s57 offen sc1
    s_bfm_b64 exec, 21, 0
    global_load_dword v3, v[40:41], off
    s_mov_b64 exec, -1
    s_mov_b64 exec, 0
    s_cmp_eq_u32 s40, 0
    s_cbranch_scc1 L_pg0
    s_cmp_eq_u32 s40, 1
    s_cbranch_scc1 L_pg1
    s_cmp_eq_u32 s40, 2
    s_cbranch_scc1 L_pg2
    s_branch L_pg3
.p2align 12
.fill 4, 4, 0xbf810000
L_main:
    s_mov_b64 exec, -1
    s_lshl_b32 s53, s51, 7
    s_mul_i32 s54, s51, 393216
    s_add_u32 m0, s52, 81920
    s_add_u32 s51, s51, 1
    buffer_load_dwordx4 v8, s[4:7], s53 offen offset:0 lds
    buffer_load_dwordx4 v9, s[4:7], s53 offen offset:1024 lds
    buffer_load_dwordx4 v10, s[4:7], s53 offen offset:2048 lds
    buffer_load_dwordx4 v11, s[4:7], s53 offen offset:3072 lds
    s_add_u32 m0, s52, 86016
    s_and_b32 s51, s51, 15
    buffer_load_dwordx4 v12, s[8:11], s54 offen offset:0 lds
    buffer_load_dwordx4 v13, s[8:11], s54 offen offset:1024 lds
    buffer_load_dwordx4 v14, s[8:11], s54 offen offset:2048 lds
    buffer_load_dwordx4 v15, s[8:11], s54 offen offset:3072 lds
    s_add_u32 m0, s52, 90112
    s_nop 0
    buffer_load_dwordx4 v16, s[8:11], s54 offen offset:0 lds
    buffer_load_dwordx4 v17, s[8:11], s54 offen offset:1024 lds
    s_waitcnt vmcnt(12)
    s_barrier
    ds_read_b128 v[36:39], v22 offset:0
    ds_read_b128 v[40:43], v22 offset:2048
    ds_read_b128 v[44:47], v22 offset:10240
    ds_read_b128 v[48:51], v22 offset:12288
    ds_read_b64_tr_b16 v[52:53], v24 offset:0
    ds_read_b64_tr_b16 v[54:55], v24 offset:512
    ds_read_b64_tr_b16 v[56:57], v25 offset:0
    ds_read_b64_tr_b16 v[58:59], v25 offset:512
    ds_read_b64_tr_b16 v[60:61], v24 offset:2048
    ds_read_b64_tr_b16 v[62:63], v24 offset:2560
    ds_read_b64_tr_b16 v[64:65], v25 offset:2048
    ds_read_b64_tr_b16 v[66:67], v25 offset:2560
    ds_read_b64_tr_b16 v[68:69], v24 offset:4096
    ds_read_b64_tr_b16 v[70:71], v24 offset:4608
    ds_read_b64_tr_b16 v[72:73], v25 offset:4096
    ds_read_b64_tr_b16 v[74:75], v25 offset:4608
    ds_read_b64_tr_b16 a[192:193], v32 offset:40960
    s_lshl_b32 s53, s51, 7
    s_mul_i32 s54, s51, 393216
    s_add_u32 m0, s52, 0
    s_add_u32 s51, s51, 1
    buffer_load_dwordx4 v8, s[4:7], s53 offen offset:0 lds
    buffer_load_dwordx4 v9, s[4:7], s53 offen offset:1024 lds
    buffer_load_dwordx4 v10, s[4:7], s53 offen offset:2048 lds
    buffer_load_dwordx4 v11, s[4:7], s53 offen offset:3072 lds
    s_add_u32 m0, s52, 4096
    s_and_b32 s51, s51, 15
    buffer_load_dwordx4 v12, s[8:11], s54 offen offset:0 lds
    s_waitcnt lgkmcnt(0)
    v_mfma_f32_16x16x32_bf16 v[116:119], v[52:55], v[36:39], 0
    s_mov_b32 s97, 0x100000
    ds_read_b128 v[76:79], v23 offset:0
    v_and_b32 v6, 3, v0
    v_mfma_f32_16x16x32_bf16 v[120:123], v[52:55], v[40:43], 0
    s_lshl_b32 s50, s50, 4
    ds_read_b128 v[80:83], v23 offset:2048
    v_bfe_u32 v7, v0, 3, 2
    v_mfma_f32_16x16x32_bf16 v[124:127], v[52:55], v[44:47], 0
    s_add_u32 s50, s50, s41
    ds_read_b128 v[84:87], v23 offset:10240
    v_lshl_add_u32 v6, v7, 2, v6
    v_mfma_f32_16x16x32_bf16 v[128:131], v[52:55], v[48:51], 0
    s_lshl_b32 s49, s49, 2
    ds_read_b128 v[88:91], v23 offset:12288
    v_bfe_u32 v7, v0, 2, 1
    v_mfma_f32_16x16x32_bf16 v[132:135], v[56:59], v[36:39], 0
    buffer_load_dwordx4 v13, s[8:11], s54 offen offset:1024 lds
    v_mfma_f32_16x16x32_bf16 v[136:139], v[56:59], v[40:43], 0
    s_add_u32 s49, s49, s40
    ds_read_b64_tr_b16 v[92:93], v24 offset:20480
    ds_read_b64_tr_b16 v[94:95], v24 offset:20992
    v_mfma_f32_16x16x32_bf16 v[140:143], v[56:59], v[44:47], 0
    s_and_b32 s55, s43, 6
    ds_read_b64_tr_b16 v[96:97], v25 offset:20480
    ds_read_b64_tr_b16 v[98:99], v25 offset:20992
    v_mfma_f32_16x16x32_bf16 v[144:147], v[56:59], v[48:51], 0
    s_add_u32 s45, s45, s55
    ds_read_b64_tr_b16 v[100:101], v24 offset:22528
    v_lshl_add_u32 v252, v7, 4, v6
    v_mfma_f32_16x16x32_bf16 v[148:151], v[60:63], v[36:39], 0
    buffer_load_dwordx4 v14, s[8:11], s54 offen offset:2048 lds
    v_mfma_f32_16x16x32_bf16 v[152:155], v[60:63], v[40:43], 0
    s_and_b32 s55, s44, 1
    ds_read_b64_tr_b16 v[102:103], v24 offset:23040
    ds_read_b64_tr_b16 v[104:105], v25 offset:22528
    v_mfma_f32_16x16x32_bf16 v[156:159], v[60:63], v[44:47], 0
    s_add_u32 s45, s45, s55
    ds_read_b64_tr_b16 v[106:107], v25 offset:23040
    v_cvt_f32_u32 v6, v252
    v_mfma_f32_16x16x32_bf16 v[160:163], v[60:63], v[48:51], 0
    s_lshr_b32 s46, s44, 1
    ds_read_b64_tr_b16 v[108:109], v24 offset:24576
    v_mul_f32 v6, 0x3a800000, v6
    v_mfma_f32_16x16x32_bf16 v[164:167], v[64:67], v[36:39], 0
    buffer_load_dwordx4 v15, s[8:11], s54 offen offset:3072 lds
    v_mfma_f32_16x16x32_bf16 v[168:171], v[64:67], v[40:43], 0
    s_and_b32 s55, s45, 1
    ds_read_b64_tr_b16 v[110:111], v24 offset:25088
    v_lshrrev_b32 v7, 5, v0
    v_mfma_f32_16x16x32_bf16 v[172:175], v[64:67], v[44:47], 0
    s_lshl_b32 s72, s55, 1
    ds_read_b64_tr_b16 v[112:113], v25 offset:24576
    v_lshlrev_b32 v7, 2, v7
    v_mfma_f32_16x16x32_bf16 v[176:179], v[64:67], v[48:51], 0
    s_add_u32 m0, s52, 8192
    ds_read_b64_tr_b16 v[114:115], v25 offset:25088
    v_cvt_f32_u32 v7, v7
    v_mfma_f32_16x16x32_bf16 v[180:183], v[36:39], v[68:71], 0
    buffer_load_dwordx4 v16, s[8:11], s54 offen offset:0 lds
    v_mfma_f32_16x16x32_bf16 v[184:187], v[40:43], v[68:71], 0
    s_xor_b32 s72, s72, s46
    ds_read_b64_tr_b16 a[194:195], v32 offset:51200
    v_mul_f32 v7, v6, v7
    v_mfma_f32_16x16x32_bf16 v[188:191], v[44:47], v[68:71], 0
    s_lshl_b32 s72, s72, 13
    v_fmamk_f32 v228, v6, 0x00000000, v7
    v_fmamk_f32 v229, v6, 0x3f800000, v7
    v_mfma_f32_16x16x32_bf16 v[192:195], v[48:51], v[68:71], 0
    s_lshl_b32 s73, s40, 12
    v_cos_f32 v212, v228
    v_mfma_f32_16x16x32_bf16 v[196:199], v[36:39], v[72:75], 0
    buffer_load_dwordx4 v17, s[8:11], s54 offen offset:1024 lds
    v_mfma_f32_16x16x32_bf16 v[200:203], v[40:43], v[72:75], 0
    s_lshl_b32 s75, s47, 4
    v_cos_f32 v213, v229
    v_mfma_f32_16x16x32_bf16 v[204:207], v[44:47], v[72:75], 0
    s_add_u32 s75, s75, s45
    v_fmamk_f32 v230, v6, 0x40000000, v7
    v_fmamk_f32 v231, v6, 0x40400000, v7
    v_mfma_f32_16x16x32_bf16 v[208:211], v[48:51], v[72:75], 0
    s_waitcnt vmcnt(10) lgkmcnt(0)
    s_barrier
    v_mfma_f32_16x16x32_bf16 v[116:119], v[92:95], v[76:79], v[116:119]
    s_lshl_b32 s53, s51, 7
    ds_read_b128 v[36:39], v26 offset:0
    v_fmamk_f32 v232, v6, 0x41000000, v7
    v_mfma_f32_16x16x32_bf16 v[120:123], v[92:95], v[80:83], v[120:123]
    s_mul_i32 s54, s51, 393216
    ds_read_b128 v[40:43], v26 offset:2048
    v_fmamk_f32 v233, v6, 0x41100000, v7
    v_mfma_f32_16x16x32_bf16 v[124:127], v[92:95], v[84:87], v[124:127]
    s_add_u32 m0, s52, 40960
    ds_read_b128 v[44:47], v26 offset:10240
    v_fmamk_f32 v234, v6, 0x41200000, v7
    v_mfma_f32_16x16x32_bf16 v[128:131], v[92:95], v[88:91], v[128:131]
    s_add_u32 s51, s51, 1
    ds_read_b128 v[48:51], v26 offset:12288
    v_fmamk_f32 v235, v6, 0x41300000, v7
    v_mfma_f32_16x16x32_bf16 v[132:135], v[96:99], v[76:79], v[132:135]
    buffer_load_dwordx4 v8, s[4:7], s53 offen offset:0 lds
    v_mfma_f32_16x16x32_bf16 v[136:139], v[96:99], v[80:83], v[136:139]
    s_lshl_b32 s89, s47, 14
    ds_read_b64_tr_b16 v[52:53], v28 offset:0
    ds_read_b64_tr_b16 v[54:55], v28 offset:512
    v_mfma_f32_16x16x32_bf16 v[140:143], v[96:99], v[84:87], v[140:143]
    s_add_u32 s89, s89, 131072
    ds_read_b64_tr_b16 v[56:57], v29 offset:0
    ds_read_b64_tr_b16 v[58:59], v29 offset:512
    v_mfma_f32_16x16x32_bf16 v[144:147], v[96:99], v[88:91], v[144:147]
    s_add_u32 s90, s89, 8192
    ds_read_b64_tr_b16 v[60:61], v28 offset:2048
    v_fmamk_f32 v236, v6, 0x41800000, v7
    v_mfma_f32_16x16x32_bf16 v[148:151], v[100:103], v[76:79], v[148:151]
    buffer_load_dwordx4 v9, s[4:7], s53 offen offset:1024 lds
    v_mfma_f32_16x16x32_bf16 v[152:155], v[100:103], v[80:83], v[152:155]
    s_cmp_eq_u32 s45, 0
    s_cselect_b32 s93, 0.5, 1.0
    ds_read_b64_tr_b16 v[62:63], v28 offset:2560
    ds_read_b64_tr_b16 v[64:65], v29 offset:2048
    v_mfma_f32_16x16x32_bf16 v[156:159], v[100:103], v[84:87], v[156:159]
    s_cmp_eq_u32 s75, 16
    s_cselect_b32 s89, 155648, s89
    s_cselect_b32 s90, 131072, s90
    s_cselect_b32 s91, 1, 2
    s_cselect_b32 s94, -0.5, 0.5
    ds_read_b64_tr_b16 v[66:67], v29 offset:2560
    v_fmamk_f32 v237, v6, 0x41880000, v7
    v_mfma_f32_16x16x32_bf16 v[160:163], v[100:103], v[88:91], v[160:163]
    s_lshl_b32 s91, s91, 13
    ds_read_b64_tr_b16 v[68:69], v28 offset:4096
    v_fmamk_f32 v238, v6, 0x41900000, v7
    v_mfma_f32_16x16x32_bf16 v[164:167], v[104:107], v[76:79], v[164:167]
    buffer_load_dwordx4 v10, s[4:7], s53 offen offset:2048 lds
    v_mfma_f32_16x16x32_bf16 v[168:171], v[104:107], v[80:83], v[168:171]
    s_add_u32 s91, s91, 131072
    ds_read_b64_tr_b16 v[70:71], v28 offset:4608
    v_fmamk_f32 v239, v6, 0x41980000, v7
    v_mfma_f32_16x16x32_bf16 v[172:175], v[104:107], v[84:87], v[172:175]
    s_add_u32 s92, s91, 8192
    ds_read_b64_tr_b16 v[72:73], v29 offset:4096
    v_fmamk_f32 v240, v6, 0x41c00000, v7
    v_mfma_f32_16x16x32_bf16 v[176:179], v[104:107], v[88:91], v[176:179]
    s_lshl_b32 s55, s42, 1
    ds_read_b64_tr_b16 v[74:75], v29 offset:4608
    v_fmamk_f32 v241, v6, 0x41c80000, v7
    v_mfma_f32_16x16x32_bf16 v[180:183], v[76:79], v[108:111], v[180:183]
    buffer_load_dwordx4 v11, s[4:7], s53 offen offset:3072 lds
    v_mfma_f32_16x16x32_bf16 v[184:187], v[80:83], v[108:111], v[184:187]
    s_add_u32 s47, s47, s55
    ds_read_b64_tr_b16 a[196:197], v254 offset:0
    v_fmamk_f32 v242, v6, 0x41d00000, v7
    v_mfma_f32_16x16x32_bf16 v[188:191], v[84:87], v[108:111], v[188:191]
    s_add_u32 m0, s52, 45056
    v_cos_f32 v214, v230
    v_mfma_f32_16x16x32_bf16 v[192:195], v[88:91], v[108:111], v[192:195]
    s_and_b32 s51, s51, 15
    v_cos_f32 v215, v231
    v_mfma_f32_16x16x32_bf16 v[196:199], v[76:79], v[112:115], v[196:199]
    buffer_load_dwordx4 v12, s[8:11], s54 offen offset:0 lds
    v_mfma_f32_16x16x32_bf16 v[200:203], v[80:83], v[112:115], v[200:203]
    s_lshl_b32 s60, s49, 7
    v_cos_f32 v216, v232
    v_mfma_f32_16x16x32_bf16 v[204:207], v[84:87], v[112:115], v[204:207]
    s_add_u32 s60, s60, s50
    v_cos_f32 v217, v233
    v_mfma_f32_16x16x32_bf16 v[208:211], v[88:91], v[112:115], v[208:211]
    s_waitcnt lgkmcnt(0)
    v_mfma_f32_16x16x32_bf16 v[116:119], v[52:55], v[36:39], v[116:119]
    s_lshl_b32 s60, s60, 11
    ds_read_b128 v[76:79], v27 offset:0
    v_fmamk_f32 v243, v6, 0x41d80000, v7
    v_mfma_f32_16x16x32_bf16 v[120:123], v[52:55], v[40:43], v[120:123]
    s_add_u32 s59, s60, 131072
    ds_read_b128 v[80:83], v27 offset:2048
    v_bfe_i32 v6, v0, 0, 1
    v_mfma_f32_16x16x32_bf16 v[124:127], v[52:55], v[44:47], v[124:127]
    s_lshl_b32 s61, s47, 18
    ds_read_b128 v[84:87], v27 offset:10240
    v_and_b32 v6, 0x80008000, v6
    v_mfma_f32_16x16x32_bf16 v[128:131], v[52:55], v[48:51], v[128:131]
    s_lshl_b32 s55, s48, 17
    ds_read_b128 v[88:91], v27 offset:12288
    v_mul_f32 v244, 0x42000000, v228
    v_mfma_f32_16x16x32_bf16 v[132:135], v[56:59], v[36:39], v[132:135]
    buffer_load_dwordx4 v13, s[8:11], s54 offen offset:1024 lds
    v_mfma_f32_16x16x32_bf16 v[136:139], v[56:59], v[40:43], v[136:139]
    s_add_u32 s61, s61, s55
    ds_read_b64_tr_b16 v[92:93], v28 offset:20480
    ds_read_b64_tr_b16 v[94:95], v28 offset:20992
    v_mfma_f32_16x16x32_bf16 v[140:143], v[56:59], v[44:47], v[140:143]
    s_lshl_b32 s82, s75, 18
    ds_read_b64_tr_b16 v[96:97], v29 offset:20480
    ds_read_b64_tr_b16 v[98:99], v29 offset:20992
    v_mfma_f32_16x16x32_bf16 v[144:147], v[56:59], v[48:51], v[144:147]
    s_add_u32 s82, s82, s55
    ds_read_b64_tr_b16 v[100:101], v28 offset:22528
    v_mul_f32 v245, 0x42000000, v229
    v_mfma_f32_16x16x32_bf16 v[148:151], v[60:63], v[36:39], v[148:151]
    buffer_load_dwordx4 v14, s[8:11], s54 offen offset:2048 lds
    v_mfma_f32_16x16x32_bf16 v[152:155], v[60:63], v[40:43], v[152:155]
    s_add_u32 s82, s82, 16777216
    ds_read_b64_tr_b16 v[102:103], v28 offset:23040
    ds_read_b64_tr_b16 v[104:105], v29 offset:22528
    v_mfma_f32_16x16x32_bf16 v[156:159], v[60:63], v[44:47], v[156:159]
    s_add_u32 s83, s82, 65536
    ds_read_b64_tr_b16 v[106:107], v29 offset:23040
    v_mul_f32 v246, 0x42000000, v230
    v_mfma_f32_16x16x32_bf16 v[160:163], v[60:63], v[48:51], v[160:163]
    s_lshl_b32 s84, s40, 13
    ds_read_b64_tr_b16 v[108:109], v28 offset:24576
    v_mul_f32 v247, 0x42000000, v231
    v_mfma_f32_16x16x32_bf16 v[164:167], v[64:67], v[36:39], v[164:167]
    buffer_load_dwordx4 v15, s[8:11], s54 offen offset:3072 lds
    v_mfma_f32_16x16x32_bf16 v[168:171], v[64:67], v[40:43], v[168:171]
    s_add_u32 s84, s84, 131072
    ds_read_b64_tr_b16 v[110:111], v28 offset:25088
    v_and_b32 v7, 1, v0
    v_mfma_f32_16x16x32_bf16 v[172:175], v[64:67], v[44:47], v[172:175]
    s_and_b32 s1, s41, 3
    ds_read_b64_tr_b16 v[112:113], v29 offset:24576
    v_cvt_f32_u32 v7, v7
    v_mfma_f32_16x16x32_bf16 v[176:179], v[64:67], v[48:51], v[176:179]
    s_add_u32 m0, s52, 49152
    ds_read_b64_tr_b16 v[114:115], v29 offset:25088
    v_mul_f32 v7, 0x3e800000, v7
    v_mfma_f32_16x16x32_bf16 v[180:183], v[36:39], v[68:71], v[180:183]
    buffer_load_dwordx4 v16, s[8:11], s54 offen offset:0 lds
    v_mfma_f32_16x16x32_bf16 v[184:187], v[40:43], v[68:71], v[184:187]
    s_and_b32 s55, s41, 4
    ds_read_b64_tr_b16 a[198:199], v254 offset:10240
    v_lshlrev_b32 v33, 2, v5
    v_mfma_f32_16x16x32_bf16 v[188:191], v[44:47], v[68:71], v[188:191]
    s_lshl_b32 s55, s55, 1
    v_sin_f32 v228, v228
    v_mfma_f32_16x16x32_bf16 v[192:195], v[48:51], v[68:71], v[192:195]
    s_add_u32 s37, s1, s55
    v_sin_f32 v229, v229
    v_mfma_f32_16x16x32_bf16 v[196:199], v[36:39], v[72:75], v[196:199]
    buffer_load_dwordx4 v17, s[8:11], s54 offen offset:1024 lds
    v_mfma_f32_16x16x32_bf16 v[200:203], v[40:43], v[72:75], v[200:203]
    s_lshr_b32 s55, s41, 3
    v_sin_f32 v230, v230
    v_mfma_f32_16x16x32_bf16 v[204:207], v[44:47], v[72:75], v[204:207]
    s_lshl_b32 s55, s55, 2
    v_sin_f32 v231, v231
    v_mfma_f32_16x16x32_bf16 v[208:211], v[48:51], v[72:75], v[208:211]
    s_waitcnt vmcnt(10) lgkmcnt(0)
    s_barrier
    v_mfma_f32_16x16x32_bf16 v[116:119], v[92:95], v[76:79], v[116:119]
    s_lshl_b32 s53, s51, 7
    ds_read_b128 v[36:39], v18 offset:0
    v_cvt_f32_u32 v33, v33
    v_mfma_f32_16x16x32_bf16 v[120:123], v[92:95], v[80:83], v[120:123]
    s_mul_i32 s54, s51, 393216
    ds_read_b128 v[40:43], v18 offset:2048
    v_and_b32 v34, 15, v0
    v_mfma_f32_16x16x32_bf16 v[124:127], v[92:95], v[84:87], v[124:127]
    s_add_u32 m0, s52, 81920
    ds_read_b128 v[44:47], v18 offset:10240
    v_lshlrev_b32 v34, 5, v34
    v_mfma_f32_16x16x32_bf16 v[128:131], v[92:95], v[88:91], v[128:131]
    s_add_u32 s51, s51, 1
    ds_read_b128 v[48:51], v18 offset:12288
    v_accvgpr_write_b32 a149, 0
    v_mfma_f32_16x16x32_bf16 v[132:135], v[96:99], v[76:79], v[132:135]
    buffer_load_dwordx4 v8, s[4:7], s53 offen offset:0 lds
    v_mfma_f32_16x16x32_bf16 v[136:139], v[96:99], v[80:83], v[136:139]
    s_add_u32 s1, s37, s55
    ds_read_b64_tr_b16 v[52:53], v20 offset:0
    ds_read_b64_tr_b16 v[54:55], v20 offset:512
    v_mfma_f32_16x16x32_bf16 v[140:143], v[96:99], v[84:87], v[140:143]
    s_lshl_b32 s55, s55, 13
    ds_read_b64_tr_b16 v[56:57], v21 offset:0
    ds_read_b64_tr_b16 v[58:59], v21 offset:512
    v_mfma_f32_16x16x32_bf16 v[144:147], v[96:99], v[88:91], v[144:147]
    s_add_u32 s36, s61, s55
    ds_read_b64_tr_b16 v[60:61], v20 offset:2048
    v_accvgpr_write_b32 a150, 0
    v_mfma_f32_16x16x32_bf16 v[148:151], v[100:103], v[76:79], v[148:151]
    buffer_load_dwordx4 v9, s[4:7], s53 offen offset:1024 lds
    v_mfma_f32_16x16x32_bf16 v[152:155], v[100:103], v[80:83], v[152:155]
    s_lshl_b32 s55, s1, 13
    ds_read_b64_tr_b16 v[62:63], v20 offset:2560
    ds_read_b64_tr_b16 v[64:65], v21 offset:2048
    v_mfma_f32_16x16x32_bf16 v[156:159], v[100:103], v[84:87], v[156:159]
    s_add_u32 s62, s61, s55
    ds_read_b64_tr_b16 v[66:67], v21 offset:2560
    v_accvgpr_write_b32 a151, 0
    v_mfma_f32_16x16x32_bf16 v[160:163], v[100:103], v[88:91], v[160:163]
    s_add_u32 s63, s62, 4096
    ds_read_b64_tr_b16 v[68:69], v20 offset:4096
    v_accvgpr_write_b32 a152, 0
    v_mfma_f32_16x16x32_bf16 v[164:167], v[104:107], v[76:79], v[164:167]
    buffer_load_dwordx4 v10, s[4:7], s53 offen offset:2048 lds
    v_mfma_f32_16x16x32_bf16 v[168:171], v[104:107], v[80:83], v[168:171]
    s_mov_b32 s64, 0x3e8293ee
    ds_read_b64_tr_b16 v[70:71], v20 offset:4608
    v_accvgpr_write_b32 a153, 0
    v_mfma_f32_16x16x32_bf16 v[172:175], v[104:107], v[84:87], v[172:175]
    s_and_b32 s65, s50, 31
    ds_read_b64_tr_b16 v[72:73], v21 offset:4096
    v_accvgpr_write_b32 a154, 0
    v_mfma_f32_16x16x32_bf16 v[176:179], v[104:107], v[88:91], v[176:179]
    s_lshl_b32 s65, s65, 1
    ds_read_b64_tr_b16 v[74:75], v21 offset:4608
    v_accvgpr_write_b32 a155, 0
    v_mfma_f32_16x16x32_bf16 v[180:183], v[76:79], v[108:111], v[180:183]
    buffer_load_dwordx4 v11, s[4:7], s53 offen offset:3072 lds
    v_mfma_f32_16x16x32_bf16 v[184:187], v[80:83], v[108:111], v[184:187]
    s_bfe_u32 s55, s49, 0x10002
    ds_read_b64_tr_b16 a[200:201], v32 offset:0
    v_accvgpr_write_b32 a128, 0
    v_mfma_f32_16x16x32_bf16 v[188:191], v[84:87], v[108:111], v[188:191]
    s_add_u32 m0, s52, 86016
    v_cos_f32 v248, v244
    v_mfma_f32_16x16x32_bf16 v[192:195], v[88:91], v[108:111], v[192:195]
    s_and_b32 s51, s51, 15
    v_sin_f32 v244, v244
    v_mfma_f32_16x16x32_bf16 v[196:199], v[76:79], v[112:115], v[196:199]
    buffer_load_dwordx4 v12, s[8:11], s54 offen offset:0 lds
    v_mfma_f32_16x16x32_bf16 v[200:203], v[80:83], v[112:115], v[200:203]
    s_add_u32 s65, s65, s55
    v_cos_f32 v249, v245
    v_mfma_f32_16x16x32_bf16 v[204:207], v[84:87], v[112:115], v[204:207]
    s_lshl_b32 s65, s65, 5
    v_sin_f32 v245, v245
    v_mfma_f32_16x16x32_bf16 v[208:211], v[88:91], v[112:115], v[208:211]
    s_waitcnt lgkmcnt(0)
    v_mfma_f32_16x16x32_bf16 v[116:119], v[52:55], v[36:39], v[116:119]
    s_and_b32 s55, s49, 3
    ds_read_b128 v[76:79], v19 offset:0
    v_cvt_pk_bf16_f32 v248, v248, v249
    v_mfma_f32_16x16x32_bf16 v[120:123], v[52:55], v[40:43], v[120:123]
    s_lshl_b32 s55, s55, 2
    ds_read_b128 v[80:83], v19 offset:2048
    v_accvgpr_write_b32 a8, v248
    v_mfma_f32_16x16x32_bf16 v[124:127], v[52:55], v[44:47], v[124:127]
    s_add_u32 s65, s65, s55
    ds_read_b128 v[84:87], v19 offset:10240
    v_xor_b32 v248, v6, v248
    v_mfma_f32_16x16x32_bf16 v[128:131], v[52:55], v[48:51], v[128:131]
    s_and_b32 s55, s49, 8
    ds_read_b128 v[88:91], v19 offset:12288
    v_accvgpr_write_b32 a12, v248
    v_mfma_f32_16x16x32_bf16 v[132:135], v[56:59], v[36:39], v[132:135]
    buffer_load_dwordx4 v13, s[8:11], s54 offen offset:1024 lds
    v_mfma_f32_16x16x32_bf16 v[136:139], v[56:59], v[40:43], v[136:139]
    s_lshl_b32 s55, s55, 1
    ds_read_b64_tr_b16 v[92:93], v20 offset:20480
    ds_read_b64_tr_b16 v[94:95], v20 offset:20992
    v_mfma_f32_16x16x32_bf16 v[140:143], v[56:59], v[44:47], v[140:143]
    s_add_u32 s65, s65, s55
    ds_read_b64_tr_b16 v[96:97], v21 offset:20480
    ds_read_b64_tr_b16 v[98:99], v21 offset:20992
    v_mfma_f32_16x16x32_bf16 v[144:147], v[56:59], v[48:51], v[144:147]
    s_lshr_b32 s55, s50, 5
    ds_read_b64_tr_b16 v[100:101], v20 offset:22528
    v_accvgpr_write_b32 a129, 0
    v_mfma_f32_16x16x32_bf16 v[148:151], v[60:63], v[36:39], v[148:151]
    buffer_load_dwordx4 v14, s[8:11], s54 offen offset:2048 lds
    v_mfma_f32_16x16x32_bf16 v[152:155], v[60:63], v[40:43], v[152:155]
    s_add_u32 s65, s65, s55
    ds_read_b64_tr_b16 v[102:103], v20 offset:23040
    ds_read_b64_tr_b16 v[104:105], v21 offset:22528
    v_mfma_f32_16x16x32_bf16 v[156:159], v[60:63], v[44:47], v[156:159]
    s_lshl_b32 s65, s65, 2
    ds_read_b64_tr_b16 v[106:107], v21 offset:23040
    v_accvgpr_write_b32 a130, 0
    v_mfma_f32_16x16x32_bf16 v[160:163], v[60:63], v[48:51], v[160:163]
    s_lshl_b32 s3, s75, 1
    ds_read_b64_tr_b16 v[108:109], v20 offset:24576
    v_accvgpr_write_b32 a131, 0
    v_mfma_f32_16x16x32_bf16 v[164:167], v[64:67], v[36:39], v[164:167]
    buffer_load_dwordx4 v15, s[8:11], s54 offen offset:3072 lds
    v_mfma_f32_16x16x32_bf16 v[168:171], v[64:67], v[40:43], v[168:171]
    s_add_u32 s3, s3, s48
    ds_read_b64_tr_b16 v[110:111], v20 offset:25088
    v_accvgpr_write_b32 a132, 0
    v_mfma_f32_16x16x32_bf16 v[172:175], v[64:67], v[44:47], v[172:175]
    s_lshl_b32 s3, s3, 7
    ds_read_b64_tr_b16 v[112:113], v21 offset:24576
    v_accvgpr_write_b32 a133, 0
    v_mfma_f32_16x16x32_bf16 v[176:179], v[64:67], v[48:51], v[176:179]
    s_add_u32 m0, s52, 90112
    ds_read_b64_tr_b16 v[114:115], v21 offset:25088
    v_accvgpr_write_b32 a134, 0
    v_mfma_f32_16x16x32_bf16 v[180:183], v[36:39], v[68:71], v[180:183]
    buffer_load_dwordx4 v16, s[8:11], s54 offen offset:0 lds
    v_mfma_f32_16x16x32_bf16 v[184:187], v[40:43], v[68:71], v[184:187]
    s_lshl_b32 s67, s42, 2
    ds_read_b64_tr_b16 a[202:203], v32 offset:10240
    v_accvgpr_write_b32 a135, 0
    v_mfma_f32_16x16x32_bf16 v[188:191], v[44:47], v[68:71], v[188:191]
    s_add_u32 s67, s67, s40
    v_cos_f32 v250, v246
    v_mfma_f32_16x16x32_bf16 v[192:195], v[48:51], v[68:71], v[192:195]
    s_lshl_b32 s67, s67, 7
    v_sin_f32 v246, v246
    v_mfma_f32_16x16x32_bf16 v[196:199], v[36:39], v[72:75], v[196:199]
    buffer_load_dwordx4 v17, s[8:11], s54 offen offset:1024 lds
    v_mfma_f32_16x16x32_bf16 v[200:203], v[40:43], v[72:75], v[200:203]
    s_add_u32 s67, s67, 12288
    v_cos_f32 v251, v247
    v_mfma_f32_16x16x32_bf16 v[204:207], v[44:47], v[72:75], v[204:207]
    s_lshl_b32 s66, s1, 2
    v_sin_f32 v247, v247
    v_mfma_f32_16x16x32_bf16 v[208:211], v[48:51], v[72:75], v[208:211]
    s_waitcnt vmcnt(10) lgkmcnt(0)
    s_barrier
    v_mfma_f32_16x16x32_bf16 v[116:119], v[92:95], v[76:79], v[116:119]
    s_lshl_b32 s53, s51, 7
    ds_read_b128 v[36:39], v22 offset:0
    v_cvt_pk_bf16_f32 v249, v250, v251
    v_mfma_f32_16x16x32_bf16 v[120:123], v[92:95], v[80:83], v[120:123]
    s_mul_i32 s54, s51, 393216
    ds_read_b128 v[40:43], v22 offset:2048
    v_cvt_pk_bf16_f32 v250, -v244, -v245
    v_mfma_f32_16x16x32_bf16 v[124:127], v[92:95], v[84:87], v[124:127]
    s_add_u32 m0, s52, 0
    ds_read_b128 v[44:47], v22 offset:10240
    v_cvt_pk_bf16_f32 v251, -v246, -v247
    v_mfma_f32_16x16x32_bf16 v[128:131], v[92:95], v[88:91], v[128:131]
    s_add_u32 s51, s51, 1
    ds_read_b128 v[48:51], v22 offset:12288
    v_cvt_pk_bf16_f32 v244, v244, v245
    v_mfma_f32_16x16x32_bf16 v[132:135], v[96:99], v[76:79], v[132:135]
    buffer_load_dwordx4 v8, s[4:7], s53 offen offset:0 lds
    v_mfma_f32_16x16x32_bf16 v[136:139], v[96:99], v[80:83], v[136:139]
    s_add_u32 s66, s66, s67
    ds_read_b64_tr_b16 v[52:53], v24 offset:0
    ds_read_b64_tr_b16 v[54:55], v24 offset:512
    v_mfma_f32_16x16x32_bf16 v[140:143], v[96:99], v[84:87], v[140:143]
    s_mov_b32 s43, 0
    ds_read_b64_tr_b16 v[56:57], v25 offset:0
    ds_read_b64_tr_b16 v[58:59], v25 offset:512
    v_mfma_f32_16x16x32_bf16 v[144:147], v[96:99], v[88:91], v[144:147]
    s_cmp_lt_u32 s37, 8
    s_cselect_b32 s38, 0x4000000, s62
    s_cselect_b32 s39, 0x4000000, s63
    s_cselect_b32 s0, 0x100000, s66
    s_cselect_b32 s62, s62, 0x4000000
    s_cselect_b32 s63, s63, 0x4000000
    s_cselect_b32 s66, s66, 0x100000
    ds_read_b64_tr_b16 v[60:61], v24 offset:2048
    v_cvt_pk_bf16_f32 v245, v246, v247
    v_mfma_f32_16x16x32_bf16 v[148:151], v[100:103], v[76:79], v[148:151]
    buffer_load_dwordx4 v9, s[4:7], s53 offen offset:1024 lds
    v_mfma_f32_16x16x32_bf16 v[152:155], v[100:103], v[80:83], v[152:155]
    s_mov_b32 s68, -1
    ds_read_b64_tr_b16 v[62:63], v24 offset:2560
    ds_read_b64_tr_b16 v[64:65], v25 offset:2048
    v_mfma_f32_16x16x32_bf16 v[156:159], v[100:103], v[84:87], v[156:159]
    s_mov_b32 s70, 4
    ds_read_b64_tr_b16 v[66:67], v25 offset:2560
    v_accvgpr_write_b32 a16, v244
    v_mfma_f32_16x16x32_bf16 v[160:163], v[100:103], v[88:91], v[160:163]
    s_lshl_b32 s55, s50, 11
    ds_read_b64_tr_b16 v[68:69], v24 offset:4096
    v_xor_b32 v244, v6, v244
    v_mfma_f32_16x16x32_bf16 v[164:167], v[104:107], v[76:79], v[164:167]
    buffer_load_dwordx4 v10, s[4:7], s53 offen offset:2048 lds
    v_mfma_f32_16x16x32_bf16 v[168:171], v[104:107], v[80:83], v[168:171]
    s_add_u32 s55, s55, 16777216
    ds_read_b64_tr_b16 v[70:71], v24 offset:4608
    v_accvgpr_write_b32 a20, v244
    v_mfma_f32_16x16x32_bf16 v[172:175], v[104:107], v[84:87], v[172:175]
    s_lshl_b32 s76, s49, 18
    ds_read_b64_tr_b16 v[72:73], v25 offset:4096
    v_accvgpr_write_b32 a24, v250
    v_mfma_f32_16x16x32_bf16 v[176:179], v[104:107], v[88:91], v[176:179]
    s_add_u32 s76, s76, s55
    ds_read_b64_tr_b16 v[74:75], v25 offset:4608
    v_xor_b32 v250, v6, v250
    v_mfma_f32_16x16x32_bf16 v[180:183], v[76:79], v[108:111], v[180:183]
    buffer_load_dwordx4 v11, s[4:7], s53 offen offset:3072 lds
    v_mfma_f32_16x16x32_bf16 v[184:187], v[80:83], v[108:111], v[184:187]
    s_add_u32 s77, s76, 131072
    ds_read_b64_tr_b16 a[204:205], v32 offset:40960
    v_accvgpr_write_b32 a28, v250
    v_mfma_f32_16x16x32_bf16 v[188:191], v[84:87], v[108:111], v[188:191]
    s_add_u32 m0, s52, 4096
    v_cos_f32 v218, v234
    v_mfma_f32_16x16x32_bf16 v[192:195], v[88:91], v[108:111], v[192:195]
    s_and_b32 s51, s51, 15
    v_cos_f32 v219, v235
    v_mfma_f32_16x16x32_bf16 v[196:199], v[76:79], v[112:115], v[196:199]
    buffer_load_dwordx4 v12, s[8:11], s54 offen offset:0 lds
    v_mfma_f32_16x16x32_bf16 v[200:203], v[80:83], v[112:115], v[200:203]
    s_sub_u32 s78, 32, s49
    v_cos_f32 v220, v236
    v_mfma_f32_16x16x32_bf16 v[204:207], v[84:87], v[112:115], v[204:207]
    s_cmp_eq_u32 s49, 0
    s_cselect_b32 s78, 16, s78
    v_sin_f32 v236, v236
    v_mfma_f32_16x16x32_bf16 v[208:211], v[88:91], v[112:115], v[208:211]
    s_waitcnt lgkmcnt(0)
    v_mfma_f32_16x16x32_bf16 v[116:119], v[52:55], v[36:39], v[116:119]
    s_lshl_b32 s78, s78, 18
    ds_read_b128 v[76:79], v23 offset:0
    v_accvgpr_write_b32 a9, v249
    v_mfma_f32_16x16x32_bf16 v[120:123], v[52:55], v[40:43], v[120:123]
    s_add_u32 s78, s78, s55
    ds_read_b128 v[80:83], v23 offset:2048
    v_xor_b32 v249, v6, v249
    v_mfma_f32_16x16x32_bf16 v[124:127], v[52:55], v[44:47], v[124:127]
    s_add_u32 s79, s78, 131072
    ds_read_b128 v[84:87], v23 offset:10240
    v_accvgpr_write_b32 a13, v249
    v_mfma_f32_16x16x32_bf16 v[128:131], v[52:55], v[48:51], v[128:131]
    s_lshl_b32 s80, s49, 1
    ds_read_b128 v[88:91], v23 offset:12288
    v_accvgpr_write_b32 a17, v245
    v_mfma_f32_16x16x32_bf16 v[132:135], v[56:59], v[36:39], v[132:135]
    buffer_load_dwordx4 v13, s[8:11], s54 offen offset:1024 lds
    v_mfma_f32_16x16x32_bf16 v[136:139], v[56:59], v[40:43], v[136:139]
    s_lshr_b32 s55, s50, 5
    ds_read_b64_tr_b16 v[92:93], v24 offset:20480
    ds_read_b64_tr_b16 v[94:95], v24 offset:20992
    v_mfma_f32_16x16x32_bf16 v[140:143], v[56:59], v[44:47], v[140:143]
    s_add_u32 s80, s80, s55
    ds_read_b64_tr_b16 v[96:97], v25 offset:20480
    ds_read_b64_tr_b16 v[98:99], v25 offset:20992
    v_mfma_f32_16x16x32_bf16 v[144:147], v[56:59], v[48:51], v[144:147]
    s_lshl_b32 s80, s80, 7
    ds_read_b64_tr_b16 v[100:101], v24 offset:22528
    v_xor_b32 v245, v6, v245
    v_mfma_f32_16x16x32_bf16 v[148:151], v[60:63], v[36:39], v[148:151]
    buffer_load_dwordx4 v14, s[8:11], s54 offen offset:2048 lds
    v_mfma_f32_16x16x32_bf16 v[152:155], v[60:63], v[40:43], v[152:155]
    s_and_b32 s55, s50, 31
    ds_read_b64_tr_b16 v[102:103], v24 offset:23040
    ds_read_b64_tr_b16 v[104:105], v25 offset:22528
    v_mfma_f32_16x16x32_bf16 v[156:159], v[60:63], v[44:47], v[156:159]
    s_lshl_b32 s55, s55, 2
    ds_read_b64_tr_b16 v[106:107], v25 offset:23040
    v_accvgpr_write_b32 a21, v245
    v_mfma_f32_16x16x32_bf16 v[160:163], v[60:63], v[48:51], v[160:163]
L_pg0:
    s_cbranch_execz L_pg4
    s_add_u32 s80, s80, s55
    ds_read_b64_tr_b16 v[108:109], v24 offset:24576
    v_accvgpr_write_b32 a25, v251
    v_mfma_f32_16x16x32_bf16 v[164:167], v[64:67], v[36:39], v[164:167]
    buffer_load_dwordx4 v15, s[8:11], s54 offen offset:3072 lds
    v_mfma_f32_16x16x32_bf16 v[168:171], v[64:67], v[40:43], v[168:171]
    s_add_u32 s80, s80, 8192
    ds_read_b64_tr_b16 v[110:111], v24 offset:25088
    v_xor_b32 v251, v6, v251
    v_mfma_f32_16x16x32_bf16 v[172:175], v[64:67], v[44:47], v[172:175]
    s_sub_u32 s81, 32, s75
    ds_read_b64_tr_b16 v[112:113], v25 offset:24576
    v_accvgpr_write_b32 a29, v251
    v_mfma_f32_16x16x32_bf16 v[176:179], v[64:67], v[48:51], v[176:179]
    s_add_u32 m0, s52, 8192
    ds_read_b64_tr_b16 v[114:115], v25 offset:25088
    v_mul_f32 v244, 0x42000000, v232
    v_mfma_f32_16x16x32_bf16 v[180:183], v[36:39], v[68:71], v[180:183]
    buffer_load_dwordx4 v16, s[8:11], s54 offen offset:0 lds
    v_mfma_f32_16x16x32_bf16 v[184:187], v[40:43], v[68:71], v[184:187]
    s_and_b32 s81, s81, 15
    ds_read_b64_tr_b16 a[206:207], v32 offset:51200
    v_mul_f32 v245, 0x42000000, v233
    v_mfma_f32_16x16x32_bf16 v[188:191], v[44:47], v[68:71], v[188:191]
    s_cmp_lt_u32 s75, 16
    s_cselect_b32 s81, s75, s81
    v_sin_f32 v232, v232
    v_mfma_f32_16x16x32_bf16 v[192:195], v[48:51], v[68:71], v[192:195]
    s_lshl_b32 s81, s81, 8
    v_sin_f32 v233, v233
    v_mfma_f32_16x16x32_bf16 v[196:199], v[36:39], v[72:75], v[196:199]
    buffer_load_dwordx4 v17, s[8:11], s54 offen offset:1024 lds
    v_mfma_f32_16x16x32_bf16 v[200:203], v[40:43], v[72:75], v[200:203]
    s_add_u32 s81, s81, 8192
    v_cos_f32 v248, v244
    v_mfma_f32_16x16x32_bf16 v[204:207], v[44:47], v[72:75], v[204:207]
    s_lshl_b32 s85, s41, 18
    v_sin_f32 v244, v244
    v_mfma_f32_16x16x32_bf16 v[208:211], v[48:51], v[72:75], v[208:211]
    s_waitcnt vmcnt(10) lgkmcnt(0)
    s_barrier
    v_mfma_f32_16x16x32_bf16 v[116:119], v[92:95], v[76:79], v[116:119]
    s_lshl_b32 s53, s51, 7
    ds_read_b128 v[36:39], v26 offset:0
    v_mul_f32 v246, 0x42000000, v234
    v_mfma_f32_16x16x32_bf16 v[120:123], v[92:95], v[80:83], v[120:123]
    s_mul_i32 s54, s51, 393216
    ds_read_b128 v[40:43], v26 offset:2048
    v_mul_f32 v247, 0x42000000, v235
    v_mfma_f32_16x16x32_bf16 v[124:127], v[92:95], v[84:87], v[124:127]
    s_add_u32 m0, s52, 40960
    ds_read_b128 v[44:47], v26 offset:10240
    v_accvgpr_write_b32 a136, 0
    v_mfma_f32_16x16x32_bf16 v[128:131], v[92:95], v[88:91], v[128:131]
    s_add_u32 s51, s51, 1
    ds_read_b128 v[48:51], v26 offset:12288
    v_accvgpr_write_b32 a137, 0
    v_mfma_f32_16x16x32_bf16 v[132:135], v[96:99], v[76:79], v[132:135]
    buffer_load_dwordx4 v8, s[4:7], s53 offen offset:0 lds
    v_mfma_f32_16x16x32_bf16 v[136:139], v[96:99], v[80:83], v[136:139]
    s_lshl_b32 s55, s47, 13
    ds_read_b64_tr_b16 v[52:53], v28 offset:0
    ds_read_b64_tr_b16 v[54:55], v28 offset:512
    v_mfma_f32_16x16x32_bf16 v[140:143], v[96:99], v[84:87], v[140:143]
    s_add_u32 s85, s85, s55
    ds_read_b64_tr_b16 v[56:57], v29 offset:0
    ds_read_b64_tr_b16 v[58:59], v29 offset:512
    v_mfma_f32_16x16x32_bf16 v[144:147], v[96:99], v[88:91], v[144:147]
    s_lshl_b32 s55, s48, 12
    ds_read_b64_tr_b16 v[60:61], v28 offset:2048
    v_accvgpr_write_b32 a138, 0
    v_mfma_f32_16x16x32_bf16 v[148:151], v[100:103], v[76:79], v[148:151]
    buffer_load_dwordx4 v9, s[4:7], s53 offen offset:1024 lds
    v_mfma_f32_16x16x32_bf16 v[152:155], v[100:103], v[80:83], v[152:155]
    s_add_u32 s85, s85, s55
    ds_read_b64_tr_b16 v[62:63], v28 offset:2560
    ds_read_b64_tr_b16 v[64:65], v29 offset:2048
    v_mfma_f32_16x16x32_bf16 v[156:159], v[100:103], v[84:87], v[156:159]
    s_add_u32 s85, s85, 12582912
    ds_read_b64_tr_b16 v[66:67], v29 offset:2560
    v_accvgpr_write_b32 a139, 0
    v_mfma_f32_16x16x32_bf16 v[160:163], v[100:103], v[88:91], v[160:163]
    s_lshl_b32 s86, s41, 7
    ds_read_b64_tr_b16 v[68:69], v28 offset:4096
    v_accvgpr_write_b32 a140, 0
    v_mfma_f32_16x16x32_bf16 v[164:167], v[104:107], v[76:79], v[164:167]
    buffer_load_dwordx4 v10, s[4:7], s53 offen offset:2048 lds
    v_mfma_f32_16x16x32_bf16 v[168:171], v[104:107], v[80:83], v[168:171]
    s_lshl_b32 s55, s48, 5
    ds_read_b64_tr_b16 v[70:71], v28 offset:4608
    v_accvgpr_write_b32 a141, 0
    v_mfma_f32_16x16x32_bf16 v[172:175], v[104:107], v[84:87], v[172:175]
    s_add_u32 s86, s86, s55
    ds_read_b64_tr_b16 v[72:73], v29 offset:4096
    v_accvgpr_write_b32 a142, 0
    v_mfma_f32_16x16x32_bf16 v[176:179], v[104:107], v[88:91], v[176:179]
    s_add_u32 s86, s86, s47
    ds_read_b64_tr_b16 v[74:75], v29 offset:4608
    v_accvgpr_write_b32 a143, 0
    v_mfma_f32_16x16x32_bf16 v[180:183], v[76:79], v[108:111], v[180:183]
    buffer_load_dwordx4 v11, s[4:7], s53 offen offset:3072 lds
    v_mfma_f32_16x16x32_bf16 v[184:187], v[80:83], v[108:111], v[184:187]
    s_lshl_b32 s86, s86, 7
    ds_read_b64_tr_b16 a[208:209], v254 offset:0
    v_mfma_f32_16x16x32_bf16 v[188:191], v[84:87], v[108:111], v[188:191]
    s_add_u32 m0, s52, 45056
    v_sin_f32 v234, v234
    v_mfma_f32_16x16x32_bf16 v[192:195], v[88:91], v[108:111], v[192:195]
    s_and_b32 s51, s51, 15
    v_sin_f32 v235, v235
    v_mfma_f32_16x16x32_bf16 v[196:199], v[76:79], v[112:115], v[196:199]
    buffer_load_dwordx4 v12, s[8:11], s54 offen offset:0 lds
    v_mfma_f32_16x16x32_bf16 v[200:203], v[80:83], v[112:115], v[200:203]
    s_add_u32 s86, s86, 20480
    v_cos_f32 v249, v245
    v_mfma_f32_16x16x32_bf16 v[204:207], v[84:87], v[112:115], v[204:207]
    buffer_store_dword v30, v31, s[28:31], s58 offen sc1
    v_mfma_f32_16x16x32_bf16 v[208:211], v[88:91], v[112:115], v[208:211]
    s_waitcnt lgkmcnt(0)
    v_mfma_f32_16x16x32_bf16 v[116:119], v[52:55], v[36:39], v[116:119]
    s_lshl_b32 s87, s45, 14
    ds_read_b128 v[76:79], v27 offset:0
    v_cvt_pk_bf16_f32 v248, v248, v249
    v_mfma_f32_16x16x32_bf16 v[120:123], v[52:55], v[40:43], v[120:123]
    s_add_u32 s87, s87, 20480
    ds_read_b128 v[80:83], v27 offset:2048
    v_accvgpr_write_b32 a10, v248
    v_mfma_f32_16x16x32_bf16 v[124:127], v[52:55], v[44:47], v[124:127]
    s_lshr_b32 s55, s72, 16
    ds_read_b128 v[84:87], v27 offset:10240
    v_xor_b32 v248, v6, v248
    v_mfma_f32_16x16x32_bf16 v[128:131], v[52:55], v[48:51], v[128:131]
    s_xor_b32 s55, s55, s40
    ds_read_b128 v[88:91], v27 offset:12288
    v_accvgpr_write_b32 a14, v248
    v_mfma_f32_16x16x32_bf16 v[132:135], v[56:59], v[36:39], v[132:135]
    buffer_load_dwordx4 v13, s[8:11], s54 offen offset:1024 lds
    v_mfma_f32_16x16x32_bf16 v[136:139], v[56:59], v[40:43], v[136:139]
    s_lshl_b32 s55, s55, 11
    ds_read_b64_tr_b16 v[92:93], v28 offset:20480
    ds_read_b64_tr_b16 v[94:95], v28 offset:20992
    v_mfma_f32_16x16x32_bf16 v[140:143], v[56:59], v[44:47], v[140:143]
    s_add_u32 s87, s87, s55
    ds_read_b64_tr_b16 v[96:97], v29 offset:20480
    ds_read_b64_tr_b16 v[98:99], v29 offset:20992
    v_mfma_f32_16x16x32_bf16 v[144:147], v[56:59], v[48:51], v[144:147]
    s_lshl_b32 s88, s45, 18
    ds_read_b64_tr_b16 v[100:101], v28 offset:22528
    v_mfma_f32_16x16x32_bf16 v[148:151], v[60:63], v[36:39], v[148:151]
    buffer_load_dwordx4 v14, s[8:11], s54 offen offset:2048 lds
    v_mfma_f32_16x16x32_bf16 v[152:155], v[60:63], v[40:43], v[152:155]
    s_and_b32 s55, s40, 2
    ds_read_b64_tr_b16 v[102:103], v28 offset:23040
    ds_read_b64_tr_b16 v[104:105], v29 offset:22528
    v_mfma_f32_16x16x32_bf16 v[156:159], v[60:63], v[44:47], v[156:159]
    s_lshl_b32 s55, s55, 11
    ds_read_b64_tr_b16 v[106:107], v29 offset:23040
    v_mfma_f32_16x16x32_bf16 v[160:163], v[60:63], v[48:51], v[160:163]
    s_add_u32 s88, s88, s55
    ds_read_b64_tr_b16 v[108:109], v28 offset:24576
    v_mfma_f32_16x16x32_bf16 v[164:167], v[64:67], v[36:39], v[164:167]
    buffer_load_dwordx4 v15, s[8:11], s54 offen offset:3072 lds
    v_mfma_f32_16x16x32_bf16 v[168:171], v[64:67], v[40:43], v[168:171]
    s_lshl_b32 s55, s48, 16
    ds_read_b64_tr_b16 v[110:111], v28 offset:25088
    v_mfma_f32_16x16x32_bf16 v[172:175], v[64:67], v[44:47], v[172:175]
    s_xor_b32 s55, s55, s72
    ds_read_b64_tr_b16 v[112:113], v29 offset:24576
    v_mfma_f32_16x16x32_bf16 v[176:179], v[64:67], v[48:51], v[176:179]
    s_add_u32 m0, s52, 49152
    ds_read_b64_tr_b16 v[114:115], v29 offset:25088
    v_mfma_f32_16x16x32_bf16 v[180:183], v[36:39], v[68:71], v[180:183]
    buffer_load_dwordx4 v16, s[8:11], s54 offen offset:0 lds
    v_mfma_f32_16x16x32_bf16 v[184:187], v[40:43], v[68:71], v[184:187]
    s_lshl_b32 s55, s55, 1
    ds_read_b64_tr_b16 a[210:211], v254 offset:10240
    v_mfma_f32_16x16x32_bf16 v[188:191], v[44:47], v[68:71], v[188:191]
    s_add_u32 s88, s88, s55
    v_sin_f32 v245, v245
    v_mfma_f32_16x16x32_bf16 v[192:195], v[48:51], v[68:71], v[192:195]
    s_add_u32 s88, s88, 12582912
    v_cos_f32 v250, v246
    v_mfma_f32_16x16x32_bf16 v[196:199], v[36:39], v[72:75], v[196:199]
    buffer_load_dwordx4 v17, s[8:11], s54 offen offset:1024 lds
    v_mfma_f32_16x16x32_bf16 v[200:203], v[40:43], v[72:75], v[200:203]
    s_lshl_b32 s95, s46, 7
    v_sin_f32 v246, v246
    v_mfma_f32_16x16x32_bf16 v[204:207], v[44:47], v[72:75], v[204:207]
    s_add_u32 s96, s95, 2097152
    v_cos_f32 v251, v247
    v_mfma_f32_16x16x32_bf16 v[208:211], v[48:51], v[72:75], v[208:211]
    s_waitcnt vmcnt(11) lgkmcnt(0)
    s_barrier
    v_mfma_f32_16x16x32_bf16 v[116:119], v[92:95], v[76:79], v[116:119]
    s_lshl_b32 s53, s51, 7
    ds_read_b128 v[36:39], v18 offset:0
    v_cvt_pk_bf16_f32 v249, v250, v251
    v_mfma_f32_16x16x32_bf16 v[120:123], v[92:95], v[80:83], v[120:123]
    s_mul_i32 s54, s51, 393216
    ds_read_b128 v[40:43], v18 offset:2048
    v_cvt_pk_bf16_f32 v250, -v244, -v245
    v_mfma_f32_16x16x32_bf16 v[124:127], v[92:95], v[84:87], v[124:127]
    s_add_u32 m0, s52, 81920
    ds_read_b128 v[44:47], v18 offset:10240
    v_cvt_pk_bf16_f32 v244, v244, v245
    v_mfma_f32_16x16x32_bf16 v[128:131], v[92:95], v[88:91], v[128:131]
    s_add_u32 s51, s51, 1
    ds_read_b128 v[48:51], v18 offset:12288
    v_accvgpr_write_b32 a18, v244
    v_mfma_f32_16x16x32_bf16 v[132:135], v[96:99], v[76:79], v[132:135]
    buffer_load_dwordx4 v8, s[4:7], s53 offen offset:0 lds
    v_mfma_f32_16x16x32_bf16 v[136:139], v[96:99], v[80:83], v[136:139]
    ds_read_b64_tr_b16 v[52:53], v20 offset:0
    ds_read_b64_tr_b16 v[54:55], v20 offset:512
    v_mfma_f32_16x16x32_bf16 v[140:143], v[96:99], v[84:87], v[140:143]
    ds_read_b64_tr_b16 v[56:57], v21 offset:0
    ds_read_b64_tr_b16 v[58:59], v21 offset:512
    v_mfma_f32_16x16x32_bf16 v[144:147], v[96:99], v[88:91], v[144:147]
    ds_read_b64_tr_b16 v[60:61], v20 offset:2048
    v_xor_b32 v244, v6, v244
    v_mfma_f32_16x16x32_bf16 v[148:151], v[100:103], v[76:79], v[148:151]
    buffer_load_dwordx4 v9, s[4:7], s53 offen offset:1024 lds
    v_mfma_f32_16x16x32_bf16 v[152:155], v[100:103], v[80:83], v[152:155]
    ds_read_b64_tr_b16 v[62:63], v20 offset:2560
    ds_read_b64_tr_b16 v[64:65], v21 offset:2048
    v_mfma_f32_16x16x32_bf16 v[156:159], v[100:103], v[84:87], v[156:159]
    ds_read_b64_tr_b16 v[66:67], v21 offset:2560
    v_accvgpr_write_b32 a22, v244
    v_mfma_f32_16x16x32_bf16 v[160:163], v[100:103], v[88:91], v[160:163]
    ds_read_b64_tr_b16 v[68:69], v20 offset:4096
    v_accvgpr_write_b32 a26, v250
    v_mfma_f32_16x16x32_bf16 v[164:167], v[104:107], v[76:79], v[164:167]
    buffer_load_dwordx4 v10, s[4:7], s53 offen offset:2048 lds
    v_mfma_f32_16x16x32_bf16 v[168:171], v[104:107], v[80:83], v[168:171]
    ds_read_b64_tr_b16 v[70:71], v20 offset:4608
    v_xor_b32 v250, v6, v250
    v_mfma_f32_16x16x32_bf16 v[172:175], v[104:107], v[84:87], v[172:175]
    ds_read_b64_tr_b16 v[72:73], v21 offset:4096
    v_accvgpr_write_b32 a30, v250
    v_mfma_f32_16x16x32_bf16 v[176:179], v[104:107], v[88:91], v[176:179]
    ds_read_b64_tr_b16 v[74:75], v21 offset:4608
    v_accvgpr_write_b32 a11, v249
    v_mfma_f32_16x16x32_bf16 v[180:183], v[76:79], v[108:111], v[180:183]
    buffer_load_dwordx4 v11, s[4:7], s53 offen offset:3072 lds
    v_mfma_f32_16x16x32_bf16 v[184:187], v[80:83], v[108:111], v[184:187]
    ds_read_b64_tr_b16 a[212:213], v32 offset:0
    v_xor_b32 v249, v6, v249
    v_mfma_f32_16x16x32_bf16 v[188:191], v[84:87], v[108:111], v[188:191]
    s_add_u32 m0, s52, 86016
    v_sin_f32 v247, v247
    v_mfma_f32_16x16x32_bf16 v[192:195], v[88:91], v[108:111], v[192:195]
    s_and_b32 s51, s51, 15
    v_cos_f32 v221, v237
    v_mfma_f32_16x16x32_bf16 v[196:199], v[76:79], v[112:115], v[196:199]
    buffer_load_dwordx4 v12, s[8:11], s54 offen offset:0 lds
    v_mfma_f32_16x16x32_bf16 v[200:203], v[80:83], v[112:115], v[200:203]
    v_sin_f32 v237, v237
    v_mfma_f32_16x16x32_bf16 v[204:207], v[84:87], v[112:115], v[204:207]
    v_cos_f32 v222, v238
    v_mfma_f32_16x16x32_bf16 v[208:211], v[88:91], v[112:115], v[208:211]
    s_waitcnt lgkmcnt(0)
    v_mfma_f32_16x16x32_bf16 v[116:119], v[52:55], v[36:39], v[116:119]
    ds_read_b128 v[76:79], v19 offset:0
    v_cvt_pk_bf16_f32 v251, -v246, -v247
    v_mfma_f32_16x16x32_bf16 v[120:123], v[52:55], v[40:43], v[120:123]
    ds_read_b128 v[80:83], v19 offset:2048
    v_cvt_pk_bf16_f32 v245, v246, v247
    v_mfma_f32_16x16x32_bf16 v[124:127], v[52:55], v[44:47], v[124:127]
    ds_read_b128 v[84:87], v19 offset:10240
    v_accvgpr_write_b32 a15, v249
    v_mfma_f32_16x16x32_bf16 v[128:131], v[52:55], v[48:51], v[128:131]
    ds_read_b128 v[88:91], v19 offset:12288
    v_accvgpr_write_b32 a19, v245
    v_mfma_f32_16x16x32_bf16 v[132:135], v[56:59], v[36:39], v[132:135]
    buffer_load_dwordx4 v13, s[8:11], s54 offen offset:1024 lds
    v_mfma_f32_16x16x32_bf16 v[136:139], v[56:59], v[40:43], v[136:139]
    ds_read_b64_tr_b16 v[92:93], v20 offset:20480
    ds_read_b64_tr_b16 v[94:95], v20 offset:20992
    v_mfma_f32_16x16x32_bf16 v[140:143], v[56:59], v[44:47], v[140:143]
    ds_read_b64_tr_b16 v[96:97], v21 offset:20480
    ds_read_b64_tr_b16 v[98:99], v21 offset:20992
    v_mfma_f32_16x16x32_bf16 v[144:147], v[56:59], v[48:51], v[144:147]
    ds_read_b64_tr_b16 v[100:101], v20 offset:22528
    v_xor_b32 v245, v6, v245
    v_mfma_f32_16x16x32_bf16 v[148:151], v[60:63], v[36:39], v[148:151]
    buffer_load_dwordx4 v14, s[8:11], s54 offen offset:2048 lds
    v_mfma_f32_16x16x32_bf16 v[152:155], v[60:63], v[40:43], v[152:155]
    ds_read_b64_tr_b16 v[102:103], v20 offset:23040
    ds_read_b64_tr_b16 v[104:105], v21 offset:22528
    v_mfma_f32_16x16x32_bf16 v[156:159], v[60:63], v[44:47], v[156:159]
    ds_read_b64_tr_b16 v[106:107], v21 offset:23040
    v_accvgpr_write_b32 a23, v245
    v_mfma_f32_16x16x32_bf16 v[160:163], v[60:63], v[48:51], v[160:163]
    ds_read_b64_tr_b16 v[108:109], v20 offset:24576
    v_accvgpr_write_b32 a27, v251
    v_mfma_f32_16x16x32_bf16 v[164:167], v[64:67], v[36:39], v[164:167]
    buffer_load_dwordx4 v15, s[8:11], s54 offen offset:3072 lds
    v_mfma_f32_16x16x32_bf16 v[168:171], v[64:67], v[40:43], v[168:171]
    ds_read_b64_tr_b16 v[110:111], v20 offset:25088
    v_xor_b32 v251, v6, v251
    v_mfma_f32_16x16x32_bf16 v[172:175], v[64:67], v[44:47], v[172:175]
    ds_read_b64_tr_b16 v[112:113], v21 offset:24576
    v_accvgpr_write_b32 a31, v251
    v_mfma_f32_16x16x32_bf16 v[176:179], v[64:67], v[48:51], v[176:179]
    s_add_u32 m0, s52, 90112
    ds_read_b64_tr_b16 v[114:115], v21 offset:25088
    v_mov_b32 v6, s49
    v_mfma_f32_16x16x32_bf16 v[180:183], v[36:39], v[68:71], v[180:183]
    buffer_load_dwordx4 v16, s[8:11], s54 offen offset:0 lds
    v_mfma_f32_16x16x32_bf16 v[184:187], v[40:43], v[68:71], v[184:187]
    ds_read_b64_tr_b16 a[214:215], v32 offset:10240
    v_and_b32 v6, 12, v6
    v_mfma_f32_16x16x32_bf16 v[188:191], v[44:47], v[68:71], v[188:191]
    v_sin_f32 v238, v238
    v_mfma_f32_16x16x32_bf16 v[192:195], v[48:51], v[68:71], v[192:195]
    v_cos_f32 v223, v239
    v_mfma_f32_16x16x32_bf16 v[196:199], v[36:39], v[72:75], v[196:199]
    buffer_load_dwordx4 v17, s[8:11], s54 offen offset:1024 lds
    v_mfma_f32_16x16x32_bf16 v[200:203], v[40:43], v[72:75], v[200:203]
    v_sin_f32 v239, v239
    v_mfma_f32_16x16x32_bf16 v[204:207], v[44:47], v[72:75], v[204:207]
    v_cos_f32 v224, v240
    v_mfma_f32_16x16x32_bf16 v[208:211], v[48:51], v[72:75], v[208:211]
    s_waitcnt vmcnt(10) lgkmcnt(0)
    s_barrier
    v_mfma_f32_16x16x32_bf16 v[116:119], v[92:95], v[76:79], v[116:119]
    s_lshl_b32 s53, s51, 7
    ds_read_b128 v[36:39], v22 offset:0
    v_lshl_add_u32 v6, v6, 1, v2
    v_mfma_f32_16x16x32_bf16 v[120:123], v[92:95], v[80:83], v[120:123]
    s_mul_i32 s54, s51, 393216
    ds_read_b128 v[40:43], v22 offset:2048
    v_cmp_eq_u32 vcc, 1, v6
    v_mfma_f32_16x16x32_bf16 v[124:127], v[92:95], v[84:87], v[124:127]
    s_add_u32 m0, s52, 0
    ds_read_b128 v[44:47], v22 offset:10240
    v_lshrrev_b32 v6, 1, v6
    v_mfma_f32_16x16x32_bf16 v[128:131], v[92:95], v[88:91], v[128:131]
    s_add_u32 s51, s51, 1
    ds_read_b128 v[48:51], v22 offset:12288
    v_cndmask_b32 v6, v6, 16, vcc
    v_mfma_f32_16x16x32_bf16 v[132:135], v[96:99], v[76:79], v[132:135]
    buffer_load_dwordx4 v8, s[4:7], s53 offen offset:0 lds
    v_mfma_f32_16x16x32_bf16 v[136:139], v[96:99], v[80:83], v[136:139]
    ds_read_b64_tr_b16 v[52:53], v24 offset:0
    ds_read_b64_tr_b16 v[54:55], v24 offset:512
    v_mfma_f32_16x16x32_bf16 v[140:143], v[96:99], v[84:87], v[140:143]
    ds_read_b64_tr_b16 v[56:57], v25 offset:0
    ds_read_b64_tr_b16 v[58:59], v25 offset:512
    v_mfma_f32_16x16x32_bf16 v[144:147], v[96:99], v[88:91], v[144:147]
    ds_read_b64_tr_b16 v[60:61], v24 offset:2048
    v_cndmask_b32 v7, v7, 0, vcc
    v_mfma_f32_16x16x32_bf16 v[148:151], v[100:103], v[76:79], v[148:151]
    buffer_load_dwordx4 v9, s[4:7], s53 offen offset:1024 lds
    v_mfma_f32_16x16x32_bf16 v[152:155], v[100:103], v[80:83], v[152:155]
    ds_read_b64_tr_b16 v[62:63], v24 offset:2560
    ds_read_b64_tr_b16 v[64:65], v25 offset:2048
    v_mfma_f32_16x16x32_bf16 v[156:159], v[100:103], v[84:87], v[156:159]
    ds_read_b64_tr_b16 v[66:67], v25 offset:2560
    v_cvt_f32_u32 v6, v6
    v_mfma_f32_16x16x32_bf16 v[160:163], v[100:103], v[88:91], v[160:163]
    ds_read_b64_tr_b16 v[68:69], v24 offset:4096
    v_mul_f32 v6, 0x3d000000, v6
    v_mfma_f32_16x16x32_bf16 v[164:167], v[104:107], v[76:79], v[164:167]
    buffer_load_dwordx4 v10, s[4:7], s53 offen offset:2048 lds
    v_mfma_f32_16x16x32_bf16 v[168:171], v[104:107], v[80:83], v[168:171]
    ds_read_b64_tr_b16 v[70:71], v24 offset:4608
    v_fma_f32 v7, v6, v33, v7
    v_mfma_f32_16x16x32_bf16 v[172:175], v[104:107], v[84:87], v[172:175]
    ds_read_b64_tr_b16 v[72:73], v25 offset:4096
    v_fmamk_f32 v244, v6, 0x00000000, v7
    v_mfma_f32_16x16x32_bf16 v[176:179], v[104:107], v[88:91], v[176:179]
    ds_read_b64_tr_b16 v[74:75], v25 offset:4608
    v_fmamk_f32 v245, v6, 0x3f800000, v7
    v_mfma_f32_16x16x32_bf16 v[180:183], v[76:79], v[108:111], v[180:183]
    buffer_load_dwordx4 v11, s[4:7], s53 offen offset:3072 lds
    v_mfma_f32_16x16x32_bf16 v[184:187], v[80:83], v[108:111], v[184:187]
    ds_read_b64_tr_b16 a[216:217], v32 offset:40960
    v_fmamk_f32 v246, v6, 0x40000000, v7
    v_mfma_f32_16x16x32_bf16 v[188:191], v[84:87], v[108:111], v[188:191]
    s_add_u32 m0, s52, 4096
    v_sin_f32 v240, v240
    v_mfma_f32_16x16x32_bf16 v[192:195], v[88:91], v[108:111], v[192:195]
    s_and_b32 s51, s51, 15
    v_cos_f32 v225, v241
    v_mfma_f32_16x16x32_bf16 v[196:199], v[76:79], v[112:115], v[196:199]
    buffer_load_dwordx4 v12, s[8:11], s54 offen offset:0 lds
    v_mfma_f32_16x16x32_bf16 v[200:203], v[80:83], v[112:115], v[200:203]
    v_sin_f32 v241, v241
    v_mfma_f32_16x16x32_bf16 v[204:207], v[84:87], v[112:115], v[204:207]
    v_cos_f32 v226, v242
    v_mfma_f32_16x16x32_bf16 v[208:211], v[88:91], v[112:115], v[208:211]
    s_waitcnt lgkmcnt(0)
    v_mfma_f32_16x16x32_bf16 v[116:119], v[52:55], v[36:39], v[116:119]
    ds_read_b128 v[76:79], v23 offset:0
    v_fmamk_f32 v247, v6, 0x40400000, v7
    v_mfma_f32_16x16x32_bf16 v[120:123], v[52:55], v[40:43], v[120:123]
    ds_read_b128 v[80:83], v23 offset:2048
    v_fmamk_f32 v248, v6, 0x41800000, v7
    v_mfma_f32_16x16x32_bf16 v[124:127], v[52:55], v[44:47], v[124:127]
    ds_read_b128 v[84:87], v23 offset:10240
    v_fmamk_f32 v249, v6, 0x41880000, v7
    v_mfma_f32_16x16x32_bf16 v[128:131], v[52:55], v[48:51], v[128:131]
    ds_read_b128 v[88:91], v23 offset:12288
    v_fmamk_f32 v250, v6, 0x41900000, v7
    v_mfma_f32_16x16x32_bf16 v[132:135], v[56:59], v[36:39], v[132:135]
    buffer_load_dwordx4 v13, s[8:11], s54 offen offset:1024 lds
    v_mfma_f32_16x16x32_bf16 v[136:139], v[56:59], v[40:43], v[136:139]
    ds_read_b64_tr_b16 v[92:93], v24 offset:20480
    ds_read_b64_tr_b16 v[94:95], v24 offset:20992
    v_mfma_f32_16x16x32_bf16 v[140:143], v[56:59], v[44:47], v[140:143]
    ds_read_b64_tr_b16 v[96:97], v25 offset:20480
    ds_read_b64_tr_b16 v[98:99], v25 offset:20992
    v_mfma_f32_16x16x32_bf16 v[144:147], v[56:59], v[48:51], v[144:147]
    ds_read_b64_tr_b16 v[100:101], v24 offset:22528
    v_fmamk_f32 v251, v6, 0x41980000, v7
    v_mfma_f32_16x16x32_bf16 v[148:151], v[60:63], v[36:39], v[148:151]
    buffer_load_dwordx4 v14, s[8:11], s54 offen offset:2048 lds
    v_mfma_f32_16x16x32_bf16 v[152:155], v[60:63], v[40:43], v[152:155]
    ds_read_b64_tr_b16 v[102:103], v24 offset:23040
    ds_read_b64_tr_b16 v[104:105], v25 offset:22528
    v_mfma_f32_16x16x32_bf16 v[156:159], v[60:63], v[44:47], v[156:159]
    ds_read_b64_tr_b16 v[106:107], v25 offset:23040
    v_bfe_i32 v6, v0, 3, 1
    v_mfma_f32_16x16x32_bf16 v[160:163], v[60:63], v[48:51], v[160:163]
    ds_read_b64_tr_b16 v[108:109], v24 offset:24576
    v_mov_b32 v35, s48
    v_mfma_f32_16x16x32_bf16 v[164:167], v[64:67], v[36:39], v[164:167]
    buffer_load_dwordx4 v15, s[8:11], s54 offen offset:3072 lds
    v_mfma_f32_16x16x32_bf16 v[168:171], v[64:67], v[40:43], v[168:171]
    ds_read_b64_tr_b16 v[110:111], v24 offset:25088
    v_lshl_add_u32 v34, v35, 9, v34
    v_mfma_f32_16x16x32_bf16 v[172:175], v[64:67], v[44:47], v[172:175]
    ds_read_b64_tr_b16 v[112:113], v25 offset:24576
    v_add_u32 v255, s75, v34
    v_mfma_f32_16x16x32_bf16 v[176:179], v[64:67], v[48:51], v[176:179]
    s_add_u32 m0, s52, 8192
    ds_read_b64_tr_b16 v[114:115], v25 offset:25088
    v_lshlrev_b32 v7, 3, v5
    v_mfma_f32_16x16x32_bf16 v[180:183], v[36:39], v[68:71], v[180:183]
    buffer_load_dwordx4 v16, s[8:11], s54 offen offset:0 lds
    v_mfma_f32_16x16x32_bf16 v[184:187], v[40:43], v[68:71], v[184:187]
    ds_read_b64_tr_b16 a[218:219], v32 offset:51200
    v_cvt_f32_u32 v7, v7
    v_mfma_f32_16x16x32_bf16 v[188:191], v[44:47], v[68:71], v[188:191]
    v_sin_f32 v242, v242
    v_mfma_f32_16x16x32_bf16 v[192:195], v[48:51], v[68:71], v[192:195]
    v_cos_f32 v227, v243
    v_mfma_f32_16x16x32_bf16 v[196:199], v[36:39], v[72:75], v[196:199]
    buffer_load_dwordx4 v17, s[8:11], s54 offen offset:1024 lds
    v_mfma_f32_16x16x32_bf16 v[200:203], v[40:43], v[72:75], v[200:203]
    v_sin_f32 v243, v243
    v_mfma_f32_16x16x32_bf16 v[204:207], v[44:47], v[72:75], v[204:207]
    v_cos_f32 v244, v244
    v_mfma_f32_16x16x32_bf16 v[208:211], v[48:51], v[72:75], v[208:211]
    s_waitcnt vmcnt(10) lgkmcnt(0)
    s_barrier
    v_mfma_f32_16x16x32_bf16 v[116:119], v[92:95], v[76:79], v[116:119]
    s_lshl_b32 s53, s51, 7
    ds_read_b128 v[36:39], v26 offset:0
    v_and_b32 v34, 3, v0
    v_mfma_f32_16x16x32_bf16 v[120:123], v[92:95], v[80:83], v[120:123]
    s_mul_i32 s54, s51, 393216
    ds_read_b128 v[40:43], v26 offset:2048
    v_min_u32 v34, 1, v34
    v_mfma_f32_16x16x32_bf16 v[124:127], v[92:95], v[84:87], v[124:127]
    s_add_u32 m0, s52, 40960
    ds_read_b128 v[44:47], v26 offset:10240
    v_add_u32 v34, -1, v34
    v_mfma_f32_16x16x32_bf16 v[128:131], v[92:95], v[88:91], v[128:131]
    s_add_u32 s51, s51, 1
    ds_read_b128 v[48:51], v26 offset:12288
    v_and_b32 v34, 0x3f803f80, v34
    v_mfma_f32_16x16x32_bf16 v[132:135], v[96:99], v[76:79], v[132:135]
    buffer_load_dwordx4 v8, s[4:7], s53 offen offset:0 lds
    v_mfma_f32_16x16x32_bf16 v[136:139], v[96:99], v[80:83], v[136:139]
    ds_read_b64_tr_b16 v[52:53], v28 offset:0
    ds_read_b64_tr_b16 v[54:55], v28 offset:512
    v_mfma_f32_16x16x32_bf16 v[140:143], v[96:99], v[84:87], v[140:143]
    ds_read_b64_tr_b16 v[56:57], v29 offset:0
    ds_read_b64_tr_b16 v[58:59], v29 offset:512
    v_mfma_f32_16x16x32_bf16 v[144:147], v[96:99], v[88:91], v[144:147]
    ds_read_b64_tr_b16 v[60:61], v28 offset:2048
    v_bfe_i32 v35, v0, 2, 1
    v_mfma_f32_16x16x32_bf16 v[148:151], v[100:103], v[76:79], v[148:151]
    buffer_load_dwordx4 v9, s[4:7], s53 offen offset:1024 lds
    v_mfma_f32_16x16x32_bf16 v[152:155], v[100:103], v[80:83], v[152:155]
    ds_read_b64_tr_b16 v[62:63], v28 offset:2560
    ds_read_b64_tr_b16 v[64:65], v29 offset:2048
    v_mfma_f32_16x16x32_bf16 v[156:159], v[100:103], v[84:87], v[156:159]
    ds_read_b64_tr_b16 v[66:67], v29 offset:2560
    v_and_b32 v35, v34, v35
    v_mfma_f32_16x16x32_bf16 v[160:163], v[100:103], v[88:91], v[160:163]
    ds_read_b64_tr_b16 v[68:69], v28 offset:4096
    v_xor_b32 v3, v34, v35
    v_mfma_f32_16x16x32_bf16 v[164:167], v[104:107], v[76:79], v[164:167]
    buffer_load_dwordx4 v10, s[4:7], s53 offen offset:2048 lds
    v_mfma_f32_16x16x32_bf16 v[168:171], v[104:107], v[80:83], v[168:171]
    ds_read_b64_tr_b16 v[70:71], v28 offset:4608
    v_accvgpr_write_b32 a144, v3
    v_mfma_f32_16x16x32_bf16 v[172:175], v[104:107], v[84:87], v[172:175]
    ds_read_b64_tr_b16 v[72:73], v29 offset:4096
    v_accvgpr_write_b32 a145, v3
    v_mfma_f32_16x16x32_bf16 v[176:179], v[104:107], v[88:91], v[176:179]
    ds_read_b64_tr_b16 v[74:75], v29 offset:4608
    v_accvgpr_write_b32 a146, v35
    v_mfma_f32_16x16x32_bf16 v[180:183], v[76:79], v[108:111], v[180:183]
    buffer_load_dwordx4 v11, s[4:7], s53 offen offset:3072 lds
    v_mfma_f32_16x16x32_bf16 v[184:187], v[80:83], v[108:111], v[184:187]
    ds_read_b64_tr_b16 a[220:221], v254 offset:0
    v_accvgpr_write_b32 a147, v35
    v_mfma_f32_16x16x32_bf16 v[188:191], v[84:87], v[108:111], v[188:191]
    s_add_u32 m0, s52, 45056
    v_cos_f32 v245, v245
    v_mfma_f32_16x16x32_bf16 v[192:195], v[88:91], v[108:111], v[192:195]
    s_and_b32 s51, s51, 15
    v_cos_f32 v246, v246
    v_mfma_f32_16x16x32_bf16 v[196:199], v[76:79], v[112:115], v[196:199]
    buffer_load_dwordx4 v12, s[8:11], s54 offen offset:0 lds
    v_mfma_f32_16x16x32_bf16 v[200:203], v[80:83], v[112:115], v[200:203]
    v_cos_f32 v247, v247
    v_mfma_f32_16x16x32_bf16 v[204:207], v[84:87], v[112:115], v[204:207]
    v_cos_f32 v248, v248
    v_mfma_f32_16x16x32_bf16 v[208:211], v[88:91], v[112:115], v[208:211]
    s_waitcnt lgkmcnt(0)
    v_mfma_f32_16x16x32_bf16 v[116:119], v[52:55], v[36:39], v[116:119]
    ds_read_b128 v[76:79], v27 offset:0
    v_cvt_pk_bf16_f32 v244, v244, v245
    v_mfma_f32_16x16x32_bf16 v[120:123], v[52:55], v[40:43], v[120:123]
    ds_read_b128 v[80:83], v27 offset:2048
    v_cvt_pk_bf16_f32 v245, v246, v247
    v_mfma_f32_16x16x32_bf16 v[124:127], v[52:55], v[44:47], v[124:127]
    ds_read_b128 v[84:87], v27 offset:10240
    v_mov_b32 v34, 0xbf00bf00
    v_mfma_f32_16x16x32_bf16 v[128:131], v[52:55], v[48:51], v[128:131]
    ds_read_b128 v[88:91], v27 offset:12288
    v_accvgpr_write_b32 a148, v34
    v_mfma_f32_16x16x32_bf16 v[132:135], v[56:59], v[36:39], v[132:135]
    buffer_load_dwordx4 v13, s[8:11], s54 offen offset:1024 lds
    v_mfma_f32_16x16x32_bf16 v[136:139], v[56:59], v[40:43], v[136:139]
    ds_read_b64_tr_b16 v[92:93], v28 offset:20480
    ds_read_b64_tr_b16 v[94:95], v28 offset:20992
    v_mfma_f32_16x16x32_bf16 v[140:143], v[56:59], v[44:47], v[140:143]
    ds_read_b64_tr_b16 v[96:97], v29 offset:20480
    ds_read_b64_tr_b16 v[98:99], v29 offset:20992
    v_mfma_f32_16x16x32_bf16 v[144:147], v[56:59], v[48:51], v[144:147]
    ds_read_b64_tr_b16 v[100:101], v28 offset:22528
    v_mov_b32 v34, s1
    v_mfma_f32_16x16x32_bf16 v[148:151], v[60:63], v[36:39], v[148:151]
    buffer_load_dwordx4 v14, s[8:11], s54 offen offset:2048 lds
    v_mfma_f32_16x16x32_bf16 v[152:155], v[60:63], v[40:43], v[152:155]
    ds_read_b64_tr_b16 v[102:103], v28 offset:23040
    ds_read_b64_tr_b16 v[104:105], v29 offset:22528
    v_mfma_f32_16x16x32_bf16 v[156:159], v[60:63], v[44:47], v[156:159]
    ds_read_b64_tr_b16 v[106:107], v29 offset:23040
    v_and_b32 v34, 4, v34
    v_mfma_f32_16x16x32_bf16 v[160:163], v[60:63], v[48:51], v[160:163]
    ds_read_b64_tr_b16 v[108:109], v28 offset:24576
    v_xor_b32 v34, v34, v0
    v_mfma_f32_16x16x32_bf16 v[164:167], v[64:67], v[36:39], v[164:167]
    buffer_load_dwordx4 v15, s[8:11], s54 offen offset:3072 lds
    v_mfma_f32_16x16x32_bf16 v[168:171], v[64:67], v[40:43], v[168:171]
    ds_read_b64_tr_b16 v[110:111], v28 offset:25088
    v_lshlrev_b32 v34, 2, v34
    v_mfma_f32_16x16x32_bf16 v[172:175], v[64:67], v[44:47], v[172:175]
    ds_read_b64_tr_b16 v[112:113], v29 offset:24576
    v_lshl_add_u32 v34, v5, 20, v34
    v_mfma_f32_16x16x32_bf16 v[176:179], v[64:67], v[48:51], v[176:179]
L_pg1:
    s_cbranch_execz L_pg5
    s_add_u32 m0, s52, 49152
    ds_read_b64_tr_b16 v[114:115], v29 offset:25088
    v_accvgpr_write_b32 a96, v34
    v_mfma_f32_16x16x32_bf16 v[180:183], v[36:39], v[68:71], v[180:183]
    buffer_load_dwordx4 v16, s[8:11], s54 offen offset:0 lds
    v_mfma_f32_16x16x32_bf16 v[184:187], v[40:43], v[68:71], v[184:187]
    ds_read_b64_tr_b16 a[222:223], v254 offset:10240
    v_lshlrev_b32 v35, 1, v5
    v_mfma_f32_16x16x32_bf16 v[188:191], v[44:47], v[68:71], v[188:191]
    v_cos_f32 v249, v249
    v_mfma_f32_16x16x32_bf16 v[192:195], v[48:51], v[68:71], v[192:195]
    v_cos_f32 v250, v250
    v_mfma_f32_16x16x32_bf16 v[196:199], v[36:39], v[72:75], v[196:199]
    buffer_load_dwordx4 v17, s[8:11], s54 offen offset:1024 lds
    v_mfma_f32_16x16x32_bf16 v[200:203], v[40:43], v[72:75], v[200:203]
    v_cos_f32 v251, v251
    v_mfma_f32_16x16x32_bf16 v[204:207], v[44:47], v[72:75], v[204:207]
    v_cvt_pk_bf16_f32 v246, v248, v249
    v_cvt_pk_bf16_f32 v247, v250, v251
    v_mfma_f32_16x16x32_bf16 v[208:211], v[48:51], v[72:75], v[208:211]
    s_waitcnt vmcnt(10) lgkmcnt(0)
    s_barrier
    v_mfma_f32_16x16x32_bf16 v[116:119], v[92:95], v[76:79], v[116:119]
    s_lshl_b32 s53, s51, 7
    ds_read_b128 v[36:39], v18 offset:0
    v_and_b32 v248, v6, v244
    v_mfma_f32_16x16x32_bf16 v[120:123], v[92:95], v[80:83], v[120:123]
    s_mul_i32 s54, s51, 393216
    ds_read_b128 v[40:43], v18 offset:2048
    v_and_b32 v249, v6, v245
    v_mfma_f32_16x16x32_bf16 v[124:127], v[92:95], v[84:87], v[124:127]
    s_add_u32 m0, s52, 81920
    ds_read_b128 v[44:47], v18 offset:10240
    v_and_b32 v250, v6, v246
    v_mfma_f32_16x16x32_bf16 v[128:131], v[92:95], v[88:91], v[128:131]
    s_add_u32 s51, s51, 1
    ds_read_b128 v[48:51], v18 offset:12288
    v_and_b32 v251, v6, v247
    v_mfma_f32_16x16x32_bf16 v[132:135], v[96:99], v[76:79], v[132:135]
    buffer_load_dwordx4 v8, s[4:7], s53 offen offset:0 lds
    v_mfma_f32_16x16x32_bf16 v[136:139], v[96:99], v[80:83], v[136:139]
    ds_read_b64_tr_b16 v[52:53], v20 offset:0
    ds_read_b64_tr_b16 v[54:55], v20 offset:512
    v_mfma_f32_16x16x32_bf16 v[140:143], v[96:99], v[84:87], v[140:143]
    ds_read_b64_tr_b16 v[56:57], v21 offset:0
    ds_read_b64_tr_b16 v[58:59], v21 offset:512
    v_mfma_f32_16x16x32_bf16 v[144:147], v[96:99], v[88:91], v[144:147]
    ds_read_b64_tr_b16 v[60:61], v20 offset:2048
    v_xor_b32 v244, v244, v248
    v_mfma_f32_16x16x32_bf16 v[148:151], v[100:103], v[76:79], v[148:151]
    buffer_load_dwordx4 v9, s[4:7], s53 offen offset:1024 lds
    v_mfma_f32_16x16x32_bf16 v[152:155], v[100:103], v[80:83], v[152:155]
    ds_read_b64_tr_b16 v[62:63], v20 offset:2560
    ds_read_b64_tr_b16 v[64:65], v21 offset:2048
    v_mfma_f32_16x16x32_bf16 v[156:159], v[100:103], v[84:87], v[156:159]
    ds_read_b64_tr_b16 v[66:67], v21 offset:2560
    v_xor_b32 v245, v245, v249
    v_mfma_f32_16x16x32_bf16 v[160:163], v[100:103], v[88:91], v[160:163]
    ds_read_b64_tr_b16 v[68:69], v20 offset:4096
    v_xor_b32 v246, v246, v250
    v_mfma_f32_16x16x32_bf16 v[164:167], v[104:107], v[76:79], v[164:167]
    buffer_load_dwordx4 v10, s[4:7], s53 offen offset:2048 lds
    v_mfma_f32_16x16x32_bf16 v[168:171], v[104:107], v[80:83], v[168:171]
    ds_read_b64_tr_b16 v[70:71], v20 offset:4608
    v_xor_b32 v247, v247, v251
    v_mfma_f32_16x16x32_bf16 v[172:175], v[104:107], v[84:87], v[172:175]
    ds_read_b64_tr_b16 v[72:73], v21 offset:4096
    v_accvgpr_write_b32 a0, v244
    v_mfma_f32_16x16x32_bf16 v[176:179], v[104:107], v[88:91], v[176:179]
    ds_read_b64_tr_b16 v[74:75], v21 offset:4608
    v_accvgpr_write_b32 a1, v245
    v_mfma_f32_16x16x32_bf16 v[180:183], v[76:79], v[108:111], v[180:183]
    buffer_load_dwordx4 v11, s[4:7], s53 offen offset:3072 lds
    v_mfma_f32_16x16x32_bf16 v[184:187], v[80:83], v[108:111], v[184:187]
    ds_read_b64_tr_b16 a[224:225], v32 offset:0
    v_accvgpr_write_b32 a2, v246
    v_mfma_f32_16x16x32_bf16 v[188:191], v[84:87], v[108:111], v[188:191]
    s_add_u32 m0, s52, 86016
    v_accvgpr_write_b32 a3, v247
    v_accvgpr_write_b32 a4, v248
    v_mfma_f32_16x16x32_bf16 v[192:195], v[88:91], v[108:111], v[192:195]
    s_and_b32 s51, s51, 15
    v_accvgpr_write_b32 a5, v249
    v_accvgpr_write_b32 a6, v250
    v_mfma_f32_16x16x32_bf16 v[196:199], v[76:79], v[112:115], v[196:199]
    buffer_load_dwordx4 v12, s[8:11], s54 offen offset:0 lds
    v_mfma_f32_16x16x32_bf16 v[200:203], v[80:83], v[112:115], v[200:203]
    v_accvgpr_write_b32 a7, v251
    v_cvt_f32_u32 v6, v255
    v_mfma_f32_16x16x32_bf16 v[204:207], v[84:87], v[112:115], v[204:207]
    v_mul_f32 v6, 0x3a000000, v6
    v_mul_f32 v33, v6, v7
    v_mfma_f32_16x16x32_bf16 v[208:211], v[88:91], v[112:115], v[208:211]
    s_waitcnt lgkmcnt(0)
    v_mfma_f32_16x16x32_bf16 v[116:119], v[52:55], v[36:39], v[116:119]
    ds_read_b128 v[76:79], v19 offset:0
    v_fmamk_f32 v244, v6, 0x00000000, v33
    v_mfma_f32_16x16x32_bf16 v[120:123], v[52:55], v[40:43], v[120:123]
    ds_read_b128 v[80:83], v19 offset:2048
    v_fmamk_f32 v245, v6, 0x3f800000, v33
    v_mfma_f32_16x16x32_bf16 v[124:127], v[52:55], v[44:47], v[124:127]
    ds_read_b128 v[84:87], v19 offset:10240
    v_fmamk_f32 v246, v6, 0x40000000, v33
    v_mfma_f32_16x16x32_bf16 v[128:131], v[52:55], v[48:51], v[128:131]
    ds_read_b128 v[88:91], v19 offset:12288
    v_fmamk_f32 v247, v6, 0x40400000, v33
    v_mfma_f32_16x16x32_bf16 v[132:135], v[56:59], v[36:39], v[132:135]
    buffer_load_dwordx4 v13, s[8:11], s54 offen offset:1024 lds
    v_mfma_f32_16x16x32_bf16 v[136:139], v[56:59], v[40:43], v[136:139]
    ds_read_b64_tr_b16 v[92:93], v20 offset:20480
    ds_read_b64_tr_b16 v[94:95], v20 offset:20992
    v_mfma_f32_16x16x32_bf16 v[140:143], v[56:59], v[44:47], v[140:143]
    ds_read_b64_tr_b16 v[96:97], v21 offset:20480
    ds_read_b64_tr_b16 v[98:99], v21 offset:20992
    v_mfma_f32_16x16x32_bf16 v[144:147], v[56:59], v[48:51], v[144:147]
    ds_read_b64_tr_b16 v[100:101], v20 offset:22528
    v_xor_b32 v35, v2, v35
    v_mfma_f32_16x16x32_bf16 v[148:151], v[60:63], v[36:39], v[148:151]
    buffer_load_dwordx4 v14, s[8:11], s54 offen offset:2048 lds
    v_mfma_f32_16x16x32_bf16 v[152:155], v[60:63], v[40:43], v[152:155]
    ds_read_b64_tr_b16 v[102:103], v20 offset:23040
    ds_read_b64_tr_b16 v[104:105], v21 offset:22528
    v_mfma_f32_16x16x32_bf16 v[156:159], v[60:63], v[44:47], v[156:159]
    ds_read_b64_tr_b16 v[106:107], v21 offset:23040
    v_lshlrev_b32 v35, 4, v35
    v_mfma_f32_16x16x32_bf16 v[160:163], v[60:63], v[48:51], v[160:163]
    ds_read_b64_tr_b16 v[108:109], v20 offset:24576
    v_lshl_add_u32 v35, v1, 11, v35
    v_mfma_f32_16x16x32_bf16 v[164:167], v[64:67], v[36:39], v[164:167]
    buffer_load_dwordx4 v15, s[8:11], s54 offen offset:3072 lds
    v_mfma_f32_16x16x32_bf16 v[168:171], v[64:67], v[40:43], v[168:171]
    ds_read_b64_tr_b16 v[110:111], v20 offset:25088
    v_add_u32 v35, s95, v35
    v_mfma_f32_16x16x32_bf16 v[172:175], v[64:67], v[44:47], v[172:175]
    ds_read_b64_tr_b16 v[112:113], v21 offset:24576
    v_accvgpr_write_b32 a97, v35
    v_mfma_f32_16x16x32_bf16 v[176:179], v[64:67], v[48:51], v[176:179]
    s_add_u32 m0, s52, 90112
    ds_read_b64_tr_b16 v[114:115], v21 offset:25088
    v_add_u32 v34, 15360, v35
    v_mfma_f32_16x16x32_bf16 v[180:183], v[36:39], v[68:71], v[180:183]
    buffer_load_dwordx4 v16, s[8:11], s54 offen offset:0 lds
    v_mfma_f32_16x16x32_bf16 v[184:187], v[40:43], v[68:71], v[184:187]
    ds_read_b64_tr_b16 a[226:227], v32 offset:10240
    v_accvgpr_write_b32 a98, v34
    v_mfma_f32_16x16x32_bf16 v[188:191], v[44:47], v[68:71], v[188:191]
    v_cos_f32 v248, v244
    v_mfma_f32_16x16x32_bf16 v[192:195], v[48:51], v[68:71], v[192:195]
    v_sin_f32 v244, v244
    v_mfma_f32_16x16x32_bf16 v[196:199], v[36:39], v[72:75], v[196:199]
    buffer_load_dwordx4 v17, s[8:11], s54 offen offset:1024 lds
    v_mfma_f32_16x16x32_bf16 v[200:203], v[40:43], v[72:75], v[200:203]
    v_cos_f32 v249, v245
    v_mfma_f32_16x16x32_bf16 v[204:207], v[44:47], v[72:75], v[204:207]
    v_sin_f32 v245, v245
    v_mfma_f32_16x16x32_bf16 v[208:211], v[48:51], v[72:75], v[208:211]
    s_waitcnt vmcnt(10) lgkmcnt(0)
    s_barrier
    v_mfma_f32_16x16x32_bf16 v[116:119], v[92:95], v[76:79], v[116:119]
    s_lshl_b32 s53, s51, 7
    ds_read_b128 v[36:39], v22 offset:0
    v_cvt_pk_bf16_f32 v7, v248, v249
    v_mfma_f32_16x16x32_bf16 v[120:123], v[92:95], v[80:83], v[120:123]
    s_mul_i32 s54, s51, 393216
    ds_read_b128 v[40:43], v22 offset:2048
    v_accvgpr_write_b32 a160, v7
    v_mfma_f32_16x16x32_bf16 v[124:127], v[92:95], v[84:87], v[124:127]
    s_add_u32 m0, s52, 0
    ds_read_b128 v[44:47], v22 offset:10240
    v_cvt_pk_bf16_f32 v7, -v244, -v245
    v_mfma_f32_16x16x32_bf16 v[128:131], v[92:95], v[88:91], v[128:131]
    s_add_u32 s51, s51, 1
    ds_read_b128 v[48:51], v22 offset:12288
    v_accvgpr_write_b32 a168, v7
    v_mfma_f32_16x16x32_bf16 v[132:135], v[96:99], v[76:79], v[132:135]
    buffer_load_dwordx4 v8, s[4:7], s53 offen offset:0 lds
    v_mfma_f32_16x16x32_bf16 v[136:139], v[96:99], v[80:83], v[136:139]
    ds_read_b64_tr_b16 v[52:53], v24 offset:0
    ds_read_b64_tr_b16 v[54:55], v24 offset:512
    v_mfma_f32_16x16x32_bf16 v[140:143], v[96:99], v[84:87], v[140:143]
    ds_read_b64_tr_b16 v[56:57], v25 offset:0
    ds_read_b64_tr_b16 v[58:59], v25 offset:512
    v_mfma_f32_16x16x32_bf16 v[144:147], v[96:99], v[88:91], v[144:147]
    ds_read_b64_tr_b16 v[60:61], v24 offset:2048
    v_cvt_pk_bf16_f32 v7, v248, -v249
    v_mfma_f32_16x16x32_bf16 v[148:151], v[100:103], v[76:79], v[148:151]
    buffer_load_dwordx4 v9, s[4:7], s53 offen offset:1024 lds
    v_mfma_f32_16x16x32_bf16 v[152:155], v[100:103], v[80:83], v[152:155]
    ds_read_b64_tr_b16 v[62:63], v24 offset:2560
    ds_read_b64_tr_b16 v[64:65], v25 offset:2048
    v_mfma_f32_16x16x32_bf16 v[156:159], v[100:103], v[84:87], v[156:159]
    ds_read_b64_tr_b16 v[66:67], v25 offset:2560
    v_accvgpr_write_b32 a176, v7
    v_mfma_f32_16x16x32_bf16 v[160:163], v[100:103], v[88:91], v[160:163]
    ds_read_b64_tr_b16 v[68:69], v24 offset:4096
    v_cvt_pk_bf16_f32 v7, -v244, v245
    v_mfma_f32_16x16x32_bf16 v[164:167], v[104:107], v[76:79], v[164:167]
    buffer_load_dwordx4 v10, s[4:7], s53 offen offset:2048 lds
    v_mfma_f32_16x16x32_bf16 v[168:171], v[104:107], v[80:83], v[168:171]
    ds_read_b64_tr_b16 v[70:71], v24 offset:4608
    v_accvgpr_write_b32 a184, v7
    v_mfma_f32_16x16x32_bf16 v[172:175], v[104:107], v[84:87], v[172:175]
    ds_read_b64_tr_b16 v[72:73], v25 offset:4096
    v_fmamk_f32 v244, v6, 0x40800000, v33
    v_mfma_f32_16x16x32_bf16 v[176:179], v[104:107], v[88:91], v[176:179]
    ds_read_b64_tr_b16 v[74:75], v25 offset:4608
    v_fmamk_f32 v245, v6, 0x40a00000, v33
    v_mfma_f32_16x16x32_bf16 v[180:183], v[76:79], v[108:111], v[180:183]
    buffer_load_dwordx4 v11, s[4:7], s53 offen offset:3072 lds
    v_mfma_f32_16x16x32_bf16 v[184:187], v[80:83], v[108:111], v[184:187]
    ds_read_b64_tr_b16 a[228:229], v32 offset:40960
    v_add_u32 v34, 30720, v35
    v_mfma_f32_16x16x32_bf16 v[188:191], v[84:87], v[108:111], v[188:191]
    s_add_u32 m0, s52, 4096
    v_cos_f32 v250, v246
    v_mfma_f32_16x16x32_bf16 v[192:195], v[88:91], v[108:111], v[192:195]
    s_and_b32 s51, s51, 15
    v_sin_f32 v246, v246
    v_mfma_f32_16x16x32_bf16 v[196:199], v[76:79], v[112:115], v[196:199]
    buffer_load_dwordx4 v12, s[8:11], s54 offen offset:0 lds
    v_mfma_f32_16x16x32_bf16 v[200:203], v[80:83], v[112:115], v[200:203]
    v_cos_f32 v251, v247
    v_mfma_f32_16x16x32_bf16 v[204:207], v[84:87], v[112:115], v[204:207]
    v_sin_f32 v247, v247
    v_mfma_f32_16x16x32_bf16 v[208:211], v[88:91], v[112:115], v[208:211]
    s_waitcnt lgkmcnt(0)
    v_mfma_f32_16x16x32_bf16 v[116:119], v[52:55], v[36:39], v[116:119]
    ds_read_b128 v[76:79], v23 offset:0
    v_cvt_pk_bf16_f32 v7, v250, v251
    v_mfma_f32_16x16x32_bf16 v[120:123], v[52:55], v[40:43], v[120:123]
    ds_read_b128 v[80:83], v23 offset:2048
    v_accvgpr_write_b32 a161, v7
    v_mfma_f32_16x16x32_bf16 v[124:127], v[52:55], v[44:47], v[124:127]
    ds_read_b128 v[84:87], v23 offset:10240
    v_cvt_pk_bf16_f32 v7, -v246, -v247
    v_mfma_f32_16x16x32_bf16 v[128:131], v[52:55], v[48:51], v[128:131]
    ds_read_b128 v[88:91], v23 offset:12288
    v_accvgpr_write_b32 a169, v7
    v_mfma_f32_16x16x32_bf16 v[132:135], v[56:59], v[36:39], v[132:135]
    buffer_load_dwordx4 v13, s[8:11], s54 offen offset:1024 lds
    v_mfma_f32_16x16x32_bf16 v[136:139], v[56:59], v[40:43], v[136:139]
    ds_read_b64_tr_b16 v[92:93], v24 offset:20480
    ds_read_b64_tr_b16 v[94:95], v24 offset:20992
    v_mfma_f32_16x16x32_bf16 v[140:143], v[56:59], v[44:47], v[140:143]
    ds_read_b64_tr_b16 v[96:97], v25 offset:20480
    ds_read_b64_tr_b16 v[98:99], v25 offset:20992
    v_mfma_f32_16x16x32_bf16 v[144:147], v[56:59], v[48:51], v[144:147]
    ds_read_b64_tr_b16 v[100:101], v24 offset:22528
    v_cvt_pk_bf16_f32 v7, v250, -v251
    v_mfma_f32_16x16x32_bf16 v[148:151], v[60:63], v[36:39], v[148:151]
    buffer_load_dwordx4 v14, s[8:11], s54 offen offset:2048 lds
    v_mfma_f32_16x16x32_bf16 v[152:155], v[60:63], v[40:43], v[152:155]
    ds_read_b64_tr_b16 v[102:103], v24 offset:23040
    ds_read_b64_tr_b16 v[104:105], v25 offset:22528
    v_mfma_f32_16x16x32_bf16 v[156:159], v[60:63], v[44:47], v[156:159]
    ds_read_b64_tr_b16 v[106:107], v25 offset:23040
    v_accvgpr_write_b32 a177, v7
    v_mfma_f32_16x16x32_bf16 v[160:163], v[60:63], v[48:51], v[160:163]
    ds_read_b64_tr_b16 v[108:109], v24 offset:24576
    v_cvt_pk_bf16_f32 v7, -v246, v247
    v_mfma_f32_16x16x32_bf16 v[164:167], v[64:67], v[36:39], v[164:167]
    buffer_load_dwordx4 v15, s[8:11], s54 offen offset:3072 lds
    v_mfma_f32_16x16x32_bf16 v[168:171], v[64:67], v[40:43], v[168:171]
    ds_read_b64_tr_b16 v[110:111], v24 offset:25088
    v_accvgpr_write_b32 a185, v7
    v_mfma_f32_16x16x32_bf16 v[172:175], v[64:67], v[44:47], v[172:175]
    ds_read_b64_tr_b16 v[112:113], v25 offset:24576
    v_fmamk_f32 v246, v6, 0x40c00000, v33
    v_mfma_f32_16x16x32_bf16 v[176:179], v[64:67], v[48:51], v[176:179]
    s_add_u32 m0, s52, 8192
    ds_read_b64_tr_b16 v[114:115], v25 offset:25088
    v_fmamk_f32 v247, v6, 0x40e00000, v33
    v_mfma_f32_16x16x32_bf16 v[180:183], v[36:39], v[68:71], v[180:183]
    buffer_load_dwordx4 v16, s[8:11], s54 offen offset:0 lds
    v_mfma_f32_16x16x32_bf16 v[184:187], v[40:43], v[68:71], v[184:187]
    ds_read_b64_tr_b16 a[230:231], v32 offset:51200
    v_accvgpr_write_b32 a99, v34
    v_mfma_f32_16x16x32_bf16 v[188:191], v[44:47], v[68:71], v[188:191]
    v_cos_f32 v248, v244
    v_mfma_f32_16x16x32_bf16 v[192:195], v[48:51], v[68:71], v[192:195]
    v_sin_f32 v244, v244
    v_mfma_f32_16x16x32_bf16 v[196:199], v[36:39], v[72:75], v[196:199]
    buffer_load_dwordx4 v17, s[8:11], s54 offen offset:1024 lds
    v_mfma_f32_16x16x32_bf16 v[200:203], v[40:43], v[72:75], v[200:203]
    v_cos_f32 v249, v245
    v_mfma_f32_16x16x32_bf16 v[204:207], v[44:47], v[72:75], v[204:207]
    v_sin_f32 v245, v245
    v_mfma_f32_16x16x32_bf16 v[208:211], v[48:51], v[72:75], v[208:211]
    s_waitcnt vmcnt(10) lgkmcnt(0)
    s_barrier
    v_mfma_f32_16x16x32_bf16 v[116:119], v[92:95], v[76:79], v[116:119]
    s_lshl_b32 s53, s51, 7
    ds_read_b128 v[36:39], v26 offset:0
    v_cvt_pk_bf16_f32 v7, v248, v249
    v_mfma_f32_16x16x32_bf16 v[120:123], v[92:95], v[80:83], v[120:123]
    s_mul_i32 s54, s51, 393216
    ds_read_b128 v[40:43], v26 offset:2048
    v_accvgpr_write_b32 a162, v7
    v_mfma_f32_16x16x32_bf16 v[124:127], v[92:95], v[84:87], v[124:127]
    s_add_u32 m0, s52, 40960
    ds_read_b128 v[44:47], v26 offset:10240
    v_cvt_pk_bf16_f32 v7, -v244, -v245
    v_mfma_f32_16x16x32_bf16 v[128:131], v[92:95], v[88:91], v[128:131]
    s_add_u32 s51, s51, 1
    ds_read_b128 v[48:51], v26 offset:12288
    v_accvgpr_write_b32 a170, v7
    v_mfma_f32_16x16x32_bf16 v[132:135], v[96:99], v[76:79], v[132:135]
    buffer_load_dwordx4 v8, s[4:7], s53 offen offset:0 lds
    v_mfma_f32_16x16x32_bf16 v[136:139], v[96:99], v[80:83], v[136:139]
    ds_read_b64_tr_b16 v[52:53], v28 offset:0
    ds_read_b64_tr_b16 v[54:55], v28 offset:512
    v_mfma_f32_16x16x32_bf16 v[140:143], v[96:99], v[84:87], v[140:143]
    ds_read_b64_tr_b16 v[56:57], v29 offset:0
    ds_read_b64_tr_b16 v[58:59], v29 offset:512
    v_mfma_f32_16x16x32_bf16 v[144:147], v[96:99], v[88:91], v[144:147]
    ds_read_b64_tr_b16 v[60:61], v28 offset:2048
    v_cvt_pk_bf16_f32 v7, v248, -v249
    v_mfma_f32_16x16x32_bf16 v[148:151], v[100:103], v[76:79], v[148:151]
    buffer_load_dwordx4 v9, s[4:7], s53 offen offset:1024 lds
    v_mfma_f32_16x16x32_bf16 v[152:155], v[100:103], v[80:83], v[152:155]
    ds_read_b64_tr_b16 v[62:63], v28 offset:2560
    ds_read_b64_tr_b16 v[64:65], v29 offset:2048
    v_mfma_f32_16x16x32_bf16 v[156:159], v[100:103], v[84:87], v[156:159]
    ds_read_b64_tr_b16 v[66:67], v29 offset:2560
    v_accvgpr_write_b32 a178, v7
    v_mfma_f32_16x16x32_bf16 v[160:163], v[100:103], v[88:91], v[160:163]
    ds_read_b64_tr_b16 v[68:69], v28 offset:4096
    v_cvt_pk_bf16_f32 v7, -v244, v245
    v_mfma_f32_16x16x32_bf16 v[164:167], v[104:107], v[76:79], v[164:167]
    buffer_load_dwordx4 v10, s[4:7], s53 offen offset:2048 lds
    v_mfma_f32_16x16x32_bf16 v[168:171], v[104:107], v[80:83], v[168:171]
    ds_read_b64_tr_b16 v[70:71], v28 offset:4608
    v_accvgpr_write_b32 a186, v7
    v_mfma_f32_16x16x32_bf16 v[172:175], v[104:107], v[84:87], v[172:175]
    ds_read_b64_tr_b16 v[72:73], v29 offset:4096
    v_fmamk_f32 v244, v6, 0x42000000, v33
    v_mfma_f32_16x16x32_bf16 v[176:179], v[104:107], v[88:91], v[176:179]
    ds_read_b64_tr_b16 v[74:75], v29 offset:4608
    v_fmamk_f32 v245, v6, 0x42040000, v33
    v_mfma_f32_16x16x32_bf16 v[180:183], v[76:79], v[108:111], v[180:183]
    buffer_load_dwordx4 v11, s[4:7], s53 offen offset:3072 lds
    v_mfma_f32_16x16x32_bf16 v[184:187], v[80:83], v[108:111], v[184:187]
    ds_read_b64_tr_b16 a[232:233], v254 offset:0
    v_add_u32 v34, 46080, v35
    v_mfma_f32_16x16x32_bf16 v[188:191], v[84:87], v[108:111], v[188:191]
    s_add_u32 m0, s52, 45056
    v_cos_f32 v250, v246
    v_mfma_f32_16x16x32_bf16 v[192:195], v[88:91], v[108:111], v[192:195]
    s_and_b32 s51, s51, 15
    v_sin_f32 v246, v246
    v_mfma_f32_16x16x32_bf16 v[196:199], v[76:79], v[112:115], v[196:199]
    buffer_load_dwordx4 v12, s[8:11], s54 offen offset:0 lds
    v_mfma_f32_16x16x32_bf16 v[200:203], v[80:83], v[112:115], v[200:203]
    v_cos_f32 v251, v247
    v_mfma_f32_16x16x32_bf16 v[204:207], v[84:87], v[112:115], v[204:207]
    v_sin_f32 v247, v247
    v_mfma_f32_16x16x32_bf16 v[208:211], v[88:91], v[112:115], v[208:211]
    s_waitcnt lgkmcnt(0)
    v_mfma_f32_16x16x32_bf16 v[116:119], v[52:55], v[36:39], v[116:119]
    ds_read_b128 v[76:79], v27 offset:0
    v_cvt_pk_bf16_f32 v7, v250, v251
    v_mfma_f32_16x16x32_bf16 v[120:123], v[52:55], v[40:43], v[120:123]
    ds_read_b128 v[80:83], v27 offset:2048
    v_accvgpr_write_b32 a163, v7
    v_mfma_f32_16x16x32_bf16 v[124:127], v[52:55], v[44:47], v[124:127]
    ds_read_b128 v[84:87], v27 offset:10240
    v_cvt_pk_bf16_f32 v7, -v246, -v247
    v_mfma_f32_16x16x32_bf16 v[128:131], v[52:55], v[48:51], v[128:131]
    ds_read_b128 v[88:91], v27 offset:12288
    v_accvgpr_write_b32 a171, v7
    v_mfma_f32_16x16x32_bf16 v[132:135], v[56:59], v[36:39], v[132:135]
    buffer_load_dwordx4 v13, s[8:11], s54 offen offset:1024 lds
    v_mfma_f32_16x16x32_bf16 v[136:139], v[56:59], v[40:43], v[136:139]
    ds_read_b64_tr_b16 v[92:93], v28 offset:20480
    ds_read_b64_tr_b16 v[94:95], v28 offset:20992
    v_mfma_f32_16x16x32_bf16 v[140:143], v[56:59], v[44:47], v[140:143]
    ds_read_b64_tr_b16 v[96:97], v29 offset:20480
    ds_read_b64_tr_b16 v[98:99], v29 offset:20992
    v_mfma_f32_16x16x32_bf16 v[144:147], v[56:59], v[48:51], v[144:147]
    ds_read_b64_tr_b16 v[100:101], v28 offset:22528
    v_cvt_pk_bf16_f32 v7, v250, -v251
    v_mfma_f32_16x16x32_bf16 v[148:151], v[60:63], v[36:39], v[148:151]
    buffer_load_dwordx4 v14, s[8:11], s54 offen offset:2048 lds
    v_mfma_f32_16x16x32_bf16 v[152:155], v[60:63], v[40:43], v[152:155]
    ds_read_b64_tr_b16 v[102:103], v28 offset:23040
    ds_read_b64_tr_b16 v[104:105], v29 offset:22528
    v_mfma_f32_16x16x32_bf16 v[156:159], v[60:63], v[44:47], v[156:159]
    ds_read_b64_tr_b16 v[106:107], v29 offset:23040
    v_accvgpr_write_b32 a179, v7
    v_mfma_f32_16x16x32_bf16 v[160:163], v[60:63], v[48:51], v[160:163]
    ds_read_b64_tr_b16 v[108:109], v28 offset:24576
    v_cvt_pk_bf16_f32 v7, -v246, v247
    v_mfma_f32_16x16x32_bf16 v[164:167], v[64:67], v[36:39], v[164:167]
    buffer_load_dwordx4 v15, s[8:11], s54 offen offset:3072 lds
    v_mfma_f32_16x16x32_bf16 v[168:171], v[64:67], v[40:43], v[168:171]
    ds_read_b64_tr_b16 v[110:111], v28 offset:25088
    v_accvgpr_write_b32 a187, v7
    v_mfma_f32_16x16x32_bf16 v[172:175], v[64:67], v[44:47], v[172:175]
    ds_read_b64_tr_b16 v[112:113], v29 offset:24576
    v_fmamk_f32 v246, v6, 0x42080000, v33
    v_mfma_f32_16x16x32_bf16 v[176:179], v[64:67], v[48:51], v[176:179]
    s_add_u32 m0, s52, 49152
    ds_read_b64_tr_b16 v[114:115], v29 offset:25088
    v_fmamk_f32 v247, v6, 0x420c0000, v33
    v_mfma_f32_16x16x32_bf16 v[180:183], v[36:39], v[68:71], v[180:183]
    buffer_load_dwordx4 v16, s[8:11], s54 offen offset:0 lds
    v_mfma_f32_16x16x32_bf16 v[184:187], v[40:43], v[68:71], v[184:187]
    ds_read_b64_tr_b16 a[234:235], v254 offset:10240
    v_accvgpr_write_b32 a100, v34
    v_mfma_f32_16x16x32_bf16 v[188:191], v[44:47], v[68:71], v[188:191]
    v_cos_f32 v248, v244
    v_mfma_f32_16x16x32_bf16 v[192:195], v[48:51], v[68:71], v[192:195]
    v_sin_f32 v244, v244
    v_mfma_f32_16x16x32_bf16 v[196:199], v[36:39], v[72:75], v[196:199]
    buffer_load_dwordx4 v17, s[8:11], s54 offen offset:1024 lds
    v_mfma_f32_16x16x32_bf16 v[200:203], v[40:43], v[72:75], v[200:203]
    v_cos_f32 v249, v245
    v_mfma_f32_16x16x32_bf16 v[204:207], v[44:47], v[72:75], v[204:207]
    v_sin_f32 v245, v245
    v_mfma_f32_16x16x32_bf16 v[208:211], v[48:51], v[72:75], v[208:211]
    s_waitcnt vmcnt(10) lgkmcnt(0)
    s_barrier
    v_mfma_f32_16x16x32_bf16 v[116:119], v[92:95], v[76:79], v[116:119]
    s_lshl_b32 s53, s51, 7
    ds_read_b128 v[36:39], v18 offset:0
    v_cvt_pk_bf16_f32 v7, v248, v249
    v_mfma_f32_16x16x32_bf16 v[120:123], v[92:95], v[80:83], v[120:123]
    s_mul_i32 s54, s51, 393216
    ds_read_b128 v[40:43], v18 offset:2048
    v_accvgpr_write_b32 a164, v7
    v_mfma_f32_16x16x32_bf16 v[124:127], v[92:95], v[84:87], v[124:127]
    s_add_u32 m0, s52, 81920
    ds_read_b128 v[44:47], v18 offset:10240
    v_cvt_pk_bf16_f32 v7, -v244, -v245
    v_mfma_f32_16x16x32_bf16 v[128:131], v[92:95], v[88:91], v[128:131]
    s_add_u32 s51, s51, 1
    ds_read_b128 v[48:51], v18 offset:12288
    v_accvgpr_write_b32 a172, v7
    v_mfma_f32_16x16x32_bf16 v[132:135], v[96:99], v[76:79], v[132:135]
    buffer_load_dwordx4 v8, s[4:7], s53 offen offset:0 lds
    v_mfma_f32_16x16x32_bf16 v[136:139], v[96:99], v[80:83], v[136:139]
    ds_read_b64_tr_b16 v[52:53], v20 offset:0
    ds_read_b64_tr_b16 v[54:55], v20 offset:512
    v_mfma_f32_16x16x32_bf16 v[140:143], v[96:99], v[84:87], v[140:143]
    ds_read_b64_tr_b16 v[56:57], v21 offset:0
    ds_read_b64_tr_b16 v[58:59], v21 offset:512
    v_mfma_f32_16x16x32_bf16 v[144:147], v[96:99], v[88:91], v[144:147]
    ds_read_b64_tr_b16 v[60:61], v20 offset:2048
    v_cvt_pk_bf16_f32 v7, v248, -v249
    v_mfma_f32_16x16x32_bf16 v[148:151], v[100:103], v[76:79], v[148:151]
    buffer_load_dwordx4 v9, s[4:7], s53 offen offset:1024 lds
    v_mfma_f32_16x16x32_bf16 v[152:155], v[100:103], v[80:83], v[152:155]
    ds_read_b64_tr_b16 v[62:63], v20 offset:2560
    ds_read_b64_tr_b16 v[64:65], v21 offset:2048
    v_mfma_f32_16x16x32_bf16 v[156:159], v[100:103], v[84:87], v[156:159]
    ds_read_b64_tr_b16 v[66:67], v21 offset:2560
    v_accvgpr_write_b32 a180, v7
    v_mfma_f32_16x16x32_bf16 v[160:163], v[100:103], v[88:91], v[160:163]
    ds_read_b64_tr_b16 v[68:69], v20 offset:4096
    v_cvt_pk_bf16_f32 v7, -v244, v245
    v_mfma_f32_16x16x32_bf16 v[164:167], v[104:107], v[76:79], v[164:167]
    buffer_load_dwordx4 v10, s[4:7], s53 offen offset:2048 lds
    v_mfma_f32_16x16x32_bf16 v[168:171], v[104:107], v[80:83], v[168:171]
    ds_read_b64_tr_b16 v[70:71], v20 offset:4608
    v_accvgpr_write_b32 a188, v7
    v_mfma_f32_16x16x32_bf16 v[172:175], v[104:107], v[84:87], v[172:175]
    ds_read_b64_tr_b16 v[72:73], v21 offset:4096
    v_fmamk_f32 v244, v6, 0x42100000, v33
    v_mfma_f32_16x16x32_bf16 v[176:179], v[104:107], v[88:91], v[176:179]
    ds_read_b64_tr_b16 v[74:75], v21 offset:4608
    v_fmamk_f32 v245, v6, 0x42140000, v33
    v_mfma_f32_16x16x32_bf16 v[180:183], v[76:79], v[108:111], v[180:183]
    buffer_load_dwordx4 v11, s[4:7], s53 offen offset:3072 lds
    v_mfma_f32_16x16x32_bf16 v[184:187], v[80:83], v[108:111], v[184:187]
    ds_read_b64_tr_b16 a[236:237], v32 offset:0
    v_and_b32 v34, 2, v5
    v_mfma_f32_16x16x32_bf16 v[188:191], v[84:87], v[108:111], v[188:191]
    s_add_u32 m0, s52, 86016
    v_cos_f32 v250, v246
    v_mfma_f32_16x16x32_bf16 v[192:195], v[88:91], v[108:111], v[192:195]
    s_and_b32 s51, s51, 15
    v_sin_f32 v246, v246
    v_mfma_f32_16x16x32_bf16 v[196:199], v[76:79], v[112:115], v[196:199]
    buffer_load_dwordx4 v12, s[8:11], s54 offen offset:0 lds
    v_mfma_f32_16x16x32_bf16 v[200:203], v[80:83], v[112:115], v[200:203]
    v_cos_f32 v251, v247
    v_mfma_f32_16x16x32_bf16 v[204:207], v[84:87], v[112:115], v[204:207]
    v_sin_f32 v247, v247
    v_mfma_f32_16x16x32_bf16 v[208:211], v[88:91], v[112:115], v[208:211]
    s_waitcnt lgkmcnt(0)
    v_mfma_f32_16x16x32_bf16 v[116:119], v[52:55], v[36:39], v[116:119]
    ds_read_b128 v[76:79], v19 offset:0
    v_cvt_pk_bf16_f32 v7, v250, v251
    v_mfma_f32_16x16x32_bf16 v[120:123], v[52:55], v[40:43], v[120:123]
    ds_read_b128 v[80:83], v19 offset:2048
    v_accvgpr_write_b32 a165, v7
    v_mfma_f32_16x16x32_bf16 v[124:127], v[52:55], v[44:47], v[124:127]
    ds_read_b128 v[84:87], v19 offset:10240
    v_cvt_pk_bf16_f32 v7, -v246, -v247
    v_mfma_f32_16x16x32_bf16 v[128:131], v[52:55], v[48:51], v[128:131]
    ds_read_b128 v[88:91], v19 offset:12288
    v_accvgpr_write_b32 a173, v7
    v_mfma_f32_16x16x32_bf16 v[132:135], v[56:59], v[36:39], v[132:135]
    buffer_load_dwordx4 v13, s[8:11], s54 offen offset:1024 lds
    v_mfma_f32_16x16x32_bf16 v[136:139], v[56:59], v[40:43], v[136:139]
    ds_read_b64_tr_b16 v[92:93], v20 offset:20480
    ds_read_b64_tr_b16 v[94:95], v20 offset:20992
    v_mfma_f32_16x16x32_bf16 v[140:143], v[56:59], v[44:47], v[140:143]
    ds_read_b64_tr_b16 v[96:97], v21 offset:20480
    ds_read_b64_tr_b16 v[98:99], v21 offset:20992
    v_mfma_f32_16x16x32_bf16 v[144:147], v[56:59], v[48:51], v[144:147]
    ds_read_b64_tr_b16 v[100:101], v20 offset:22528
    v_cvt_pk_bf16_f32 v7, v250, -v251
    v_mfma_f32_16x16x32_bf16 v[148:151], v[60:63], v[36:39], v[148:151]
    buffer_load_dwordx4 v14, s[8:11], s54 offen offset:2048 lds
    v_mfma_f32_16x16x32_bf16 v[152:155], v[60:63], v[40:43], v[152:155]
    ds_read_b64_tr_b16 v[102:103], v20 offset:23040
    ds_read_b64_tr_b16 v[104:105], v21 offset:22528
    v_mfma_f32_16x16x32_bf16 v[156:159], v[60:63], v[44:47], v[156:159]
    ds_read_b64_tr_b16 v[106:107], v21 offset:23040
    v_accvgpr_write_b32 a181, v7
    v_mfma_f32_16x16x32_bf16 v[160:163], v[60:63], v[48:51], v[160:163]
    ds_read_b64_tr_b16 v[108:109], v20 offset:24576
    v_cvt_pk_bf16_f32 v7, -v246, v247
    v_mfma_f32_16x16x32_bf16 v[164:167], v[64:67], v[36:39], v[164:167]
    buffer_load_dwordx4 v15, s[8:11], s54 offen offset:3072 lds
    v_mfma_f32_16x16x32_bf16 v[168:171], v[64:67], v[40:43], v[168:171]
    ds_read_b64_tr_b16 v[110:111], v20 offset:25088
    v_accvgpr_write_b32 a189, v7
    v_mfma_f32_16x16x32_bf16 v[172:175], v[64:67], v[44:47], v[172:175]
    ds_read_b64_tr_b16 v[112:113], v21 offset:24576
    v_fmamk_f32 v246, v6, 0x42180000, v33
    v_mfma_f32_16x16x32_bf16 v[176:179], v[64:67], v[48:51], v[176:179]
    s_add_u32 m0, s52, 90112
    ds_read_b64_tr_b16 v[114:115], v21 offset:25088
    v_fmamk_f32 v247, v6, 0x421c0000, v33
    v_mfma_f32_16x16x32_bf16 v[180:183], v[36:39], v[68:71], v[180:183]
    buffer_load_dwordx4 v16, s[8:11], s54 offen offset:0 lds
    v_mfma_f32_16x16x32_bf16 v[184:187], v[40:43], v[68:71], v[184:187]
    ds_read_b64_tr_b16 a[238:239], v32 offset:10240
    v_lshlrev_b32 v34, 5, v34
    v_mfma_f32_16x16x32_bf16 v[188:191], v[44:47], v[68:71], v[188:191]
    v_cos_f32 v248, v244
    v_mfma_f32_16x16x32_bf16 v[192:195], v[48:51], v[68:71], v[192:195]
L_pg2:
    s_cbranch_execz L_pg6
    v_sin_f32 v244, v244
    v_mfma_f32_16x16x32_bf16 v[196:199], v[36:39], v[72:75], v[196:199]
    buffer_load_dwordx4 v17, s[8:11], s54 offen offset:1024 lds
    v_mfma_f32_16x16x32_bf16 v[200:203], v[40:43], v[72:75], v[200:203]
    v_cos_f32 v249, v245
    v_mfma_f32_16x16x32_bf16 v[204:207], v[44:47], v[72:75], v[204:207]
    v_sin_f32 v245, v245
    v_mfma_f32_16x16x32_bf16 v[208:211], v[48:51], v[72:75], v[208:211]
    s_waitcnt vmcnt(10) lgkmcnt(0)
    s_barrier
    v_mfma_f32_16x16x32_bf16 v[116:119], v[92:95], v[76:79], v[116:119]
    s_lshl_b32 s53, s51, 7
    ds_read_b128 v[36:39], v22 offset:0
    v_cvt_pk_bf16_f32 v7, v248, v249
    v_mfma_f32_16x16x32_bf16 v[120:123], v[92:95], v[80:83], v[120:123]
    s_mul_i32 s54, s51, 393216
    ds_read_b128 v[40:43], v22 offset:2048
    v_accvgpr_write_b32 a166, v7
    v_mfma_f32_16x16x32_bf16 v[124:127], v[92:95], v[84:87], v[124:127]
    s_add_u32 m0, s52, 0
    ds_read_b128 v[44:47], v22 offset:10240
    v_cvt_pk_bf16_f32 v7, -v244, -v245
    v_mfma_f32_16x16x32_bf16 v[128:131], v[92:95], v[88:91], v[128:131]
    s_add_u32 s51, s51, 1
    ds_read_b128 v[48:51], v22 offset:12288
    v_accvgpr_write_b32 a174, v7
    v_mfma_f32_16x16x32_bf16 v[132:135], v[96:99], v[76:79], v[132:135]
    buffer_load_dwordx4 v8, s[4:7], s53 offen offset:0 lds
    v_mfma_f32_16x16x32_bf16 v[136:139], v[96:99], v[80:83], v[136:139]
    ds_read_b64_tr_b16 v[52:53], v24 offset:0
    ds_read_b64_tr_b16 v[54:55], v24 offset:512
    v_mfma_f32_16x16x32_bf16 v[140:143], v[96:99], v[84:87], v[140:143]
    ds_read_b64_tr_b16 v[56:57], v25 offset:0
    ds_read_b64_tr_b16 v[58:59], v25 offset:512
    v_mfma_f32_16x16x32_bf16 v[144:147], v[96:99], v[88:91], v[144:147]
    ds_read_b64_tr_b16 v[60:61], v24 offset:2048
    v_cvt_pk_bf16_f32 v7, v248, -v249
    v_mfma_f32_16x16x32_bf16 v[148:151], v[100:103], v[76:79], v[148:151]
    buffer_load_dwordx4 v9, s[4:7], s53 offen offset:1024 lds
    v_mfma_f32_16x16x32_bf16 v[152:155], v[100:103], v[80:83], v[152:155]
    ds_read_b64_tr_b16 v[62:63], v24 offset:2560
    ds_read_b64_tr_b16 v[64:65], v25 offset:2048
    v_mfma_f32_16x16x32_bf16 v[156:159], v[100:103], v[84:87], v[156:159]
    ds_read_b64_tr_b16 v[66:67], v25 offset:2560
    v_accvgpr_write_b32 a182, v7
    v_mfma_f32_16x16x32_bf16 v[160:163], v[100:103], v[88:91], v[160:163]
    ds_read_b64_tr_b16 v[68:69], v24 offset:4096
    v_cvt_pk_bf16_f32 v7, -v244, v245
    v_mfma_f32_16x16x32_bf16 v[164:167], v[104:107], v[76:79], v[164:167]
    buffer_load_dwordx4 v10, s[4:7], s53 offen offset:2048 lds
    v_mfma_f32_16x16x32_bf16 v[168:171], v[104:107], v[80:83], v[168:171]
    ds_read_b64_tr_b16 v[70:71], v24 offset:4608
    v_accvgpr_write_b32 a190, v7
    v_mfma_f32_16x16x32_bf16 v[172:175], v[104:107], v[84:87], v[172:175]
    ds_read_b64_tr_b16 v[72:73], v25 offset:4096
    v_xor_b32 v35, v34, v35
    v_mfma_f32_16x16x32_bf16 v[176:179], v[104:107], v[88:91], v[176:179]
    ds_read_b64_tr_b16 v[74:75], v25 offset:4608
    v_xor_b32 v3, 64, v35
    v_mfma_f32_16x16x32_bf16 v[180:183], v[76:79], v[108:111], v[180:183]
    buffer_load_dwordx4 v11, s[4:7], s53 offen offset:3072 lds
    v_mfma_f32_16x16x32_bf16 v[184:187], v[80:83], v[108:111], v[184:187]
    ds_read_b64_tr_b16 a[240:241], v32 offset:40960
    v_accvgpr_write_b32 a101, v35
    v_mfma_f32_16x16x32_bf16 v[188:191], v[84:87], v[108:111], v[188:191]
    s_add_u32 m0, s52, 4096
    v_cos_f32 v250, v246
    v_mfma_f32_16x16x32_bf16 v[192:195], v[88:91], v[108:111], v[192:195]
    s_and_b32 s51, s51, 15
    v_sin_f32 v246, v246
    v_mfma_f32_16x16x32_bf16 v[196:199], v[76:79], v[112:115], v[196:199]
    buffer_load_dwordx4 v12, s[8:11], s54 offen offset:0 lds
    v_mfma_f32_16x16x32_bf16 v[200:203], v[80:83], v[112:115], v[200:203]
    v_cos_f32 v251, v247
    v_mfma_f32_16x16x32_bf16 v[204:207], v[84:87], v[112:115], v[204:207]
    v_sin_f32 v247, v247
    v_mfma_f32_16x16x32_bf16 v[208:211], v[88:91], v[112:115], v[208:211]
    s_waitcnt lgkmcnt(0)
    v_mfma_f32_16x16x32_bf16 v[116:119], v[52:55], v[36:39], v[116:119]
    ds_read_b128 v[76:79], v23 offset:0
    v_cvt_pk_bf16_f32 v7, v250, v251
    v_mfma_f32_16x16x32_bf16 v[120:123], v[52:55], v[40:43], v[120:123]
    ds_read_b128 v[80:83], v23 offset:2048
    v_accvgpr_write_b32 a167, v7
    v_mfma_f32_16x16x32_bf16 v[124:127], v[52:55], v[44:47], v[124:127]
    ds_read_b128 v[84:87], v23 offset:10240
    v_cvt_pk_bf16_f32 v7, -v246, -v247
    v_mfma_f32_16x16x32_bf16 v[128:131], v[52:55], v[48:51], v[128:131]
    ds_read_b128 v[88:91], v23 offset:12288
    v_accvgpr_write_b32 a175, v7
    v_mfma_f32_16x16x32_bf16 v[132:135], v[56:59], v[36:39], v[132:135]
    buffer_load_dwordx4 v13, s[8:11], s54 offen offset:1024 lds
    v_mfma_f32_16x16x32_bf16 v[136:139], v[56:59], v[40:43], v[136:139]
    ds_read_b64_tr_b16 v[92:93], v24 offset:20480
    ds_read_b64_tr_b16 v[94:95], v24 offset:20992
    v_mfma_f32_16x16x32_bf16 v[140:143], v[56:59], v[44:47], v[140:143]
    ds_read_b64_tr_b16 v[96:97], v25 offset:20480
    ds_read_b64_tr_b16 v[98:99], v25 offset:20992
    v_mfma_f32_16x16x32_bf16 v[144:147], v[56:59], v[48:51], v[144:147]
    ds_read_b64_tr_b16 v[100:101], v24 offset:22528
    v_cvt_pk_bf16_f32 v7, v250, -v251
    v_mfma_f32_16x16x32_bf16 v[148:151], v[60:63], v[36:39], v[148:151]
    buffer_load_dwordx4 v14, s[8:11], s54 offen offset:2048 lds
    v_mfma_f32_16x16x32_bf16 v[152:155], v[60:63], v[40:43], v[152:155]
    ds_read_b64_tr_b16 v[102:103], v24 offset:23040
    ds_read_b64_tr_b16 v[104:105], v25 offset:22528
    v_mfma_f32_16x16x32_bf16 v[156:159], v[60:63], v[44:47], v[156:159]
    ds_read_b64_tr_b16 v[106:107], v25 offset:23040
    v_accvgpr_write_b32 a183, v7
    v_mfma_f32_16x16x32_bf16 v[160:163], v[60:63], v[48:51], v[160:163]
    ds_read_b64_tr_b16 v[108:109], v24 offset:24576
    v_cvt_pk_bf16_f32 v7, -v246, v247
    v_mfma_f32_16x16x32_bf16 v[164:167], v[64:67], v[36:39], v[164:167]
    buffer_load_dwordx4 v15, s[8:11], s54 offen offset:3072 lds
    v_mfma_f32_16x16x32_bf16 v[168:171], v[64:67], v[40:43], v[168:171]
    ds_read_b64_tr_b16 v[110:111], v24 offset:25088
    v_accvgpr_write_b32 a191, v7
    v_mfma_f32_16x16x32_bf16 v[172:175], v[64:67], v[44:47], v[172:175]
    ds_read_b64_tr_b16 v[112:113], v25 offset:24576
    v_add_u32 v34, 15360, v3
    v_mfma_f32_16x16x32_bf16 v[176:179], v[64:67], v[48:51], v[176:179]
    s_add_u32 m0, s52, 8192
    ds_read_b64_tr_b16 v[114:115], v25 offset:25088
    v_accvgpr_write_b32 a102, v34
    v_mfma_f32_16x16x32_bf16 v[180:183], v[36:39], v[68:71], v[180:183]
    buffer_load_dwordx4 v16, s[8:11], s54 offen offset:0 lds
    v_mfma_f32_16x16x32_bf16 v[184:187], v[40:43], v[68:71], v[184:187]
    ds_read_b64_tr_b16 a[242:243], v32 offset:51200
    v_add_u32 v34, 30720, v35
    v_mfma_f32_16x16x32_bf16 v[188:191], v[44:47], v[68:71], v[188:191]
    v_accvgpr_write_b32 a103, v34
    v_add_u32 v34, 46080, v3
    v_mfma_f32_16x16x32_bf16 v[192:195], v[48:51], v[68:71], v[192:195]
    v_accvgpr_write_b32 a104, v34
    v_and_b32 v34, 1, v5
    v_mfma_f32_16x16x32_bf16 v[196:199], v[36:39], v[72:75], v[196:199]
    buffer_load_dwordx4 v17, s[8:11], s54 offen offset:1024 lds
    v_mfma_f32_16x16x32_bf16 v[200:203], v[40:43], v[72:75], v[200:203]
    v_lshlrev_b32 v34, 5, v34
    v_lshl_add_u32 v34, v255, 11, v34
    v_mfma_f32_16x16x32_bf16 v[204:207], v[44:47], v[72:75], v[204:207]
    v_lshrrev_b32 v35, 1, v5
    v_lshl_add_u32 v34, v35, 4, v34
    v_mfma_f32_16x16x32_bf16 v[208:211], v[48:51], v[72:75], v[208:211]
    s_waitcnt vmcnt(10) lgkmcnt(0)
    s_barrier
    v_mfma_f32_16x16x32_bf16 v[116:119], v[92:95], v[76:79], v[116:119]
    s_lshl_b32 s53, s51, 7
    ds_read_b128 v[36:39], v26 offset:0
    v_accvgpr_write_b32 a105, v34
    v_mfma_f32_16x16x32_bf16 v[120:123], v[92:95], v[80:83], v[120:123]
    s_mul_i32 s54, s51, 393216
    ds_read_b128 v[40:43], v26 offset:2048
    v_lshlrev_b32 v34, 3, v0
    v_mfma_f32_16x16x32_bf16 v[124:127], v[92:95], v[84:87], v[124:127]
    s_add_u32 m0, s52, 40960
    ds_read_b128 v[44:47], v26 offset:10240
    v_add_u32 v34, s73, v34
    v_mfma_f32_16x16x32_bf16 v[128:131], v[92:95], v[88:91], v[128:131]
    s_add_u32 s51, s51, 1
    ds_read_b128 v[48:51], v26 offset:12288
    v_add_u32 v35, 101376, v34
    v_mfma_f32_16x16x32_bf16 v[132:135], v[96:99], v[76:79], v[132:135]
    buffer_load_dwordx4 v8, s[4:7], s53 offen offset:0 lds
    v_mfma_f32_16x16x32_bf16 v[136:139], v[96:99], v[80:83], v[136:139]
    ds_read_b64_tr_b16 v[52:53], v28 offset:0
    ds_read_b64_tr_b16 v[54:55], v28 offset:512
    v_mfma_f32_16x16x32_bf16 v[140:143], v[96:99], v[84:87], v[140:143]
    ds_read_b64_tr_b16 v[56:57], v29 offset:0
    ds_read_b64_tr_b16 v[58:59], v29 offset:512
    v_mfma_f32_16x16x32_bf16 v[144:147], v[96:99], v[88:91], v[144:147]
    ds_read_b64_tr_b16 v[60:61], v28 offset:2048
    v_accvgpr_write_b32 a106, v35
    v_mfma_f32_16x16x32_bf16 v[148:151], v[100:103], v[76:79], v[148:151]
    buffer_load_dwordx4 v9, s[4:7], s53 offen offset:1024 lds
    v_mfma_f32_16x16x32_bf16 v[152:155], v[100:103], v[80:83], v[152:155]
    ds_read_b64_tr_b16 v[62:63], v28 offset:2560
    ds_read_b64_tr_b16 v[64:65], v29 offset:2048
    v_mfma_f32_16x16x32_bf16 v[156:159], v[100:103], v[84:87], v[156:159]
    ds_read_b64_tr_b16 v[66:67], v29 offset:2560
    v_add_u32 v34, s73, v4
    v_mfma_f32_16x16x32_bf16 v[160:163], v[100:103], v[88:91], v[160:163]
    ds_read_b64_tr_b16 v[68:69], v28 offset:4096
    v_add_u32 v34, 114688, v34
    v_mfma_f32_16x16x32_bf16 v[164:167], v[104:107], v[76:79], v[164:167]
    buffer_load_dwordx4 v10, s[4:7], s53 offen offset:2048 lds
    v_mfma_f32_16x16x32_bf16 v[168:171], v[104:107], v[80:83], v[168:171]
    ds_read_b64_tr_b16 v[70:71], v28 offset:4608
    v_accvgpr_write_b32 a107, v34
    v_mfma_f32_16x16x32_bf16 v[172:175], v[104:107], v[84:87], v[172:175]
    ds_read_b64_tr_b16 v[72:73], v29 offset:4096
    v_and_b32 v34, 15, v0
    v_mfma_f32_16x16x32_bf16 v[176:179], v[104:107], v[88:91], v[176:179]
    ds_read_b64_tr_b16 v[74:75], v29 offset:4608
    v_lshlrev_b32 v34, 4, v34
    v_mfma_f32_16x16x32_bf16 v[180:183], v[76:79], v[108:111], v[180:183]
    buffer_load_dwordx4 v11, s[4:7], s53 offen offset:3072 lds
    v_mfma_f32_16x16x32_bf16 v[184:187], v[80:83], v[108:111], v[184:187]
    ds_read_b64_tr_b16 a[244:245], v254 offset:0
    v_and_b32 v35, 1, v5
    v_mfma_f32_16x16x32_bf16 v[188:191], v[84:87], v[108:111], v[188:191]
    s_add_u32 m0, s52, 45056
    v_lshl_add_u32 v34, v35, 10, v34
    v_lshrrev_b32 v35, 5, v0
    v_mfma_f32_16x16x32_bf16 v[192:195], v[88:91], v[108:111], v[192:195]
    s_and_b32 s51, s51, 15
    v_lshl_add_u32 v34, v35, 8, v34
    v_accvgpr_write_b32 a108, v34
    v_mfma_f32_16x16x32_bf16 v[196:199], v[76:79], v[112:115], v[196:199]
    buffer_load_dwordx4 v12, s[8:11], s54 offen offset:0 lds
    v_mfma_f32_16x16x32_bf16 v[200:203], v[80:83], v[112:115], v[200:203]
    v_bfe_u32 v34, v0, 3, 2
    v_lshlrev_b32 v34, 5, v34
    v_mfma_f32_16x16x32_bf16 v[204:207], v[84:87], v[112:115], v[204:207]
    v_and_b32 v35, 3, v0
    v_lshl_add_u32 v34, v35, 3, v34
    v_mfma_f32_16x16x32_bf16 v[208:211], v[88:91], v[112:115], v[208:211]
    s_waitcnt lgkmcnt(0)
    v_mfma_f32_16x16x32_bf16 v[116:119], v[52:55], v[36:39], v[116:119]
    ds_read_b128 v[76:79], v27 offset:0
    v_bfe_u32 v35, v0, 2, 2
    v_mfma_f32_16x16x32_bf16 v[120:123], v[52:55], v[40:43], v[120:123]
    ds_read_b128 v[80:83], v27 offset:2048
    v_lshl_add_u32 v34, v35, 7, v34
    v_mfma_f32_16x16x32_bf16 v[124:127], v[52:55], v[44:47], v[124:127]
    ds_read_b128 v[84:87], v27 offset:10240
    v_lshl_add_u32 v35, v5, 10, v34
    v_mfma_f32_16x16x32_bf16 v[128:131], v[52:55], v[48:51], v[128:131]
    ds_read_b128 v[88:91], v27 offset:12288
    v_accvgpr_write_b32 a109, v35
    v_mfma_f32_16x16x32_bf16 v[132:135], v[56:59], v[36:39], v[132:135]
    buffer_load_dwordx4 v13, s[8:11], s54 offen offset:1024 lds
    v_mfma_f32_16x16x32_bf16 v[136:139], v[56:59], v[40:43], v[136:139]
    ds_read_b64_tr_b16 v[92:93], v28 offset:20480
    ds_read_b64_tr_b16 v[94:95], v28 offset:20992
    v_mfma_f32_16x16x32_bf16 v[140:143], v[56:59], v[44:47], v[140:143]
    ds_read_b64_tr_b16 v[96:97], v29 offset:20480
    ds_read_b64_tr_b16 v[98:99], v29 offset:20992
    v_mfma_f32_16x16x32_bf16 v[144:147], v[56:59], v[48:51], v[144:147]
    ds_read_b64_tr_b16 v[100:101], v28 offset:22528
    v_and_b32 v35, 1, v5
    v_mfma_f32_16x16x32_bf16 v[148:151], v[60:63], v[36:39], v[148:151]
    buffer_load_dwordx4 v14, s[8:11], s54 offen offset:2048 lds
    v_mfma_f32_16x16x32_bf16 v[152:155], v[60:63], v[40:43], v[152:155]
    ds_read_b64_tr_b16 v[102:103], v28 offset:23040
    ds_read_b64_tr_b16 v[104:105], v29 offset:22528
    v_mfma_f32_16x16x32_bf16 v[156:159], v[60:63], v[44:47], v[156:159]
    ds_read_b64_tr_b16 v[106:107], v29 offset:23040
    v_lshl_add_u32 v34, v35, 9, v34
    v_mfma_f32_16x16x32_bf16 v[160:163], v[60:63], v[48:51], v[160:163]
    ds_read_b64_tr_b16 v[108:109], v28 offset:24576
    v_lshrrev_b32 v35, 5, v0
    v_mfma_f32_16x16x32_bf16 v[164:167], v[64:67], v[36:39], v[164:167]
    buffer_load_dwordx4 v15, s[8:11], s54 offen offset:3072 lds
    v_mfma_f32_16x16x32_bf16 v[168:171], v[64:67], v[40:43], v[168:171]
    ds_read_b64_tr_b16 v[110:111], v28 offset:25088
    v_lshl_add_u32 v34, v35, 11, v34
    v_mfma_f32_16x16x32_bf16 v[172:175], v[64:67], v[44:47], v[172:175]
    ds_read_b64_tr_b16 v[112:113], v29 offset:24576
    v_mov_b32 v35, s48
    v_mfma_f32_16x16x32_bf16 v[176:179], v[64:67], v[48:51], v[176:179]
    s_add_u32 m0, s52, 49152
    ds_read_b64_tr_b16 v[114:115], v29 offset:25088
    v_lshl_add_u32 v34, v35, 16, v34
    v_mfma_f32_16x16x32_bf16 v[180:183], v[36:39], v[68:71], v[180:183]
    buffer_load_dwordx4 v16, s[8:11], s54 offen offset:0 lds
    v_mfma_f32_16x16x32_bf16 v[184:187], v[40:43], v[68:71], v[184:187]
    ds_read_b64_tr_b16 a[246:247], v254 offset:10240
    v_accvgpr_write_b32 a110, v34
    v_mfma_f32_16x16x32_bf16 v[188:191], v[44:47], v[68:71], v[188:191]
    v_lshl_add_u32 v34, v35, 10, v4
    v_accvgpr_write_b32 a111, v34
    v_mfma_f32_16x16x32_bf16 v[192:195], v[48:51], v[68:71], v[192:195]
    v_mfma_f32_16x16x32_bf16 v[196:199], v[36:39], v[72:75], v[196:199]
    buffer_load_dwordx4 v17, s[8:11], s54 offen offset:1024 lds
    v_mfma_f32_16x16x32_bf16 v[200:203], v[40:43], v[72:75], v[200:203]
    v_mfma_f32_16x16x32_bf16 v[204:207], v[44:47], v[72:75], v[204:207]
    v_mfma_f32_16x16x32_bf16 v[208:211], v[48:51], v[72:75], v[208:211]
    s_waitcnt vmcnt(10) lgkmcnt(0)
    s_barrier
    v_mfma_f32_16x16x32_bf16 v[116:119], v[92:95], v[76:79], v[116:119]
    ds_read_b128 v[36:39], v18 offset:0
    v_and_b32 v33, 3, v0
    v_mfma_f32_16x16x32_bf16 v[120:123], v[92:95], v[80:83], v[120:123]
    ds_read_b128 v[40:43], v18 offset:2048
    v_lshrrev_b32 v34, 5, v0
    v_mfma_f32_16x16x32_bf16 v[124:127], v[92:95], v[84:87], v[124:127]
    ds_read_b128 v[44:47], v18 offset:10240
    v_mov_b32 v35, s40
    v_mfma_f32_16x16x32_bf16 v[128:131], v[92:95], v[88:91], v[128:131]
    ds_read_b128 v[48:51], v18 offset:12288
    v_lshlrev_b32 v8, 2, v0
    v_mfma_f32_16x16x32_bf16 v[132:135], v[96:99], v[76:79], v[132:135]
    ds_read_b64_tr_b16 v[52:53], v20 offset:0
    v_lshlrev_b32 v16, 7, v0
    v_mfma_f32_16x16x32_bf16 v[136:139], v[96:99], v[80:83], v[136:139]
    ds_read_b64_tr_b16 v[54:55], v20 offset:512
    v_lshl_add_u32 v16, v5, 21, v16
    v_mfma_f32_16x16x32_bf16 v[140:143], v[96:99], v[84:87], v[140:143]
    ds_read_b64_tr_b16 v[56:57], v21 offset:0
    v_mul_u32_u24 v9, 2056, v33
    v_mfma_f32_16x16x32_bf16 v[144:147], v[96:99], v[88:91], v[144:147]
    ds_read_b64_tr_b16 v[58:59], v21 offset:512
    v_bfe_u32 v6, v0, 2, 1
    v_mfma_f32_16x16x32_bf16 v[148:151], v[100:103], v[76:79], v[148:151]
    ds_read_b64_tr_b16 v[60:61], v20 offset:2048
    v_mul_u32_u24 v6, 8256, v6
    v_mfma_f32_16x16x32_bf16 v[152:155], v[100:103], v[80:83], v[152:155]
    ds_read_b64_tr_b16 v[62:63], v20 offset:2560
    v_add_u32 v9, v9, v6
    v_mfma_f32_16x16x32_bf16 v[156:159], v[100:103], v[84:87], v[156:159]
    ds_read_b64_tr_b16 v[64:65], v21 offset:2048
    v_bfe_u32 v6, v0, 3, 1
    v_mfma_f32_16x16x32_bf16 v[160:163], v[100:103], v[88:91], v[160:163]
    ds_read_b64_tr_b16 v[66:67], v21 offset:2560
    v_lshl_add_u32 v9, v6, 7, v9
    v_mfma_f32_16x16x32_bf16 v[164:167], v[104:107], v[76:79], v[164:167]
    ds_read_b64_tr_b16 v[68:69], v20 offset:4096
    v_lshl_add_u32 v9, v5, 3, v9
    v_mfma_f32_16x16x32_bf16 v[168:171], v[104:107], v[80:83], v[168:171]
    ds_read_b64_tr_b16 v[70:71], v20 offset:4608
    v_lshl_add_u32 v9, v35, 5, v9
    v_mfma_f32_16x16x32_bf16 v[172:175], v[104:107], v[84:87], v[172:175]
    ds_read_b64_tr_b16 v[72:73], v21 offset:4096
    v_mov_b32 v11, s51
    v_mfma_f32_16x16x32_bf16 v[176:179], v[104:107], v[88:91], v[176:179]
    ds_read_b64_tr_b16 v[74:75], v21 offset:4608
    v_lshl_add_u32 v26, v11, 7, v9
    v_mfma_f32_16x16x32_bf16 v[180:183], v[76:79], v[108:111], v[180:183]
    s_lshl_b32 s57, s58, 9
    ds_read_b64_tr_b16 a[248:249], v32 offset:0
    v_add_u32 v11, 4, v11
    v_mfma_f32_16x16x32_bf16 v[184:187], v[80:83], v[108:111], v[184:187]
    buffer_load_dword a157, v16, s[16:19], s57 offen
    v_mfma_f32_16x16x32_bf16 v[188:191], v[84:87], v[108:111], v[188:191]
    v_and_b32 v11, 15, v11
    v_lshl_add_u32 v27, v11, 7, v9
    v_mfma_f32_16x16x32_bf16 v[192:195], v[88:91], v[108:111], v[192:195]
    buffer_load_dwordx4 v[244:247], v4, s[20:23], 0 offen offset:0
    v_mfma_f32_16x16x32_bf16 v[196:199], v[76:79], v[112:115], v[196:199]
    v_add_u32 v11, 4, v11
    v_and_b32 v11, 15, v11
    v_mfma_f32_16x16x32_bf16 v[200:203], v[80:83], v[112:115], v[200:203]
    buffer_load_dword a156, v16, s[32:35], s87 offen sc1
    v_mfma_f32_16x16x32_bf16 v[204:207], v[84:87], v[112:115], v[204:207]
    v_lshl_add_u32 v28, v11, 7, v9
    v_add_u32 v11, 4, v11
    v_mfma_f32_16x16x32_bf16 v[208:211], v[88:91], v[112:115], v[208:211]
    s_waitcnt lgkmcnt(0)
    v_mfma_f32_16x16x32_bf16 v[116:119], v[52:55], v[36:39], v[116:119]
    ds_read_b128 v[76:79], v19 offset:0
    v_and_b32 v11, 15, v11
    v_mfma_f32_16x16x32_bf16 v[120:123], v[52:55], v[40:43], v[120:123]
    ds_read_b128 v[80:83], v19 offset:2048
    v_lshl_add_u32 v29, v11, 7, v9
    v_mfma_f32_16x16x32_bf16 v[124:127], v[52:55], v[44:47], v[124:127]
    ds_read_b128 v[84:87], v19 offset:10240
    v_xor_b32 v17, v6, v0
    v_mfma_f32_16x16x32_bf16 v[128:131], v[52:55], v[48:51], v[128:131]
    ds_read_b128 v[88:91], v19 offset:12288
    v_lshlrev_b32 v17, 4, v17
    v_mfma_f32_16x16x32_bf16 v[132:135], v[56:59], v[36:39], v[132:135]
    ds_read_b64_tr_b16 v[92:93], v20 offset:20480
    v_lshl_add_u32 v17, v35, 12, v17
    v_mfma_f32_16x16x32_bf16 v[136:139], v[56:59], v[40:43], v[136:139]
    ds_read_b64_tr_b16 v[94:95], v20 offset:20992
    v_add_u32 v17, 98304, v17
    v_mfma_f32_16x16x32_bf16 v[140:143], v[56:59], v[44:47], v[140:143]
    ds_read_b64_tr_b16 v[96:97], v21 offset:20480
    v_lshlrev_b32 v10, 3, v33
    v_mfma_f32_16x16x32_bf16 v[144:147], v[56:59], v[48:51], v[144:147]
    ds_read_b64_tr_b16 v[98:99], v21 offset:20992
    v_bfe_u32 v6, v0, 2, 2
    v_mfma_f32_16x16x32_bf16 v[148:151], v[60:63], v[36:39], v[148:151]
    ds_read_b64_tr_b16 v[100:101], v20 offset:22528
    v_lshl_add_u32 v10, v6, 6, v10
    v_mfma_f32_16x16x32_bf16 v[152:155], v[60:63], v[40:43], v[152:155]
    ds_read_b64_tr_b16 v[102:103], v20 offset:23040
    v_bfe_u32 v6, v0, 4, 1
    v_mfma_f32_16x16x32_bf16 v[156:159], v[60:63], v[44:47], v[156:159]
    ds_read_b64_tr_b16 v[104:105], v21 offset:22528
    v_lshl_add_u32 v10, v6, 5, v10
    v_mfma_f32_16x16x32_bf16 v[160:163], v[60:63], v[48:51], v[160:163]
    ds_read_b64_tr_b16 v[106:107], v21 offset:23040
    v_lshl_add_u32 v10, v34, 8, v10
    v_mfma_f32_16x16x32_bf16 v[164:167], v[64:67], v[36:39], v[164:167]
    ds_read_b64_tr_b16 v[108:109], v20 offset:24576
    v_and_b32 v6, 1, v35
    v_mfma_f32_16x16x32_bf16 v[168:171], v[64:67], v[40:43], v[168:171]
    ds_read_b64_tr_b16 v[110:111], v20 offset:25088
    v_mul_u32_u24 v6, 4112, v6
    v_mfma_f32_16x16x32_bf16 v[172:175], v[64:67], v[44:47], v[172:175]
    ds_read_b64_tr_b16 v[112:113], v21 offset:24576
    v_lshrrev_b32 v7, 1, v35
    v_mfma_f32_16x16x32_bf16 v[176:179], v[64:67], v[48:51], v[176:179]
    ds_read_b64_tr_b16 v[114:115], v21 offset:25088
    v_mul_u32_u24 v7, 8256, v7
    v_mfma_f32_16x16x32_bf16 v[180:183], v[36:39], v[68:71], v[180:183]
    ds_read_b64_tr_b16 a[250:251], v32 offset:10240
    v_add3_u32 v10, v10, v6, v7
    v_mfma_f32_16x16x32_bf16 v[184:187], v[40:43], v[68:71], v[184:187]
    v_lshl_add_u32 v12, v35, 12, v4
    v_xor_b32 v13, 4096, v12
    v_mfma_f32_16x16x32_bf16 v[188:191], v[44:47], v[68:71], v[188:191]
    s_add_u32 s56, s87, 8192
    v_not_b32 v14, v0
    v_and_b32 v14, 31, v14
    v_mfma_f32_16x16x32_bf16 v[192:195], v[48:51], v[68:71], v[192:195]
    buffer_load_dword a156, v16, s[32:35], s56 offen sc1
    v_mfma_f32_16x16x32_bf16 v[196:199], v[36:39], v[72:75], v[196:199]
    v_lshlrev_b32 v14, 20, v14
    v_lshl_add_u32 v14, v34, 3, v14
    v_mfma_f32_16x16x32_bf16 v[200:203], v[40:43], v[72:75], v[200:203]
    buffer_load_dwordx4 v[248:251], v4, s[20:23], 0 offen offset:1024
    v_mfma_f32_16x16x32_bf16 v[204:207], v[44:47], v[72:75], v[204:207]
    v_lshl_add_u32 v7, v252, 1, v34
    v_bfe_u32 v15, v7, 2, 1
    v_mfma_f32_16x16x32_bf16 v[208:211], v[48:51], v[72:75], v[208:211]
    s_waitcnt vmcnt(5) lgkmcnt(0)
    s_barrier
    v_mfma_f32_16x16x32_bf16 v[116:119], v[92:95], v[76:79], v[116:119]
    ds_read_b128 v[36:39], v22 offset:0
    v_bfe_u32 v6, v7, 5, 1
    v_mfma_f32_16x16x32_bf16 v[120:123], v[92:95], v[80:83], v[120:123]
    ds_read_b128 v[40:43], v22 offset:2048
    v_lshl_add_u32 v15, v6, 1, v15
    v_mfma_f32_16x16x32_bf16 v[124:127], v[92:95], v[84:87], v[124:127]
    ds_read_b128 v[44:47], v22 offset:10240
    v_lshlrev_b32 v6, 1, v7
    v_mfma_f32_16x16x32_bf16 v[128:131], v[92:95], v[88:91], v[128:131]
    ds_read_b128 v[48:51], v22 offset:12288
    v_xor_b32 v15, v15, v6
    v_mfma_f32_16x16x32_bf16 v[132:135], v[96:99], v[76:79], v[132:135]
    ds_read_b64_tr_b16 v[52:53], v24 offset:0
    v_lshlrev_b32 v15, 4, v15
    v_mfma_f32_16x16x32_bf16 v[136:139], v[96:99], v[80:83], v[136:139]
    ds_read_b64_tr_b16 v[54:55], v24 offset:512
    v_lshl_add_u32 v15, v35, 12, v15
    v_mfma_f32_16x16x32_bf16 v[140:143], v[96:99], v[84:87], v[140:143]
    ds_read_b64_tr_b16 v[56:57], v25 offset:0
    v_add_u32 v15, 98304, v15
    v_mfma_f32_16x16x32_bf16 v[144:147], v[96:99], v[88:91], v[144:147]
    ds_read_b64_tr_b16 v[58:59], v25 offset:512
    v_xor_b32 v2, 2000, v15
    v_mfma_f32_16x16x32_bf16 v[148:151], v[100:103], v[76:79], v[148:151]
    ds_read_b64_tr_b16 v[60:61], v24 offset:2048
    v_xor_b32 v3, 16, v2
    v_mfma_f32_16x16x32_bf16 v[152:155], v[100:103], v[80:83], v[152:155]
    ds_read_b64_tr_b16 v[62:63], v24 offset:2560
    v_add_u32 v7, 1, v7
    v_mfma_f32_16x16x32_bf16 v[156:159], v[100:103], v[84:87], v[156:159]
    ds_read_b64_tr_b16 v[64:65], v25 offset:2048
    v_bfe_u32 v1, v7, 1, 2
    v_mfma_f32_16x16x32_bf16 v[160:163], v[100:103], v[88:91], v[160:163]
    ds_read_b64_tr_b16 v[66:67], v25 offset:2560
    v_bfe_u32 v6, v7, 3, 2
    v_mfma_f32_16x16x32_bf16 v[164:167], v[104:107], v[76:79], v[164:167]
    ds_read_b64_tr_b16 v[68:69], v24 offset:4096
    v_lshl_add_u32 v1, v6, 3, v1
    v_mfma_f32_16x16x32_bf16 v[168:171], v[104:107], v[80:83], v[168:171]
    ds_read_b64_tr_b16 v[70:71], v24 offset:4608
    v_bfe_u32 v6, v7, 5, 1
    v_mfma_f32_16x16x32_bf16 v[172:175], v[104:107], v[84:87], v[172:175]
    ds_read_b64_tr_b16 v[72:73], v25 offset:4096
    v_lshl_add_u32 v1, v6, 2, v1
    v_mfma_f32_16x16x32_bf16 v[176:179], v[104:107], v[88:91], v[176:179]
    ds_read_b64_tr_b16 v[74:75], v25 offset:4608
    v_and_b32 v6, 1, v7
    v_mfma_f32_16x16x32_bf16 v[180:183], v[76:79], v[108:111], v[180:183]
    ds_read_b64_tr_b16 a[252:253], v32 offset:40960
    v_lshl_add_u32 v1, v6, 5, v1
    v_mfma_f32_16x16x32_bf16 v[184:187], v[80:83], v[108:111], v[184:187]
    v_lshlrev_b32 v1, 2, v1
    v_mov_b32 v6, 0
    v_mfma_f32_16x16x32_bf16 v[188:191], v[84:87], v[108:111], v[188:191]
    v_mov_b32 v7, 0
    v_xor_b32 v16, 16, v15
    v_mfma_f32_16x16x32_bf16 v[192:195], v[88:91], v[108:111], v[192:195]
    v_mfma_f32_16x16x32_bf16 v[196:199], v[76:79], v[112:115], v[196:199]
    v_mfma_f32_16x16x32_bf16 v[200:203], v[80:83], v[112:115], v[200:203]
    buffer_load_dword v254, v8, s[28:31], 0 offen sc1
    v_mfma_f32_16x16x32_bf16 v[204:207], v[84:87], v[112:115], v[204:207]
    v_mfma_f32_16x16x32_bf16 v[208:211], v[88:91], v[112:115], v[208:211]
    s_waitcnt lgkmcnt(0)
    v_mfma_f32_16x16x32_bf16 v[116:119], v[52:55], v[36:39], v[116:119]
    ds_read_b128 v[76:79], v23 offset:0
    v_mfma_f32_16x16x32_bf16 v[120:123], v[52:55], v[40:43], v[120:123]
    ds_read_b128 v[80:83], v23 offset:2048
    v_mfma_f32_16x16x32_bf16 v[124:127], v[52:55], v[44:47], v[124:127]
    ds_read_b128 v[84:87], v23 offset:10240
    v_mfma_f32_16x16x32_bf16 v[128:131], v[52:55], v[48:51], v[128:131]
    ds_read_b128 v[88:91], v23 offset:12288
    v_mfma_f32_16x16x32_bf16 v[132:135], v[56:59], v[36:39], v[132:135]
    ds_read_b64_tr_b16 v[92:93], v24 offset:20480
    v_mfma_f32_16x16x32_bf16 v[136:139], v[56:59], v[40:43], v[136:139]
    ds_read_b64_tr_b16 v[94:95], v24 offset:20992
    v_mfma_f32_16x16x32_bf16 v[140:143], v[56:59], v[44:47], v[140:143]
    ds_read_b64_tr_b16 v[96:97], v25 offset:20480
    v_mfma_f32_16x16x32_bf16 v[144:147], v[56:59], v[48:51], v[144:147]
    ds_read_b64_tr_b16 v[98:99], v25 offset:20992
    v_mfma_f32_16x16x32_bf16 v[148:151], v[60:63], v[36:39], v[148:151]
    ds_read_b64_tr_b16 v[100:101], v24 offset:22528
    v_mfma_f32_16x16x32_bf16 v[152:155], v[60:63], v[40:43], v[152:155]
    ds_read_b64_tr_b16 v[102:103], v24 offset:23040
    v_mfma_f32_16x16x32_bf16 v[156:159], v[60:63], v[44:47], v[156:159]
    ds_read_b64_tr_b16 v[104:105], v25 offset:22528
    v_mfma_f32_16x16x32_bf16 v[160:163], v[60:63], v[48:51], v[160:163]
    ds_read_b64_tr_b16 v[106:107], v25 offset:23040
    v_mfma_f32_16x16x32_bf16 v[164:167], v[64:67], v[36:39], v[164:167]
    ds_read_b64_tr_b16 v[108:109], v24 offset:24576
    v_mfma_f32_16x16x32_bf16 v[168:171], v[64:67], v[40:43], v[168:171]
    ds_read_b64_tr_b16 v[110:111], v24 offset:25088
    v_mfma_f32_16x16x32_bf16 v[172:175], v[64:67], v[44:47], v[172:175]
    ds_read_b64_tr_b16 v[112:113], v25 offset:24576
    v_mfma_f32_16x16x32_bf16 v[176:179], v[64:67], v[48:51], v[176:179]
    ds_read_b64_tr_b16 v[114:115], v25 offset:25088
    v_mfma_f32_16x16x32_bf16 v[180:183], v[36:39], v[68:71], v[180:183]
    ds_read_b64_tr_b16 a[254:255], v32 offset:51200
    v_mfma_f32_16x16x32_bf16 v[184:187], v[40:43], v[68:71], v[184:187]
    v_mfma_f32_16x16x32_bf16 v[188:191], v[44:47], v[68:71], v[188:191]
    v_mfma_f32_16x16x32_bf16 v[192:195], v[48:51], v[68:71], v[192:195]
    v_mfma_f32_16x16x32_bf16 v[196:199], v[36:39], v[72:75], v[196:199]
    v_mfma_f32_16x16x32_bf16 v[200:203], v[40:43], v[72:75], v[200:203]
    v_mfma_f32_16x16x32_bf16 v[204:207], v[44:47], v[72:75], v[204:207]
    v_mfma_f32_16x16x32_bf16 v[208:211], v[48:51], v[72:75], v[208:211]
    s_waitcnt lgkmcnt(0)
    v_mfma_f32_16x16x32_bf16 v[148:151], v[100:103], v[76:79], v[148:151]
    v_mfma_f32_16x16x32_bf16 v[152:155], v[100:103], v[80:83], v[152:155]
    buffer_load_dwordx4 v[18:21], v4, s[4:7], s60 offen offset:0
    v_mfma_f32_16x16x32_bf16 v[156:159], v[100:103], v[84:87], v[156:159]
    v_mfma_f32_16x16x32_bf16 v[160:163], v[100:103], v[88:91], v[160:163]
    v_mfma_f32_16x16x32_bf16 v[164:167], v[104:107], v[76:79], v[164:167]
    buffer_load_dwordx4 v[22:25], v4, s[4:7], s60 offen offset:1024
    v_mfma_f32_16x16x32_bf16 v[168:171], v[104:107], v[80:83], v[168:171]
    v_mfma_f32_16x16x32_bf16 v[172:175], v[104:107], v[84:87], v[172:175]
    v_mfma_f32_16x16x32_bf16 v[176:179], v[104:107], v[88:91], v[176:179]
    buffer_load_dwordx4 v[68:71], v4, s[4:7], s59 offen offset:0
    v_mfma_f32_16x16x32_bf16 v[180:183], v[76:79], v[108:111], v[180:183]
    v_mfma_f32_16x16x32_bf16 v[184:187], v[80:83], v[108:111], v[184:187]
    v_mfma_f32_16x16x32_bf16 v[188:191], v[84:87], v[108:111], v[188:191]
    buffer_load_dwordx4 v[72:75], v4, s[4:7], s59 offen offset:1024
    v_mfma_f32_16x16x32_bf16 v[192:195], v[88:91], v[108:111], v[192:195]
    v_mfma_f32_16x16x32_bf16 v[196:199], v[76:79], v[112:115], v[196:199]
    v_cvt_pk_bf16_f32 v36, v148, v149
    v_cvt_pk_bf16_f32 v37, v150, v151
    v_mfma_f32_16x16x32_bf16 v[200:203], v[80:83], v[112:115], v[200:203]
    v_cvt_pk_bf16_f32 v38, v164, v165
    v_cvt_pk_bf16_f32 v39, v166, v167
    v_mfma_f32_16x16x32_bf16 v[204:207], v[84:87], v[112:115], v[204:207]
    v_cvt_pk_bf16_f32 v40, v152, v153
    v_cvt_pk_bf16_f32 v41, v154, v155
    v_mfma_f32_16x16x32_bf16 v[208:211], v[88:91], v[112:115], v[208:211]
L_pg3:
    s_cbranch_execz L_pg7
    v_cvt_pk_bf16_f32 v42, v168, v169
    v_cvt_pk_bf16_f32 v43, v170, v171
    v_mfma_f32_16x16x32_bf16 v[116:119], v[92:95], v[76:79], v[116:119]
    v_cvt_pk_bf16_f32 v52, v156, v157
    v_cvt_pk_bf16_f32 v53, v158, v159
    v_mfma_f32_16x16x32_bf16 v[120:123], v[92:95], v[80:83], v[120:123]
    v_cvt_pk_bf16_f32 v54, v172, v173
    v_cvt_pk_bf16_f32 v55, v174, v175
    v_mfma_f32_16x16x32_bf16 v[124:127], v[92:95], v[84:87], v[124:127]
    v_cvt_pk_bf16_f32 v56, v160, v161
    v_cvt_pk_bf16_f32 v57, v162, v163
    v_mfma_f32_16x16x32_bf16 v[128:131], v[92:95], v[88:91], v[128:131]
    v_cvt_pk_bf16_f32 v58, v176, v177
    v_cvt_pk_bf16_f32 v59, v178, v179
    v_mfma_f32_16x16x32_bf16 v[132:135], v[96:99], v[76:79], v[132:135]
    v_permlane16_swap_b32 v36, v40
    v_mfma_f32_16x16x32_bf16 v[136:139], v[96:99], v[80:83], v[136:139]
    v_permlane16_swap_b32 v37, v41
    v_mfma_f32_16x16x32_bf16 v[140:143], v[96:99], v[84:87], v[140:143]
    v_permlane16_swap_b32 v38, v42
    v_mfma_f32_16x16x32_bf16 v[144:147], v[96:99], v[88:91], v[144:147]
    v_permlane16_swap_b32 v39, v43
    v_mfma_f32_16x16x32_bf16 v[76:79], a[192:195], a[0:3], 0
    buffer_store_dwordx4 v[36:39], v4, s[12:15], s62 offen offset:0 sc1
    v_mfma_f32_16x16x32_bf16 v[76:79], a[196:199], a[4:7], v[76:79]
    v_permlane16_swap_b32 v52, v56
    v_permlane16_swap_b32 v53, v57
    v_mfma_f32_16x16x32_bf16 v[80:83], a[200:203], a[0:3], 0
    v_permlane16_swap_b32 v54, v58
    v_permlane16_swap_b32 v55, v59
    v_mfma_f32_16x16x32_bf16 v[80:83], a[204:207], a[4:7], v[80:83]
    buffer_store_dwordx4 v[40:43], v4, s[12:15], s62 offen offset:1024 sc1
    v_mfma_f32_16x16x32_bf16 v[84:87], a[208:211], a[0:3], 0
    v_cvt_pk_bf16_f32 v44, v180, v181
    v_cvt_pk_bf16_f32 v45, v182, v183
    v_cvt_pk_bf16_f32 v46, v196, v197
    v_cvt_pk_bf16_f32 v47, v198, v199
    v_mfma_f32_16x16x32_bf16 v[84:87], a[212:215], a[4:7], v[84:87]
    v_cvt_pk_bf16_f32 v48, v184, v185
    v_cvt_pk_bf16_f32 v49, v186, v187
    v_cvt_pk_bf16_f32 v50, v200, v201
    v_cvt_pk_bf16_f32 v51, v202, v203
    v_mfma_f32_16x16x32_bf16 v[88:91], a[216:219], a[0:3], 0
    buffer_store_dwordx4 v[52:55], v4, s[12:15], s63 offen offset:0 sc1
    v_mfma_f32_16x16x32_bf16 v[88:91], a[220:223], a[4:7], v[88:91]
    v_cvt_pk_bf16_f32 v60, v188, v189
    v_cvt_pk_bf16_f32 v61, v190, v191
    v_cvt_pk_bf16_f32 v62, v204, v205
    v_cvt_pk_bf16_f32 v63, v206, v207
    v_mfma_f32_16x16x32_bf16 v[92:95], a[224:227], a[0:3], 0
    v_cvt_pk_bf16_f32 v64, v192, v193
    v_cvt_pk_bf16_f32 v65, v194, v195
    v_cvt_pk_bf16_f32 v66, v208, v209
    v_cvt_pk_bf16_f32 v67, v210, v211
    v_mfma_f32_16x16x32_bf16 v[92:95], a[228:231], a[4:7], v[92:95]
    buffer_store_dwordx4 v[56:59], v4, s[12:15], s63 offen offset:1024 sc1
    v_mfma_f32_16x16x32_bf16 v[96:99], a[232:235], a[0:3], 0
    v_permlane16_swap_b32 v44, v46
    v_permlane16_swap_b32 v45, v47
    v_mfma_f32_16x16x32_bf16 v[96:99], a[236:239], a[4:7], v[96:99]
    v_permlane16_swap_b32 v48, v50
    v_permlane16_swap_b32 v49, v51
    v_mfma_f32_16x16x32_bf16 v[100:103], a[240:243], a[0:3], 0
    buffer_store_dwordx4 v[44:47], v4, s[12:15], s62 offen offset:2048 sc1
    v_mfma_f32_16x16x32_bf16 v[100:103], a[244:247], a[4:7], v[100:103]
    v_permlane16_swap_b32 v60, v62
    v_permlane16_swap_b32 v61, v63
    v_mfma_f32_16x16x32_bf16 v[104:107], a[248:251], a[0:3], 0
    v_permlane16_swap_b32 v64, v66
    v_permlane16_swap_b32 v65, v67
    v_mfma_f32_16x16x32_bf16 v[104:107], a[252:255], a[4:7], v[104:107]
    buffer_store_dwordx4 v[48:51], v4, s[12:15], s62 offen offset:3072 sc1
    v_mov_b32 v34, s64
    v_pk_mul_f32 v[116:117], v[116:117], v[34:35] op_sel_hi:[1,0]
    v_pk_mul_f32 v[118:119], v[118:119], v[34:35] op_sel_hi:[1,0]
    v_pk_mul_f32 v[132:133], v[132:133], v[34:35] op_sel_hi:[1,0]
    v_pk_mul_f32 v[134:135], v[134:135], v[34:35] op_sel_hi:[1,0]
    v_cvt_pk_bf16_f32 v76, v76, v77
    v_cvt_pk_bf16_f32 v77, v78, v79
    ds_write_b64 v26, v[76:77] offset:0
    v_cvt_pk_bf16_f32 v148, v116, v117
    v_cvt_pk_bf16_f32 v149, v118, v119
    v_cvt_pk_bf16_f32 v150, v132, v133
    v_cvt_pk_bf16_f32 v151, v134, v135
    v_cvt_pk_bf16_f32 v80, v80, v81
    v_cvt_pk_bf16_f32 v81, v82, v83
    ds_write_b64 v26, v[80:81] offset:256
    buffer_store_dwordx4 v[60:63], v4, s[12:15], s63 offen offset:2048 sc1
    v_pk_mul_f32 v[120:121], v[120:121], v[34:35] op_sel_hi:[1,0]
    v_pk_mul_f32 v[122:123], v[122:123], v[34:35] op_sel_hi:[1,0]
    v_pk_mul_f32 v[136:137], v[136:137], v[34:35] op_sel_hi:[1,0]
    v_pk_mul_f32 v[138:139], v[138:139], v[34:35] op_sel_hi:[1,0]
    v_cvt_pk_bf16_f32 v84, v84, v85
    v_cvt_pk_bf16_f32 v85, v86, v87
    ds_write_b64 v27, v[84:85] offset:0
    v_cvt_pk_bf16_f32 v152, v120, v121
    v_cvt_pk_bf16_f32 v153, v122, v123
    v_cvt_pk_bf16_f32 v154, v136, v137
    v_cvt_pk_bf16_f32 v155, v138, v139
    v_cvt_pk_bf16_f32 v88, v88, v89
    v_cvt_pk_bf16_f32 v89, v90, v91
    ds_write_b64 v27, v[88:89] offset:256
    v_pk_mul_f32 v[124:125], v[124:125], v[34:35] op_sel_hi:[1,0]
    v_pk_mul_f32 v[126:127], v[126:127], v[34:35] op_sel_hi:[1,0]
    v_pk_mul_f32 v[140:141], v[140:141], v[34:35] op_sel_hi:[1,0]
    v_pk_mul_f32 v[142:143], v[142:143], v[34:35] op_sel_hi:[1,0]
    v_cvt_pk_bf16_f32 v92, v92, v93
    v_cvt_pk_bf16_f32 v93, v94, v95
    ds_write_b64 v28, v[92:93] offset:0
    v_cvt_pk_bf16_f32 v156, v124, v125
    v_cvt_pk_bf16_f32 v157, v126, v127
    v_cvt_pk_bf16_f32 v158, v140, v141
    v_cvt_pk_bf16_f32 v159, v142, v143
    v_cvt_pk_bf16_f32 v96, v96, v97
    v_cvt_pk_bf16_f32 v97, v98, v99
    ds_write_b64 v28, v[96:97] offset:256
    buffer_store_dwordx4 v[64:67], v4, s[12:15], s63 offen offset:3072 sc1
    v_pk_mul_f32 v[128:129], v[128:129], v[34:35] op_sel_hi:[1,0]
    v_pk_mul_f32 v[130:131], v[130:131], v[34:35] op_sel_hi:[1,0]
    v_pk_mul_f32 v[144:145], v[144:145], v[34:35] op_sel_hi:[1,0]
    v_pk_mul_f32 v[146:147], v[146:147], v[34:35] op_sel_hi:[1,0]
    v_cvt_pk_bf16_f32 v100, v100, v101
    v_cvt_pk_bf16_f32 v101, v102, v103
    ds_write_b64 v29, v[100:101] offset:0
    v_cvt_pk_bf16_f32 v160, v128, v129
    v_cvt_pk_bf16_f32 v161, v130, v131
    v_cvt_pk_bf16_f32 v162, v144, v145
    v_cvt_pk_bf16_f32 v163, v146, v147
    v_cvt_pk_bf16_f32 v104, v104, v105
    v_cvt_pk_bf16_f32 v105, v106, v107
    ds_write_b64 v29, v[104:105] offset:256
    v_permlane16_swap_b32 v148, v152
    v_permlane16_swap_b32 v149, v153
    v_permlane16_swap_b32 v150, v154
    v_permlane16_swap_b32 v151, v155
    ds_write_b128 v12, v[148:151] offset:20480
    v_permlane16_swap_b32 v156, v160
    v_permlane16_swap_b32 v157, v161
    v_permlane16_swap_b32 v158, v162
    v_permlane16_swap_b32 v159, v163
    ds_write_b128 v12, v[152:155] offset:21504
    s_waitcnt vmcnt(8)
    v_dot2_f32_bf16 v6, v18, v244, v6
    v_dot2_f32_bf16 v7, v68, v244, v7
    v_dot2_f32_bf16 v6, v19, v245, v6
    v_dot2_f32_bf16 v7, v69, v245, v7
    v_dot2_f32_bf16 v6, v20, v246, v6
    v_dot2_f32_bf16 v7, v70, v246, v7
    ds_write_b128 v12, v[156:159] offset:22528
    v_dot2_f32_bf16 v6, v21, v247, v6
    v_dot2_f32_bf16 v7, v71, v247, v7
    v_dot2_f32_bf16 v6, v22, v248, v6
    v_dot2_f32_bf16 v7, v72, v248, v7
    v_dot2_f32_bf16 v6, v23, v249, v6
    v_dot2_f32_bf16 v7, v73, v249, v7
    ds_write_b128 v12, v[160:163] offset:23552
    v_dot2_f32_bf16 v6, v24, v250, v6
    v_dot2_f32_bf16 v7, v74, v250, v7
    v_dot2_f32_bf16 v6, v25, v251, v6
    v_dot2_f32_bf16 v7, v75, v251, v7
    s_waitcnt lgkmcnt(0)
    s_barrier
    ds_read_b64_tr_b16 v[68:69], v10 offset:0
    ds_read_b64_tr_b16 v[70:71], v10 offset:512
    ds_read_b64_tr_b16 v[76:77], v10 offset:2056
    ds_read_b64_tr_b16 v[78:79], v10 offset:2568
    ds_read_b64_tr_b16 v[72:73], v10 offset:1024
    ds_read_b64_tr_b16 v[74:75], v10 offset:1536
    ds_read_b64_tr_b16 v[80:81], v10 offset:3080
    ds_read_b64_tr_b16 v[82:83], v10 offset:3592
    v_cmp_ne_u32 vcc, 0, v254
    v_accvgpr_write_b32 a192, v36
    v_accvgpr_write_b32 a193, v37
    v_accvgpr_write_b32 a194, v38
    v_accvgpr_write_b32 a195, v39
    v_accvgpr_write_b32 a196, v40
    v_accvgpr_write_b32 a197, v41
    v_accvgpr_write_b32 a198, v42
    v_accvgpr_write_b32 a199, v43
    v_accvgpr_write_b32 a200, v44
    v_accvgpr_write_b32 a201, v45
    v_accvgpr_write_b32 a202, v46
    v_accvgpr_write_b32 a203, v47
    v_accvgpr_write_b32 a204, v48
    v_accvgpr_write_b32 a205, v49
    v_accvgpr_write_b32 a206, v50
    v_accvgpr_write_b32 a207, v51
    s_bcnt1_i32_b64 s55, vcc
    s_cmp_eq_u32 s55, 52
    s_cbranch_scc0 L_rdy_spin
L_rdy_ok:
    s_waitcnt lgkmcnt(4)
    v_mfma_f32_32x32x16_bf16 v[84:99], v[68:71], a[8:11], 0
    ds_read_b128 a[32:35], v13 offset:20480
    v_permlane32_swap_b32 v6, v7
    v_accvgpr_write_b32 a208, v52
    v_accvgpr_write_b32 a209, v53
    v_add_f32 v6, v6, v7
    v_accvgpr_write_b32 a210, v54
    v_mfma_f32_32x32x16_bf16 v[100:115], v[76:79], a[8:11], 0
    ds_read_b128 a[36:39], v13 offset:21504
    v_accvgpr_write_b32 a211, v55
    v_add_f32_dpp v6, v6, v6 row_shr:1 row_mask:0xf bank_mask:0xf bound_ctrl:1
    v_accvgpr_write_b32 a212, v56
    v_accvgpr_write_b32 a213, v57
    v_add_f32_dpp v6, v6, v6 row_shr:2 row_mask:0xf bank_mask:0xf bound_ctrl:1
    v_mfma_f32_32x32x16_bf16 v[84:99], v[76:79], a[16:19], v[84:99]
    ds_read_b128 a[40:43], v13 offset:22528
    v_accvgpr_write_b32 a214, v58
    v_accvgpr_write_b32 a215, v59
    v_add_f32_dpp v6, v6, v6 row_shr:4 row_mask:0xf bank_mask:0xf bound_ctrl:1
    v_accvgpr_write_b32 a216, v60
    v_accvgpr_write_b32 a217, v61
    v_mfma_f32_32x32x16_bf16 v[100:115], v[68:71], a[24:27], v[100:115]
    ds_read_b128 a[44:47], v13 offset:23552
    v_add_f32_dpp v6, v6, v6 row_shr:8 row_mask:0xf bank_mask:0xf bound_ctrl:1
    v_accvgpr_write_b32 a218, v62
    v_accvgpr_write_b32 a219, v63
    v_add_f32_dpp v6, v6, v6 row_bcast:15 row_mask:0xa bank_mask:0xf
    v_accvgpr_write_b32 a220, v64
    s_waitcnt lgkmcnt(4)
    v_mfma_f32_32x32x16_bf16 v[84:99], v[72:75], a[12:15], v[84:99]
    ds_read_b128 a[48:51], v12 offset:20480
    v_accvgpr_write_b32 a221, v65
    v_mul_f32 v6, 0xbfb8aa3b, v6
    v_accvgpr_write_b32 a222, v66
    v_accvgpr_write_b32 a223, v67
    v_exp_f32 v6, v6
    v_mfma_f32_32x32x16_bf16 v[100:115], v[80:83], a[12:15], v[100:115]
    ds_read_b128 a[52:55], v12 offset:21504
    v_mov_b32 v208, v17
    v_xor_b32 v209, 32, v17
    v_add_f32 v6, 1.0, v6
    v_mov_b32 v210, v30
    v_mov_b32 v211, v31
    v_mfma_f32_32x32x16_bf16 v[84:99], v[80:83], a[20:23], v[84:99]
    ds_read_b128 a[56:59], v12 offset:22528
    v_rcp_f32 v6, v6
    v_mov_b32 v133, 0
    v_mov_b32 v134, 0
    v_or_b32 v248, 0x80000000, v6
    v_mov_b32 v135, 0
    v_mfma_f32_32x32x16_bf16 v[100:115], v[72:75], a[28:31], v[100:115]
    ds_read_b128 a[60:63], v12 offset:23552
    v_mov_b32 v137, 0
    v_mov_b32 v138, 0
    v_mov_b32 v139, 0
    s_waitcnt vmcnt(0)
    buffer_store_dword v210, v211, s[32:35], s66 offen sc1
    s_waitcnt lgkmcnt(4)
    v_mfma_f32_32x32x16_bf16 v[144:159], a[192:195], a[32:35], 0
    s_nop 3
    v_mfma_f32_32x32x16_bf16 v[144:159], a[196:199], a[36:39], v[144:159]
    v_mul_f32 v116, v84, v212
    v_mul_f32 v117, v100, v212
    v_mul_f32 v118, v85, v213
    v_mul_f32 v119, v101, v213
    v_mul_f32 v120, v86, v214
    v_mul_f32 v121, v102, v214
    v_mul_f32 v122, v87, v215
    v_mul_f32 v123, v103, v215
    v_mfma_f32_32x32x16_bf16 v[160:175], a[192:195], a[40:43], 0
    v_mul_f32 v124, v88, v216
    v_mul_f32 v125, v104, v216
    v_mul_f32 v126, v89, v217
    v_mul_f32 v127, v105, v217
    v_mul_f32 v128, v90, v218
    v_mul_f32 v129, v106, v218
    v_mul_f32 v130, v91, v219
    v_mul_f32 v131, v107, v219
    v_mfma_f32_32x32x16_bf16 v[160:175], a[196:199], a[44:47], v[160:175]
    v_fmac_f32 v116, v100, v228
    v_fma_f32 v117, -v84, v228, v117
    v_fmac_f32 v118, v101, v229
    v_fma_f32 v119, -v85, v229, v119
    v_fmac_f32 v120, v102, v230
    v_fma_f32 v121, -v86, v230, v121
    v_fmac_f32 v122, v103, v231
    v_fma_f32 v123, -v87, v231, v123
    s_waitcnt lgkmcnt(0)
    v_mfma_f32_32x32x16_bf16 v[176:191], a[192:195], a[48:51], 0
    v_fmac_f32 v124, v104, v232
    v_fma_f32 v125, -v88, v232, v125
    v_fmac_f32 v126, v105, v233
    v_fma_f32 v127, -v89, v233, v127
    v_fmac_f32 v128, v106, v234
    v_fma_f32 v129, -v90, v234, v129
    v_fmac_f32 v130, v107, v235
    v_fma_f32 v131, -v91, v235, v131
    v_mfma_f32_32x32x16_bf16 v[176:191], a[196:199], a[52:55], v[176:191]
    v_cvt_pk_bf16_f32 v32, v116, v118
    v_cvt_pk_bf16_f32 v40, v117, v119
    v_cvt_pk_bf16_f32 v33, v120, v122
    v_cvt_pk_bf16_f32 v41, v121, v123
    v_cvt_pk_bf16_f32 v34, v124, v126
    v_cvt_pk_bf16_f32 v42, v125, v127
    v_cvt_pk_bf16_f32 v35, v128, v130
    v_cvt_pk_bf16_f32 v43, v129, v131
    v_mul_f32 v116, v92, v220
    v_mul_f32 v117, v108, v220
    v_mfma_f32_32x32x16_bf16 v[48:63], v[32:35], a[8:11], 0
    v_mul_f32 v118, v93, v221
    v_mul_f32 v119, v109, v221
    v_mul_f32 v120, v94, v222
    v_mul_f32 v121, v110, v222
    v_mul_f32 v122, v95, v223
    v_mul_f32 v123, v111, v223
    v_mul_f32 v124, v96, v224
    v_mfma_f32_32x32x16_bf16 v[64:79], v[40:43], a[8:11], 0
    v_mul_f32 v125, v112, v224
    v_mul_f32 v126, v97, v225
    v_mul_f32 v127, v113, v225
    v_mul_f32 v128, v98, v226
    v_mul_f32 v129, v114, v226
    v_mul_f32 v130, v99, v227
    v_mul_f32 v131, v115, v227
    v_mfma_f32_32x32x16_bf16 v[48:63], v[40:43], a[16:19], v[48:63]
    v_fmac_f32 v116, v108, v236
    v_fma_f32 v117, -v92, v236, v117
    v_fmac_f32 v118, v109, v237
    v_fma_f32 v119, -v93, v237, v119
    v_fmac_f32 v120, v110, v238
    v_fma_f32 v121, -v94, v238, v121
    v_fmac_f32 v122, v111, v239
    v_mfma_f32_32x32x16_bf16 v[64:79], v[32:35], a[24:27], v[64:79]
    v_fma_f32 v123, -v95, v239, v123
    v_fmac_f32 v124, v112, v240
    v_fma_f32 v125, -v96, v240, v125
    v_fmac_f32 v126, v113, v241
    v_fma_f32 v127, -v97, v241, v127
    v_fmac_f32 v128, v114, v242
    v_fma_f32 v129, -v98, v242, v129
    v_mfma_f32_32x32x16_bf16 v[192:207], a[192:195], a[56:59], 0
    v_fmac_f32 v130, v115, v243
    v_fma_f32 v131, -v99, v243, v131
    v_cvt_pk_bf16_f32 v36, v116, v118
    v_cvt_pk_bf16_f32 v44, v117, v119
    v_cvt_pk_bf16_f32 v37, v120, v122
    v_cvt_pk_bf16_f32 v45, v121, v123
    v_cvt_pk_bf16_f32 v38, v124, v126
    v_mfma_f32_32x32x16_bf16 v[192:207], a[196:199], a[60:63], v[192:207]
    v_cvt_pk_bf16_f32 v46, v125, v127
    v_cvt_pk_bf16_f32 v39, v128, v130
    v_cvt_pk_bf16_f32 v47, v129, v131
    v_max3_f32 v8, v144, v145, v146
    v_max3_f32 v8, v8, v147, v148
    v_mfma_f32_32x32x16_bf16 v[48:63], v[36:39], a[12:15], v[48:63]
    v_max3_f32 v8, v8, v149, v150
    v_max3_f32 v8, v8, v151, v152
    v_max3_f32 v8, v8, v153, v154
    v_max3_f32 v8, v8, v155, v156
    v_max3_f32 v8, v8, v157, v158
    v_max_f32 v8, v8, v159
    v_mfma_f32_32x32x16_bf16 v[64:79], v[44:47], a[12:15], v[64:79]
    v_max3_f32 v9, v160, v161, v162
    v_max3_f32 v9, v9, v163, v164
    v_max3_f32 v9, v9, v165, v166
    v_max3_f32 v9, v9, v167, v168
    v_max3_f32 v9, v9, v169, v170
    v_max3_f32 v9, v9, v171, v172
    v_mfma_f32_32x32x16_bf16 v[48:63], v[44:47], a[20:23], v[48:63]
    v_max3_f32 v9, v9, v173, v174
    v_max_f32 v9, v9, v175
    v_max3_f32 v10, v176, v177, v178
    v_max3_f32 v10, v10, v179, v180
    v_max3_f32 v10, v10, v181, v182
    v_max3_f32 v10, v10, v183, v184
    v_mfma_f32_32x32x16_bf16 v[64:79], v[36:39], a[28:31], v[64:79]
    v_max3_f32 v10, v10, v185, v186
    v_max3_f32 v10, v10, v187, v188
    v_max3_f32 v10, v10, v189, v190
    v_max_f32 v10, v10, v191
    v_max3_f32 v11, v192, v193, v194
    v_max3_f32 v11, v11, v195, v196
    s_mov_b32 s55, 0x42200000
    v_max3_f32 v11, v11, v197, v198
    v_max3_f32 v11, v11, v199, v200
    v_max3_f32 v11, v11, v201, v202
    v_max3_f32 v11, v11, v203, v204
    v_max3_f32 v11, v11, v205, v206
    v_max_f32 v11, v11, v207
    v_cvt_pk_bf16_f32 v132, v8, s55
    v_cvt_pk_bf16_f32 v136, v9, s55
    v_mov_b32 v13, v16
    v_mfma_f32_32x32x16_bf16 v[16:31], a[148:151], v[132:135], 0
    ds_bpermute_b32 v6, v1, v48
    ds_bpermute_b32 v7, v1, v64
    v_cvt_pk_bf16_f32 v96, v48, v49
    v_cvt_pk_bf16_f32 v97, v50, v51
    v_cvt_pk_bf16_f32 v98, v52, v53
    v_cvt_pk_bf16_f32 v99, v54, v55
    v_accvgpr_read_b32 v213, a96
    v_accvgpr_read_b32 v214, a97
    v_mfma_f32_32x32x16_bf16 v[32:47], a[148:151], v[136:139], 0
    ds_write_b128 v15, v[96:99] offset:0
    v_cvt_pk_bf16_f32 v100, v56, v57
    v_cvt_pk_bf16_f32 v101, v58, v59
    v_cvt_pk_bf16_f32 v102, v60, v61
    v_cvt_pk_bf16_f32 v103, v62, v63
    v_accvgpr_read_b32 v215, a98
    v_accvgpr_read_b32 v216, a99
    v_accvgpr_read_b32 v217, a100
    v_mfma_f32_32x32x16_bf16 v[144:159], a[152:155], a[152:155], 0
    ds_write_b128 v13, v[100:103] offset:0
    v_cvt_pk_bf16_f32 v104, -v64, -v65
    v_cvt_pk_bf16_f32 v105, -v66, -v67
    v_cvt_pk_bf16_f32 v106, -v68, -v69
    v_cvt_pk_bf16_f32 v107, -v70, -v71
    v_accvgpr_read_b32 v236, a101
    v_accvgpr_read_b32 v237, a102
    v_accvgpr_read_b32 v238, a103
    v_mfma_f32_32x32x16_bf16 v[160:175], a[152:155], a[152:155], 0
    ds_write_b128 v15, v[104:107] offset:2048
    v_cvt_pk_bf16_f32 v108, -v72, -v73
    v_cvt_pk_bf16_f32 v109, -v74, -v75
    v_cvt_pk_bf16_f32 v110, -v76, -v77
    v_cvt_pk_bf16_f32 v111, -v78, -v79
    v_accvgpr_read_b32 v239, a104
    v_accvgpr_read_b32 v230, a105
    v_accvgpr_read_b32 v218, a106
    v_cvt_pk_bf16_f32 v132, v10, s55
    v_cvt_pk_bf16_f32 v136, v11, s55
    v_mfma_f32_32x32x16_bf16 v[80:95], a[192:195], a[32:35], v[16:31]
    s_waitcnt lgkmcnt(3)
    ds_write_b128 v13, v[108:111] offset:2048
    v_cvt_pk_bf16_f32 v112, v6, v63
    v_cvt_pk_bf16_f32 v113, v62, v61
    v_cvt_pk_bf16_f32 v114, v60, v59
    v_cvt_pk_bf16_f32 v115, v58, v57
    v_accvgpr_read_b32 v240, a107
    v_accvgpr_read_b32 v242, a108
    v_accvgpr_read_b32 v243, a109
    v_mfma_f32_32x32x16_bf16 v[80:95], a[196:199], a[36:39], v[80:95]
    ds_write_b128 v2, v[112:115] offset:16384
    v_cvt_pk_bf16_f32 v116, v56, v55
    v_cvt_pk_bf16_f32 v117, v54, v53
    v_cvt_pk_bf16_f32 v118, v52, v51
    v_cvt_pk_bf16_f32 v119, v50, v49
    v_accvgpr_read_b32 v244, a110
    v_accvgpr_read_b32 v245, a111
    v_mov_b32 v231, 0xdddddddd
    v_mfma_f32_32x32x16_bf16 v[176:191], a[152:155], a[152:155], 0
    ds_write_b128 v3, v[116:119] offset:16384
    v_cvt_pk_bf16_f32 v120, v7, v79
    v_cvt_pk_bf16_f32 v121, v78, v77
    v_cvt_pk_bf16_f32 v122, v76, v75
    v_cvt_pk_bf16_f32 v123, v74, v73
    v_and_b32 v235, 31, v0
    v_lshlrev_b32 v235, 2, v235
    v_lshrrev_b32 v234, 5, v0
    v_mfma_f32_32x32x16_bf16 v[48:63], a[148:151], v[132:135], 0
    ds_write_b128 v2, v[120:123] offset:18432
    v_cvt_pk_bf16_f32 v124, v72, v71
    v_cvt_pk_bf16_f32 v125, v70, v69
    v_cvt_pk_bf16_f32 v126, v68, v67
    v_cvt_pk_bf16_f32 v127, v66, v65
    v_lshl_add_u32 v229, v234, 20, v235
    v_lshl_add_u32 v235, v234, 7, v235
    v_xor_b32 v246, 1024, v245
    v_mfma_f32_32x32x16_bf16 v[192:207], a[152:155], a[152:155], 0
    ds_write_b128 v3, v[124:127] offset:18432
    v_xor_b32 v219, 4096, v218
    v_xor_b32 v241, 4096, v240
    buffer_load_dword v212, v213, s[32:35], s67 offen sc1
    v_mfma_f32_32x32x16_bf16 v[64:79], a[148:151], v[136:139], 0
    v_mfma_f32_32x32x16_bf16 v[96:111], a[192:195], a[40:43], v[32:47]
    v_exp_f32 v80, v80
    v_exp_f32 v81, v81
    v_exp_f32 v82, v82
    v_mfma_f32_32x32x16_bf16 v[96:111], a[196:199], a[44:47], v[96:111]
    v_exp_f32 v83, v83
    v_exp_f32 v84, v84
    v_exp_f32 v85, v85
    v_exp_f32 v86, v86
    v_exp_f32 v87, v87
    v_exp_f32 v88, v88
    v_exp_f32 v89, v89
    v_smfmac_f32_32x32x32_bf16 v[144:159], a[200:203], v[80:87], v231
    v_exp_f32 v90, v90
    v_exp_f32 v91, v91
    v_exp_f32 v92, v92
    v_smfmac_f32_16x16x64_bf16 a[128:131], a[144:147], v[80:87], v231
    v_exp_f32 v93, v93
    v_exp_f32 v94, v94
    v_exp_f32 v95, v95
    v_mfma_f32_32x32x16_bf16 v[112:127], a[192:195], a[48:51], v[48:63]
    v_exp_f32 v96, v96
    v_exp_f32 v97, v97
    v_exp_f32 v98, v98
    v_mfma_f32_32x32x16_bf16 v[112:127], a[196:199], a[52:55], v[112:127]
    v_exp_f32 v99, v99
    v_exp_f32 v100, v100
    v_exp_f32 v101, v101
    v_smfmac_f32_32x32x32_bf16 v[144:159], a[204:207], v[88:95], v231
    v_exp_f32 v102, v102
    v_exp_f32 v103, v103
    v_exp_f32 v104, v104
    v_smfmac_f32_16x16x64_bf16 a[128:131], a[144:147], v[88:95], v231
    v_exp_f32 v105, v105
    v_smfmac_f32_32x32x32_bf16 v[160:175], a[200:203], v[96:103], v231
    v_exp_f32 v106, v106
    v_exp_f32 v107, v107
    v_exp_f32 v108, v108
    v_smfmac_f32_16x16x64_bf16 a[132:135], a[144:147], v[96:103], v231
    v_exp_f32 v109, v109
    v_exp_f32 v110, v110
    v_exp_f32 v111, v111
    v_mfma_f32_32x32x16_bf16 v[128:143], a[192:195], a[56:59], v[64:79]
    s_add_u32 s68, s68, 1
    v_exp_f32 v112, v112
    v_exp_f32 v113, v113
    v_exp_f32 v114, v114
    v_mfma_f32_32x32x16_bf16 v[128:143], a[196:199], a[60:63], v[128:143]
    s_cmp_eq_u32 s68, s37
    v_exp_f32 v115, v115
    v_exp_f32 v116, v116
    v_exp_f32 v117, v117
    v_smfmac_f32_32x32x32_bf16 v[160:175], a[204:207], v[104:111], v231
    s_waitcnt vmcnt(0)
    v_cmp_ne_u32 vcc, 0, v212
    s_addc_u32 s68, s68, 0
    s_lshl_b32 s69, s68, 13
    v_exp_f32 v118, v118
    v_exp_f32 v119, v119
    v_exp_f32 v120, v120
    v_smfmac_f32_16x16x64_bf16 a[132:135], a[144:147], v[104:111], v231
    s_mov_b32 s71, vcc_lo
    s_xor_b32 s69, s69, s36
    v_exp_f32 v121, v121
    v_smfmac_f32_32x32x32_bf16 v[176:191], a[200:203], v[112:119], v231
    s_bitcmp1_b32 s71, s68
    s_cbranch_scc0 L_kv1_spin
L_kv1_ok:
    v_exp_f32 v122, v122
    v_exp_f32 v123, v123
    v_exp_f32 v124, v124
    v_smfmac_f32_16x16x64_bf16 a[136:139], a[144:147], v[112:119], v231
    buffer_load_dwordx4 a[96:99], v4, s[12:15], s69 offen offset:0 sc1
    v_exp_f32 v125, v125
    v_exp_f32 v126, v126
    v_exp_f32 v127, v127
    v_mfma_f32_32x32x16_bf16 v[80:95], a[208:211], a[32:35], v[16:31]
    v_exp_f32 v128, v128
    v_exp_f32 v129, v129
    v_exp_f32 v130, v130
    v_mfma_f32_32x32x16_bf16 v[80:95], a[212:215], a[36:39], v[80:95]
    v_exp_f32 v131, v131
    v_exp_f32 v132, v132
    v_exp_f32 v133, v133
    v_smfmac_f32_32x32x32_bf16 v[176:191], a[204:207], v[120:127], v231
    v_exp_f32 v134, v134
    v_exp_f32 v135, v135
    v_exp_f32 v136, v136
    v_smfmac_f32_16x16x64_bf16 a[136:139], a[144:147], v[120:127], v231
    buffer_load_dwordx4 a[100:103], v4, s[12:15], s69 offen offset:1024 sc1
    v_exp_f32 v137, v137
    v_smfmac_f32_32x32x32_bf16 v[192:207], a[200:203], v[128:135], v231
    v_exp_f32 v138, v138
    v_exp_f32 v139, v139
    v_exp_f32 v140, v140
    v_smfmac_f32_16x16x64_bf16 a[140:143], a[144:147], v[128:135], v231
    buffer_load_dwordx4 a[104:107], v4, s[12:15], s69 offen offset:2048 sc1
    v_exp_f32 v141, v141
    v_exp_f32 v142, v142
    v_exp_f32 v143, v143
    v_mfma_f32_32x32x16_bf16 v[96:111], a[208:211], a[40:43], v[32:47]
    v_exp_f32 v80, v80
    v_exp_f32 v81, v81
    v_exp_f32 v82, v82
    v_mfma_f32_32x32x16_bf16 v[96:111], a[212:215], a[44:47], v[96:111]
    v_exp_f32 v83, v83
    v_exp_f32 v84, v84
    v_exp_f32 v85, v85
    v_smfmac_f32_32x32x32_bf16 v[192:207], a[204:207], v[136:143], v231
    v_exp_f32 v86, v86
    v_exp_f32 v87, v87
    v_exp_f32 v88, v88
    v_smfmac_f32_16x16x64_bf16 a[140:143], a[144:147], v[136:143], v231
    buffer_load_dwordx4 a[108:111], v4, s[12:15], s69 offen offset:3072 sc1
    v_exp_f32 v89, v89
    v_smfmac_f32_32x32x32_bf16 v[144:159], a[216:219], v[80:87], v231
    s_add_u32 s69, s69, 4096
    v_exp_f32 v90, v90
    v_exp_f32 v91, v91
    v_exp_f32 v92, v92
    v_smfmac_f32_16x16x64_bf16 a[128:131], a[144:147], v[80:87], v231
    buffer_load_dwordx4 a[112:115], v4, s[12:15], s69 offen offset:0 sc1
    v_exp_f32 v93, v93
    v_exp_f32 v94, v94
    v_exp_f32 v95, v95
    v_mfma_f32_32x32x16_bf16 v[112:127], a[208:211], a[48:51], v[48:63]
    v_exp_f32 v96, v96
    v_exp_f32 v97, v97
    v_exp_f32 v98, v98
    v_mfma_f32_32x32x16_bf16 v[112:127], a[212:215], a[52:55], v[112:127]
    v_exp_f32 v99, v99
    v_exp_f32 v100, v100
    v_exp_f32 v101, v101
    v_smfmac_f32_32x32x32_bf16 v[144:159], a[220:223], v[88:95], v231
    v_exp_f32 v102, v102
    v_exp_f32 v103, v103
    v_exp_f32 v104, v104
    v_smfmac_f32_16x16x64_bf16 a[128:131], a[144:147], v[88:95], v231
    buffer_load_dwordx4 a[116:119], v4, s[12:15], s69 offen offset:1024 sc1
    v_exp_f32 v105, v105
    v_smfmac_f32_32x32x32_bf16 v[160:175], a[216:219], v[96:103], v231
    v_exp_f32 v106, v106
    v_exp_f32 v107, v107
    v_exp_f32 v108, v108
    v_smfmac_f32_16x16x64_bf16 a[132:135], a[144:147], v[96:103], v231
    buffer_load_dwordx4 a[120:123], v4, s[12:15], s69 offen offset:2048 sc1
    v_exp_f32 v109, v109
    v_exp_f32 v110, v110
    v_exp_f32 v111, v111
    v_mfma_f32_32x32x16_bf16 v[128:143], a[208:211], a[56:59], v[64:79]
    v_exp_f32 v112, v112
    v_exp_f32 v113, v113
    v_exp_f32 v114, v114
    v_mfma_f32_32x32x16_bf16 v[128:143], a[212:215], a[60:63], v[128:143]
    v_exp_f32 v115, v115
    v_exp_f32 v116, v116
    v_exp_f32 v117, v117
    v_smfmac_f32_32x32x32_bf16 v[160:175], a[220:223], v[104:111], v231
L_pg4:
    s_cbranch_execz L_pg8
    v_exp_f32 v118, v118
    v_exp_f32 v119, v119
    v_exp_f32 v120, v120
    v_smfmac_f32_16x16x64_bf16 a[132:135], a[144:147], v[104:111], v231
    buffer_load_dwordx4 a[124:127], v4, s[12:15], s69 offen offset:3072 sc1
    v_exp_f32 v121, v121
    v_smfmac_f32_32x32x32_bf16 v[176:191], a[216:219], v[112:119], v231
    s_waitcnt vmcnt(6)
    s_add_u32 s68, s68, 1
    s_cmp_eq_u32 s68, s37
    s_addc_u32 s68, s68, 0
    s_lshl_b32 s69, s68, 13
    s_xor_b32 s69, s69, s36
    s_bitcmp1_b32 s71, s68
    s_cbranch_scc0 L_kv2_spin
L_kv2_ok:
    v_exp_f32 v122, v122
    v_exp_f32 v123, v123
    v_exp_f32 v124, v124
    v_smfmac_f32_16x16x64_bf16 a[136:139], a[144:147], v[112:119], v231
    buffer_load_dwordx4 a[64:67], v4, s[12:15], s69 offen offset:0 sc1
    v_exp_f32 v125, v125
    v_exp_f32 v126, v126
    v_exp_f32 v127, v127
    v_mfma_f32_32x32x16_bf16 v[80:95], a[96:99], a[32:35], v[16:31]
    v_exp_f32 v128, v128
    v_exp_f32 v129, v129
    v_exp_f32 v130, v130
    v_mfma_f32_32x32x16_bf16 v[80:95], a[100:103], a[36:39], v[80:95]
    v_exp_f32 v131, v131
    v_exp_f32 v132, v132
    v_exp_f32 v133, v133
    v_smfmac_f32_32x32x32_bf16 v[176:191], a[220:223], v[120:127], v231
    v_exp_f32 v134, v134
    v_exp_f32 v135, v135
    v_exp_f32 v136, v136
    v_smfmac_f32_16x16x64_bf16 a[136:139], a[144:147], v[120:127], v231
    buffer_load_dwordx4 a[68:71], v4, s[12:15], s69 offen offset:1024 sc1
    v_exp_f32 v137, v137
    v_smfmac_f32_32x32x32_bf16 v[192:207], a[216:219], v[128:135], v231
    v_exp_f32 v138, v138
    v_exp_f32 v139, v139
    v_exp_f32 v140, v140
    v_smfmac_f32_16x16x64_bf16 a[140:143], a[144:147], v[128:135], v231
    buffer_load_dwordx4 a[72:75], v4, s[12:15], s69 offen offset:2048 sc1
    v_exp_f32 v141, v141
    v_exp_f32 v142, v142
    v_exp_f32 v143, v143
    v_mfma_f32_32x32x16_bf16 v[96:111], a[96:99], a[40:43], v[32:47]
    buffer_load_dword v212, v213, s[32:35], s67 offen sc1
    v_exp_f32 v80, v80
    v_exp_f32 v81, v81
    v_exp_f32 v82, v82
    v_mfma_f32_32x32x16_bf16 v[96:111], a[100:103], a[44:47], v[96:111]
    s_waitcnt vmcnt(8)
    v_exp_f32 v83, v83
    v_exp_f32 v84, v84
    v_exp_f32 v85, v85
    v_smfmac_f32_32x32x32_bf16 v[192:207], a[220:223], v[136:143], v231
    v_exp_f32 v86, v86
    v_exp_f32 v87, v87
    v_exp_f32 v88, v88
    v_smfmac_f32_16x16x64_bf16 a[140:143], a[144:147], v[136:143], v231
    buffer_load_dwordx4 a[76:79], v4, s[12:15], s69 offen offset:3072 sc1
    v_exp_f32 v89, v89
    v_smfmac_f32_32x32x32_bf16 v[144:159], a[104:107], v[80:87], v231
    s_add_u32 s69, s69, 4096
    v_exp_f32 v90, v90
    v_exp_f32 v91, v91
    v_exp_f32 v92, v92
    v_smfmac_f32_16x16x64_bf16 a[128:131], a[144:147], v[80:87], v231
    buffer_load_dwordx4 a[80:83], v4, s[12:15], s69 offen offset:0 sc1
    v_exp_f32 v93, v93
    v_exp_f32 v94, v94
    v_exp_f32 v95, v95
    v_mfma_f32_32x32x16_bf16 v[112:127], a[96:99], a[48:51], v[48:63]
    v_exp_f32 v96, v96
    v_exp_f32 v97, v97
    v_exp_f32 v98, v98
    v_mfma_f32_32x32x16_bf16 v[112:127], a[100:103], a[52:55], v[112:127]
    v_exp_f32 v99, v99
    v_exp_f32 v100, v100
    v_exp_f32 v101, v101
    v_smfmac_f32_32x32x32_bf16 v[144:159], a[108:111], v[88:95], v231
    v_exp_f32 v102, v102
    v_exp_f32 v103, v103
    v_exp_f32 v104, v104
    v_smfmac_f32_16x16x64_bf16 a[128:131], a[144:147], v[88:95], v231
    buffer_load_dwordx4 a[84:87], v4, s[12:15], s69 offen offset:1024 sc1
    v_exp_f32 v105, v105
    v_smfmac_f32_32x32x32_bf16 v[160:175], a[104:107], v[96:103], v231
    v_exp_f32 v106, v106
    v_exp_f32 v107, v107
    v_exp_f32 v108, v108
    v_smfmac_f32_16x16x64_bf16 a[132:135], a[144:147], v[96:103], v231
    buffer_load_dwordx4 a[88:91], v4, s[12:15], s69 offen offset:2048 sc1
    v_exp_f32 v109, v109
    v_exp_f32 v110, v110
    v_exp_f32 v111, v111
    v_mfma_f32_32x32x16_bf16 v[128:143], a[96:99], a[56:59], v[64:79]
    v_exp_f32 v112, v112
    v_exp_f32 v113, v113
    v_exp_f32 v114, v114
    v_mfma_f32_32x32x16_bf16 v[128:143], a[100:103], a[60:63], v[128:143]
    v_exp_f32 v115, v115
    v_exp_f32 v116, v116
    v_exp_f32 v117, v117
    v_smfmac_f32_32x32x32_bf16 v[160:175], a[108:111], v[104:111], v231
    v_exp_f32 v118, v118
    v_exp_f32 v119, v119
    v_exp_f32 v120, v120
    v_smfmac_f32_16x16x64_bf16 a[132:135], a[144:147], v[104:111], v231
    buffer_store_dwordx4 a[192:195], v4, s[12:15], s38 offen offset:0 sc1
    v_exp_f32 v121, v121
    v_smfmac_f32_32x32x32_bf16 v[176:191], a[104:107], v[112:119], v231
    s_waitcnt vmcnt(11)
    v_exp_f32 v122, v122
    v_exp_f32 v123, v123
    v_exp_f32 v124, v124
    v_smfmac_f32_16x16x64_bf16 a[136:139], a[144:147], v[112:119], v231
    buffer_load_dwordx4 a[92:95], v4, s[12:15], s69 offen offset:3072 sc1
    v_exp_f32 v125, v125
    v_exp_f32 v126, v126
    v_exp_f32 v127, v127
    v_mfma_f32_32x32x16_bf16 v[80:95], a[112:115], a[32:35], v[16:31]
    v_exp_f32 v128, v128
    v_exp_f32 v129, v129
    v_exp_f32 v130, v130
    v_mfma_f32_32x32x16_bf16 v[80:95], a[116:119], a[36:39], v[80:95]
    v_exp_f32 v131, v131
    v_exp_f32 v132, v132
    v_exp_f32 v133, v133
    v_smfmac_f32_32x32x32_bf16 v[176:191], a[108:111], v[120:127], v231
    s_waitcnt vmcnt(6)
    v_cmp_ne_u32 vcc, 0, v212
    v_exp_f32 v134, v134
    v_exp_f32 v135, v135
    v_exp_f32 v136, v136
    v_smfmac_f32_16x16x64_bf16 a[136:139], a[144:147], v[120:127], v231
    v_exp_f32 v137, v137
    v_smfmac_f32_32x32x32_bf16 v[192:207], a[104:107], v[128:135], v231
    s_mov_b32 s71, vcc_lo
    v_exp_f32 v138, v138
    v_exp_f32 v139, v139
    v_exp_f32 v140, v140
    v_smfmac_f32_16x16x64_bf16 a[140:143], a[144:147], v[128:135], v231
    v_exp_f32 v141, v141
    v_exp_f32 v142, v142
    v_exp_f32 v143, v143
    v_mfma_f32_32x32x16_bf16 v[96:111], a[112:115], a[40:43], v[32:47]
    s_add_u32 s68, s68, 1
    v_exp_f32 v80, v80
    v_exp_f32 v81, v81
    v_exp_f32 v82, v82
    v_mfma_f32_32x32x16_bf16 v[96:111], a[116:119], a[44:47], v[96:111]
    s_cmp_eq_u32 s68, s37
    v_exp_f32 v83, v83
    v_exp_f32 v84, v84
    v_exp_f32 v85, v85
    v_smfmac_f32_32x32x32_bf16 v[192:207], a[108:111], v[136:143], v231
    s_addc_u32 s68, s68, 0
    s_lshl_b32 s69, s68, 13
    v_exp_f32 v86, v86
    v_exp_f32 v87, v87
    v_exp_f32 v88, v88
    v_smfmac_f32_16x16x64_bf16 a[140:143], a[144:147], v[136:143], v231
    buffer_store_dwordx4 a[196:199], v4, s[12:15], s38 offen offset:1024 sc1
    s_xor_b32 s69, s69, s36
    v_exp_f32 v89, v89
    v_smfmac_f32_32x32x32_bf16 v[144:159], a[120:123], v[80:87], v231
    s_bitcmp1_b32 s71, s68
    s_cbranch_scc0 L_kv3_spin
L_kv3_ok:
    v_exp_f32 v90, v90
    v_exp_f32 v91, v91
    v_exp_f32 v92, v92
    v_smfmac_f32_16x16x64_bf16 a[128:131], a[144:147], v[80:87], v231
    buffer_load_dwordx4 a[96:99], v4, s[12:15], s69 offen offset:0 sc1
    v_exp_f32 v93, v93
    v_exp_f32 v94, v94
    v_exp_f32 v95, v95
    v_mfma_f32_32x32x16_bf16 v[112:127], a[112:115], a[48:51], v[48:63]
    v_exp_f32 v96, v96
    v_exp_f32 v97, v97
    v_exp_f32 v98, v98
    v_mfma_f32_32x32x16_bf16 v[112:127], a[116:119], a[52:55], v[112:127]
    v_exp_f32 v99, v99
    v_exp_f32 v100, v100
    v_exp_f32 v101, v101
    v_smfmac_f32_32x32x32_bf16 v[144:159], a[124:127], v[88:95], v231
    v_exp_f32 v102, v102
    v_exp_f32 v103, v103
    v_exp_f32 v104, v104
    v_smfmac_f32_16x16x64_bf16 a[128:131], a[144:147], v[88:95], v231
    v_exp_f32 v105, v105
    v_smfmac_f32_32x32x32_bf16 v[160:175], a[120:123], v[96:103], v231
    v_exp_f32 v106, v106
    v_exp_f32 v107, v107
    v_exp_f32 v108, v108
    v_smfmac_f32_16x16x64_bf16 a[132:135], a[144:147], v[96:103], v231
    buffer_load_dwordx4 a[100:103], v4, s[12:15], s69 offen offset:1024 sc1
    v_exp_f32 v109, v109
    v_exp_f32 v110, v110
    v_exp_f32 v111, v111
    v_mfma_f32_32x32x16_bf16 v[128:143], a[112:115], a[56:59], v[64:79]
    v_exp_f32 v112, v112
    v_exp_f32 v113, v113
    v_exp_f32 v114, v114
    v_mfma_f32_32x32x16_bf16 v[128:143], a[116:119], a[60:63], v[128:143]
    v_exp_f32 v115, v115
    v_exp_f32 v116, v116
    v_exp_f32 v117, v117
    v_smfmac_f32_32x32x32_bf16 v[160:175], a[124:127], v[104:111], v231
    v_exp_f32 v118, v118
    v_exp_f32 v119, v119
    v_exp_f32 v120, v120
    v_smfmac_f32_16x16x64_bf16 a[132:135], a[144:147], v[104:111], v231
    buffer_store_dwordx4 a[200:203], v4, s[12:15], s38 offen offset:2048 sc1
    v_exp_f32 v121, v121
    v_smfmac_f32_32x32x32_bf16 v[176:191], a[120:123], v[112:119], v231
    s_waitcnt vmcnt(9)
    v_exp_f32 v122, v122
    v_exp_f32 v123, v123
    v_exp_f32 v124, v124
    v_smfmac_f32_16x16x64_bf16 a[136:139], a[144:147], v[112:119], v231
    buffer_load_dwordx4 a[104:107], v4, s[12:15], s69 offen offset:2048 sc1
    v_exp_f32 v125, v125
    v_exp_f32 v126, v126
    v_exp_f32 v127, v127
    v_mfma_f32_32x32x16_bf16 v[80:95], a[64:67], a[32:35], v[16:31]
    v_exp_f32 v128, v128
    v_exp_f32 v129, v129
    v_exp_f32 v130, v130
    v_mfma_f32_32x32x16_bf16 v[80:95], a[68:71], a[36:39], v[80:95]
    v_exp_f32 v131, v131
    v_exp_f32 v132, v132
    v_exp_f32 v133, v133
    v_smfmac_f32_32x32x32_bf16 v[176:191], a[124:127], v[120:127], v231
    v_exp_f32 v134, v134
    v_exp_f32 v135, v135
    v_exp_f32 v136, v136
    v_smfmac_f32_16x16x64_bf16 a[136:139], a[144:147], v[120:127], v231
    v_exp_f32 v137, v137
    v_smfmac_f32_32x32x32_bf16 v[192:207], a[120:123], v[128:135], v231
    v_exp_f32 v138, v138
    v_exp_f32 v139, v139
    v_exp_f32 v140, v140
    v_smfmac_f32_16x16x64_bf16 a[140:143], a[144:147], v[128:135], v231
    buffer_load_dwordx4 a[108:111], v4, s[12:15], s69 offen offset:3072 sc1
    v_exp_f32 v141, v141
    v_exp_f32 v142, v142
    v_exp_f32 v143, v143
    v_mfma_f32_32x32x16_bf16 v[96:111], a[64:67], a[40:43], v[32:47]
    s_add_u32 s69, s69, 4096
    v_exp_f32 v80, v80
    v_exp_f32 v81, v81
    v_exp_f32 v82, v82
    v_mfma_f32_32x32x16_bf16 v[96:111], a[68:71], a[44:47], v[96:111]
    v_exp_f32 v83, v83
    v_exp_f32 v84, v84
    v_exp_f32 v85, v85
    v_smfmac_f32_32x32x32_bf16 v[192:207], a[124:127], v[136:143], v231
    v_exp_f32 v86, v86
    v_exp_f32 v87, v87
    v_exp_f32 v88, v88
    v_smfmac_f32_16x16x64_bf16 a[140:143], a[144:147], v[136:143], v231
    buffer_store_dwordx4 a[204:207], v4, s[12:15], s38 offen offset:3072 sc1
    v_exp_f32 v89, v89
    v_smfmac_f32_32x32x32_bf16 v[144:159], a[72:75], v[80:87], v231
    v_exp_f32 v90, v90
    v_exp_f32 v91, v91
    v_exp_f32 v92, v92
    v_smfmac_f32_16x16x64_bf16 a[128:131], a[144:147], v[80:87], v231
    buffer_load_dwordx4 a[112:115], v4, s[12:15], s69 offen offset:0 sc1
    v_exp_f32 v93, v93
    v_exp_f32 v94, v94
    v_exp_f32 v95, v95
    v_mfma_f32_32x32x16_bf16 v[112:127], a[64:67], a[48:51], v[48:63]
    v_exp_f32 v96, v96
    v_exp_f32 v97, v97
    v_exp_f32 v98, v98
    v_mfma_f32_32x32x16_bf16 v[112:127], a[68:71], a[52:55], v[112:127]
    v_exp_f32 v99, v99
    v_exp_f32 v100, v100
    v_exp_f32 v101, v101
    v_smfmac_f32_32x32x32_bf16 v[144:159], a[76:79], v[88:95], v231
    v_exp_f32 v102, v102
    v_exp_f32 v103, v103
    v_exp_f32 v104, v104
    v_smfmac_f32_16x16x64_bf16 a[128:131], a[144:147], v[88:95], v231
    v_exp_f32 v105, v105
    v_smfmac_f32_32x32x32_bf16 v[160:175], a[72:75], v[96:103], v231
    v_exp_f32 v106, v106
    v_exp_f32 v107, v107
    v_exp_f32 v108, v108
    v_smfmac_f32_16x16x64_bf16 a[132:135], a[144:147], v[96:103], v231
    buffer_load_dwordx4 a[116:119], v4, s[12:15], s69 offen offset:1024 sc1
    v_exp_f32 v109, v109
    v_exp_f32 v110, v110
    v_exp_f32 v111, v111
    v_mfma_f32_32x32x16_bf16 v[128:143], a[64:67], a[56:59], v[64:79]
    v_exp_f32 v112, v112
    v_exp_f32 v113, v113
    v_exp_f32 v114, v114
    v_mfma_f32_32x32x16_bf16 v[128:143], a[68:71], a[60:63], v[128:143]
    v_exp_f32 v115, v115
    v_exp_f32 v116, v116
    v_exp_f32 v117, v117
    v_smfmac_f32_32x32x32_bf16 v[160:175], a[76:79], v[104:111], v231
    v_exp_f32 v118, v118
    v_exp_f32 v119, v119
    v_exp_f32 v120, v120
    v_smfmac_f32_16x16x64_bf16 a[132:135], a[144:147], v[104:111], v231
    buffer_store_dwordx4 a[208:211], v4, s[12:15], s39 offen offset:0 sc1
    v_exp_f32 v121, v121
    v_smfmac_f32_32x32x32_bf16 v[176:191], a[72:75], v[112:119], v231
    s_waitcnt vmcnt(10)
    v_exp_f32 v122, v122
    v_exp_f32 v123, v123
    v_exp_f32 v124, v124
    v_smfmac_f32_16x16x64_bf16 a[136:139], a[144:147], v[112:119], v231
    buffer_load_dwordx4 a[120:123], v4, s[12:15], s69 offen offset:2048 sc1
    v_exp_f32 v125, v125
    v_exp_f32 v126, v126
    v_exp_f32 v127, v127
    v_mfma_f32_32x32x16_bf16 v[80:95], a[80:83], a[32:35], v[16:31]
    v_exp_f32 v128, v128
    v_exp_f32 v129, v129
    v_exp_f32 v130, v130
    v_mfma_f32_32x32x16_bf16 v[80:95], a[84:87], a[36:39], v[80:95]
    v_exp_f32 v131, v131
    v_exp_f32 v132, v132
    v_exp_f32 v133, v133
    v_smfmac_f32_32x32x32_bf16 v[176:191], a[76:79], v[120:127], v231
    v_exp_f32 v134, v134
    v_exp_f32 v135, v135
    v_exp_f32 v136, v136
    v_smfmac_f32_16x16x64_bf16 a[136:139], a[144:147], v[120:127], v231
    v_exp_f32 v137, v137
    v_smfmac_f32_32x32x32_bf16 v[192:207], a[72:75], v[128:135], v231
    v_exp_f32 v138, v138
    v_exp_f32 v139, v139
    v_exp_f32 v140, v140
    v_smfmac_f32_16x16x64_bf16 a[140:143], a[144:147], v[128:135], v231
    buffer_load_dwordx4 a[124:127], v4, s[12:15], s69 offen offset:3072 sc1
    v_exp_f32 v141, v141
    v_exp_f32 v142, v142
    v_exp_f32 v143, v143
    v_mfma_f32_32x32x16_bf16 v[96:111], a[80:83], a[40:43], v[32:47]
    s_add_u32 s68, s68, 1
    v_exp_f32 v80, v80
    v_exp_f32 v81, v81
    v_exp_f32 v82, v82
    v_mfma_f32_32x32x16_bf16 v[96:111], a[84:87], a[44:47], v[96:111]
    s_cmp_eq_u32 s68, s37
    v_exp_f32 v83, v83
    v_exp_f32 v84, v84
    v_exp_f32 v85, v85
    v_smfmac_f32_32x32x32_bf16 v[192:207], a[76:79], v[136:143], v231
    s_addc_u32 s68, s68, 0
    s_lshl_b32 s69, s68, 13
    v_exp_f32 v86, v86
    v_exp_f32 v87, v87
    v_exp_f32 v88, v88
    v_smfmac_f32_16x16x64_bf16 a[140:143], a[144:147], v[136:143], v231
    buffer_store_dwordx4 a[212:215], v4, s[12:15], s39 offen offset:1024 sc1
    s_xor_b32 s69, s69, s36
    v_exp_f32 v89, v89
    v_smfmac_f32_32x32x32_bf16 v[144:159], a[88:91], v[80:87], v231
    s_bitcmp1_b32 s71, s68
    s_cbranch_scc0 L_kv4_spin
L_kv4_ok:
    v_exp_f32 v90, v90
    v_exp_f32 v91, v91
    v_exp_f32 v92, v92
    v_smfmac_f32_16x16x64_bf16 a[128:131], a[144:147], v[80:87], v231
    buffer_load_dwordx4 a[64:67], v4, s[12:15], s69 offen offset:0 sc1
    v_exp_f32 v93, v93
    v_exp_f32 v94, v94
    v_exp_f32 v95, v95
    v_mfma_f32_32x32x16_bf16 v[112:127], a[80:83], a[48:51], v[48:63]
    v_exp_f32 v96, v96
    v_exp_f32 v97, v97
    v_exp_f32 v98, v98
    v_mfma_f32_32x32x16_bf16 v[112:127], a[84:87], a[52:55], v[112:127]
    v_exp_f32 v99, v99
    v_exp_f32 v100, v100
    v_exp_f32 v101, v101
    v_smfmac_f32_32x32x32_bf16 v[144:159], a[92:95], v[88:95], v231
    v_exp_f32 v102, v102
    v_exp_f32 v103, v103
    v_exp_f32 v104, v104
    v_smfmac_f32_16x16x64_bf16 a[128:131], a[144:147], v[88:95], v231
    v_exp_f32 v105, v105
    v_smfmac_f32_32x32x32_bf16 v[160:175], a[88:91], v[96:103], v231
    v_exp_f32 v106, v106
    v_exp_f32 v107, v107
    v_exp_f32 v108, v108
    v_smfmac_f32_16x16x64_bf16 a[132:135], a[144:147], v[96:103], v231
    buffer_load_dwordx4 a[68:71], v4, s[12:15], s69 offen offset:1024 sc1
    v_exp_f32 v109, v109
    v_exp_f32 v110, v110
    v_exp_f32 v111, v111
    v_mfma_f32_32x32x16_bf16 v[128:143], a[80:83], a[56:59], v[64:79]
    v_exp_f32 v112, v112
    v_exp_f32 v113, v113
    v_exp_f32 v114, v114
    v_mfma_f32_32x32x16_bf16 v[128:143], a[84:87], a[60:63], v[128:143]
    v_exp_f32 v115, v115
    v_exp_f32 v116, v116
    v_exp_f32 v117, v117
    v_smfmac_f32_32x32x32_bf16 v[160:175], a[92:95], v[104:111], v231
    v_exp_f32 v118, v118
    v_exp_f32 v119, v119
    v_exp_f32 v120, v120
    v_smfmac_f32_16x16x64_bf16 a[132:135], a[144:147], v[104:111], v231
    buffer_store_dwordx4 a[216:219], v4, s[12:15], s39 offen offset:2048 sc1
    v_exp_f32 v121, v121
    v_smfmac_f32_32x32x32_bf16 v[176:191], a[88:91], v[112:119], v231
    s_waitcnt vmcnt(10)
    v_exp_f32 v122, v122
    v_exp_f32 v123, v123
    v_exp_f32 v124, v124
    v_smfmac_f32_16x16x64_bf16 a[136:139], a[144:147], v[112:119], v231
    buffer_load_dwordx4 a[72:75], v4, s[12:15], s69 offen offset:2048 sc1
    v_exp_f32 v125, v125
    v_exp_f32 v126, v126
    v_exp_f32 v127, v127
    v_mfma_f32_32x32x16_bf16 v[80:95], a[96:99], a[32:35], v[16:31]
    v_exp_f32 v128, v128
    v_exp_f32 v129, v129
    v_exp_f32 v130, v130
    v_mfma_f32_32x32x16_bf16 v[80:95], a[100:103], a[36:39], v[80:95]
    v_exp_f32 v131, v131
    v_exp_f32 v132, v132
    v_exp_f32 v133, v133
    v_smfmac_f32_32x32x32_bf16 v[176:191], a[92:95], v[120:127], v231
    v_exp_f32 v134, v134
    v_exp_f32 v135, v135
    v_exp_f32 v136, v136
    v_smfmac_f32_16x16x64_bf16 a[136:139], a[144:147], v[120:127], v231
    buffer_load_dword v212, v213, s[32:35], s67 offen sc1
    v_exp_f32 v137, v137
    v_smfmac_f32_32x32x32_bf16 v[192:207], a[88:91], v[128:135], v231
    v_exp_f32 v138, v138
    v_exp_f32 v139, v139
    v_exp_f32 v140, v140
    v_smfmac_f32_16x16x64_bf16 a[140:143], a[144:147], v[128:135], v231
    buffer_load_dwordx4 a[76:79], v4, s[12:15], s69 offen offset:3072 sc1
    v_exp_f32 v141, v141
    v_exp_f32 v142, v142
    v_exp_f32 v143, v143
    v_mfma_f32_32x32x16_bf16 v[96:111], a[96:99], a[40:43], v[32:47]
    s_add_u32 s69, s69, 4096
    v_exp_f32 v80, v80
    v_exp_f32 v81, v81
    v_exp_f32 v82, v82
    v_mfma_f32_32x32x16_bf16 v[96:111], a[100:103], a[44:47], v[96:111]
    v_exp_f32 v83, v83
    v_exp_f32 v84, v84
    v_exp_f32 v85, v85
    v_smfmac_f32_32x32x32_bf16 v[192:207], a[92:95], v[136:143], v231
    s_barrier
    v_exp_f32 v86, v86
    v_exp_f32 v87, v87
    v_exp_f32 v88, v88
    v_smfmac_f32_16x16x64_bf16 a[140:143], a[144:147], v[136:143], v231
    buffer_store_dwordx4 a[220:223], v4, s[12:15], s39 offen offset:3072 sc1
    v_exp_f32 v89, v89
    v_smfmac_f32_32x32x32_bf16 v[144:159], a[104:107], v[80:87], v231
    v_exp_f32 v90, v90
    v_exp_f32 v91, v91
    v_exp_f32 v92, v92
    v_smfmac_f32_16x16x64_bf16 a[128:131], a[144:147], v[80:87], v231
    buffer_load_dwordx4 a[80:83], v4, s[12:15], s69 offen offset:0 sc1
    v_exp_f32 v93, v93
    v_exp_f32 v94, v94
    v_exp_f32 v95, v95
    v_mfma_f32_32x32x16_bf16 v[112:127], a[96:99], a[48:51], v[48:63]
    s_xor_b32 s55, s73, s72
    v_exp_f32 v96, v96
    v_exp_f32 v97, v97
    v_exp_f32 v98, v98
    v_mfma_f32_32x32x16_bf16 v[112:127], a[100:103], a[52:55], v[112:127]
    s_lshl_b32 s74, s55, 4
    v_exp_f32 v99, v99
    v_exp_f32 v100, v100
    v_exp_f32 v101, v101
    v_smfmac_f32_32x32x32_bf16 v[144:159], a[108:111], v[88:95], v231
    s_mov_b32 m0, s73
    s_add_u32 s73, s73, 16384
    v_exp_f32 v102, v102
    v_exp_f32 v103, v103
    v_exp_f32 v104, v104
    v_smfmac_f32_16x16x64_bf16 a[128:131], a[144:147], v[88:95], v231
    buffer_load_dwordx4 v214, s[16:19], s74 offen offset:0 lds
    v_exp_f32 v105, v105
    v_smfmac_f32_32x32x32_bf16 v[160:175], a[104:107], v[96:103], v231
    v_exp_f32 v106, v106
    v_exp_f32 v107, v107
    v_exp_f32 v108, v108
    v_smfmac_f32_16x16x64_bf16 a[132:135], a[144:147], v[96:103], v231
    buffer_load_dwordx4 a[84:87], v4, s[12:15], s69 offen offset:1024 sc1
    v_exp_f32 v109, v109
    v_exp_f32 v110, v110
    v_exp_f32 v111, v111
    v_mfma_f32_32x32x16_bf16 v[128:143], a[96:99], a[56:59], v[64:79]
    v_exp_f32 v112, v112
    v_exp_f32 v113, v113
    v_exp_f32 v114, v114
    v_mfma_f32_32x32x16_bf16 v[128:143], a[100:103], a[60:63], v[128:143]
    v_exp_f32 v115, v115
    v_exp_f32 v116, v116
    v_exp_f32 v117, v117
    v_smfmac_f32_32x32x32_bf16 v[160:175], a[108:111], v[104:111], v231
    v_exp_f32 v118, v118
    v_exp_f32 v119, v119
    v_exp_f32 v120, v120
    v_smfmac_f32_16x16x64_bf16 a[132:135], a[144:147], v[104:111], v231
    buffer_load_dwordx4 v215, s[16:19], s74 offen offset:1024 lds
    v_exp_f32 v121, v121
    v_smfmac_f32_32x32x32_bf16 v[176:191], a[104:107], v[112:119], v231
    s_waitcnt vmcnt(12)
    v_exp_f32 v122, v122
    v_exp_f32 v123, v123
    v_exp_f32 v124, v124
    v_smfmac_f32_16x16x64_bf16 a[136:139], a[144:147], v[112:119], v231
    buffer_load_dwordx4 a[88:91], v4, s[12:15], s69 offen offset:2048 sc1
    v_exp_f32 v125, v125
    v_exp_f32 v126, v126
    v_exp_f32 v127, v127
    v_mfma_f32_32x32x16_bf16 v[80:95], a[112:115], a[32:35], v[16:31]
    s_waitcnt vmcnt(7)
    v_cmp_ne_u32 vcc, 0, v212
    v_exp_f32 v128, v128
    v_exp_f32 v129, v129
    v_exp_f32 v130, v130
    v_mfma_f32_32x32x16_bf16 v[80:95], a[116:119], a[36:39], v[80:95]
    s_mov_b32 s71, vcc_lo
    v_exp_f32 v131, v131
    v_exp_f32 v132, v132
    v_exp_f32 v133, v133
    v_smfmac_f32_32x32x32_bf16 v[176:191], a[108:111], v[120:127], v231
    v_exp_f32 v134, v134
    v_exp_f32 v135, v135
    v_exp_f32 v136, v136
    v_smfmac_f32_16x16x64_bf16 a[136:139], a[144:147], v[120:127], v231
    buffer_store_dword v248, v14, s[32:35], s65 offen sc1
    v_exp_f32 v137, v137
    v_smfmac_f32_32x32x32_bf16 v[192:207], a[104:107], v[128:135], v231
    v_exp_f32 v138, v138
    v_exp_f32 v139, v139
    v_exp_f32 v140, v140
    v_smfmac_f32_16x16x64_bf16 a[140:143], a[144:147], v[128:135], v231
    buffer_load_dwordx4 a[92:95], v4, s[12:15], s69 offen offset:3072 sc1
    v_exp_f32 v141, v141
    v_exp_f32 v142, v142
    v_exp_f32 v143, v143
    v_mfma_f32_32x32x16_bf16 v[96:111], a[112:115], a[40:43], v[32:47]
    s_add_u32 s68, s68, 1
    v_exp_f32 v80, v80
    v_exp_f32 v81, v81
    v_exp_f32 v82, v82
    v_mfma_f32_32x32x16_bf16 v[96:111], a[116:119], a[44:47], v[96:111]
    s_cmp_eq_u32 s68, s37
    v_exp_f32 v83, v83
    v_exp_f32 v84, v84
    v_exp_f32 v85, v85
    v_smfmac_f32_32x32x32_bf16 v[192:207], a[108:111], v[136:143], v231
    s_addc_u32 s68, s68, 0
    s_lshl_b32 s69, s68, 13
    v_exp_f32 v86, v86
    v_exp_f32 v87, v87
    v_exp_f32 v88, v88
    v_smfmac_f32_16x16x64_bf16 a[140:143], a[144:147], v[136:143], v231
    s_xor_b32 s69, s69, s36
    v_exp_f32 v89, v89
    v_smfmac_f32_32x32x32_bf16 v[144:159], a[120:123], v[80:87], v231
    s_andn2_b32 s55, 255, s71
    s_cbranch_scc1 L_kv5_spin
L_kv5_ok:
    v_exp_f32 v90, v90
    v_exp_f32 v91, v91
    v_exp_f32 v92, v92
    v_smfmac_f32_16x16x64_bf16 a[128:131], a[144:147], v[80:87], v231
    buffer_load_dwordx4 a[96:99], v4, s[12:15], s69 offen offset:0 sc1
    v_exp_f32 v93, v93
    v_exp_f32 v94, v94
    v_exp_f32 v95, v95
    v_mfma_f32_32x32x16_bf16 v[112:127], a[112:115], a[48:51], v[48:63]
    v_exp_f32 v96, v96
    v_exp_f32 v97, v97
    v_exp_f32 v98, v98
    v_mfma_f32_32x32x16_bf16 v[112:127], a[116:119], a[52:55], v[112:127]
    v_exp_f32 v99, v99
    v_exp_f32 v100, v100
    v_exp_f32 v101, v101
    v_smfmac_f32_32x32x32_bf16 v[144:159], a[124:127], v[88:95], v231
    v_exp_f32 v102, v102
    v_exp_f32 v103, v103
    v_exp_f32 v104, v104
    v_smfmac_f32_16x16x64_bf16 a[128:131], a[144:147], v[88:95], v231
    buffer_load_dwordx4 v216, s[16:19], s74 offen offset:2048 lds
    v_exp_f32 v105, v105
    v_smfmac_f32_32x32x32_bf16 v[160:175], a[120:123], v[96:103], v231
    v_exp_f32 v106, v106
    v_exp_f32 v107, v107
    v_exp_f32 v108, v108
    v_smfmac_f32_16x16x64_bf16 a[132:135], a[144:147], v[96:103], v231
    buffer_load_dwordx4 a[100:103], v4, s[12:15], s69 offen offset:1024 sc1
    v_exp_f32 v109, v109
    v_exp_f32 v110, v110
    v_exp_f32 v111, v111
    v_mfma_f32_32x32x16_bf16 v[128:143], a[112:115], a[56:59], v[64:79]
    v_exp_f32 v112, v112
    v_exp_f32 v113, v113
    v_exp_f32 v114, v114
    v_mfma_f32_32x32x16_bf16 v[128:143], a[116:119], a[60:63], v[128:143]
    v_exp_f32 v115, v115
    v_exp_f32 v116, v116
    v_exp_f32 v117, v117
    v_smfmac_f32_32x32x32_bf16 v[160:175], a[124:127], v[104:111], v231
    v_exp_f32 v118, v118
    v_exp_f32 v119, v119
    v_exp_f32 v120, v120
    v_smfmac_f32_16x16x64_bf16 a[132:135], a[144:147], v[104:111], v231
    buffer_load_dwordx4 v217, s[16:19], s74 offen offset:3072 lds
    v_exp_f32 v121, v121
    v_smfmac_f32_32x32x32_bf16 v[176:191], a[120:123], v[112:119], v231
    s_waitcnt vmcnt(12)
    v_exp_f32 v122, v122
    v_exp_f32 v123, v123
    v_exp_f32 v124, v124
    v_smfmac_f32_16x16x64_bf16 a[136:139], a[144:147], v[112:119], v231
    buffer_load_dwordx4 a[104:107], v4, s[12:15], s69 offen offset:2048 sc1
    v_exp_f32 v125, v125
    v_exp_f32 v126, v126
    v_exp_f32 v127, v127
    v_mfma_f32_32x32x16_bf16 v[80:95], a[64:67], a[32:35], v[16:31]
    s_mov_b32 s59, 0x800
    v_exp_f32 v128, v128
    v_exp_f32 v129, v129
    v_exp_f32 v130, v130
    v_mfma_f32_32x32x16_bf16 v[80:95], a[68:71], a[36:39], v[80:95]
    v_exp_f32 v131, v131
    v_exp_f32 v132, v132
    v_exp_f32 v133, v133
    v_smfmac_f32_32x32x32_bf16 v[176:191], a[124:127], v[120:127], v231
    v_exp_f32 v134, v134
    v_exp_f32 v135, v135
    v_exp_f32 v136, v136
    v_smfmac_f32_16x16x64_bf16 a[136:139], a[144:147], v[120:127], v231
    s_waitcnt vmcnt(12)
    buffer_store_dword v210, v211, s[32:35], s0 offen sc1
    v_exp_f32 v137, v137
    v_smfmac_f32_32x32x32_bf16 v[192:207], a[120:123], v[128:135], v231
    v_exp_f32 v138, v138
    v_exp_f32 v139, v139
    v_exp_f32 v140, v140
    v_smfmac_f32_16x16x64_bf16 a[140:143], a[144:147], v[128:135], v231
    buffer_load_dwordx4 a[108:111], v4, s[12:15], s69 offen offset:3072 sc1
    v_exp_f32 v141, v141
    v_exp_f32 v142, v142
    v_exp_f32 v143, v143
L_att_loop:
    v_mfma_f32_32x32x16_bf16 v[96:111], a[64:67], a[40:43], v[32:47]
    s_add_u32 s69, s69, 4096
    v_exp_f32 v80, v80
    v_exp_f32 v81, v81
    v_exp_f32 v82, v82
    v_mfma_f32_32x32x16_bf16 v[96:111], a[68:71], a[44:47], v[96:111]
    v_exp_f32 v83, v83
    v_exp_f32 v84, v84
    v_exp_f32 v85, v85
    v_smfmac_f32_32x32x32_bf16 v[192:207], a[124:127], v[136:143], v231
    v_exp_f32 v86, v86
    v_exp_f32 v87, v87
    v_exp_f32 v88, v88
    v_smfmac_f32_16x16x64_bf16 a[140:143], a[144:147], v[136:143], v231
    v_exp_f32 v89, v89
    v_smfmac_f32_32x32x32_bf16 v[144:159], a[72:75], v[80:87], v231
    v_exp_f32 v90, v90
    v_exp_f32 v91, v91
    v_exp_f32 v92, v92
    v_smfmac_f32_16x16x64_bf16 a[128:131], a[144:147], v[80:87], v231
    buffer_load_dwordx4 a[112:115], v4, s[12:15], s69 offen offset:0 sc1
    v_exp_f32 v93, v93
    v_exp_f32 v94, v94
    v_exp_f32 v95, v95
    v_mfma_f32_32x32x16_bf16 v[112:127], a[64:67], a[48:51], v[48:63]
    s_xor_b32 s55, s73, s72
    v_exp_f32 v96, v96
    v_exp_f32 v97, v97
    v_exp_f32 v98, v98
    v_mfma_f32_32x32x16_bf16 v[112:127], a[68:71], a[52:55], v[112:127]
    s_lshl_b32 s74, s55, 4
    v_exp_f32 v99, v99
    v_exp_f32 v100, v100
    v_exp_f32 v101, v101
    v_smfmac_f32_32x32x32_bf16 v[144:159], a[76:79], v[88:95], v231
    s_mov_b32 m0, s73
    v_exp_f32 v102, v102
    v_exp_f32 v103, v103
    v_exp_f32 v104, v104
    v_smfmac_f32_16x16x64_bf16 a[128:131], a[144:147], v[88:95], v231
    ds_read_b128 v[220:223], v208 offset:0
    v_exp_f32 v105, v105
    v_smfmac_f32_32x32x32_bf16 v[160:175], a[72:75], v[96:103], v231
    s_add_u32 s73, s73, 16384
    v_exp_f32 v106, v106
    v_exp_f32 v107, v107
    v_exp_f32 v108, v108
    v_smfmac_f32_16x16x64_bf16 a[132:135], a[144:147], v[96:103], v231
    buffer_load_dwordx4 a[116:119], v4, s[12:15], s69 offen offset:1024 sc1
    v_exp_f32 v109, v109
    v_exp_f32 v110, v110
    v_exp_f32 v111, v111
    v_mfma_f32_32x32x16_bf16 v[128:143], a[64:67], a[56:59], v[64:79]
    v_exp_f32 v112, v112
    v_exp_f32 v113, v113
    v_exp_f32 v114, v114
    v_mfma_f32_32x32x16_bf16 v[128:143], a[68:71], a[60:63], v[128:143]
    v_exp_f32 v115, v115
    v_exp_f32 v116, v116
    v_exp_f32 v117, v117
    v_smfmac_f32_32x32x32_bf16 v[160:175], a[76:79], v[104:111], v231
    s_waitcnt lgkmcnt(0)
    v_exp_f32 v118, v118
    v_exp_f32 v119, v119
    v_exp_f32 v120, v120
    v_smfmac_f32_16x16x64_bf16 a[132:135], a[144:147], v[104:111], v231
    buffer_store_dwordx4 v[220:223], v4, s[12:15], s76 offen offset:0 sc1
    v_exp_f32 v121, v121
    v_smfmac_f32_32x32x32_bf16 v[176:191], a[72:75], v[112:119], v231
    s_waitcnt vmcnt(7)
    v_exp_f32 v122, v122
    v_exp_f32 v123, v123
    v_exp_f32 v124, v124
    v_smfmac_f32_16x16x64_bf16 a[136:139], a[144:147], v[112:119], v231
    buffer_load_dwordx4 a[120:123], v4, s[12:15], s69 offen offset:2048 sc1
    v_exp_f32 v125, v125
    v_exp_f32 v126, v126
    v_exp_f32 v127, v127
    v_mfma_f32_32x32x16_bf16 v[80:95], a[80:83], a[32:35], v[16:31]
    v_exp_f32 v128, v128
    v_exp_f32 v129, v129
    v_exp_f32 v130, v130
    v_mfma_f32_32x32x16_bf16 v[80:95], a[84:87], a[36:39], v[80:95]
    v_exp_f32 v131, v131
    v_exp_f32 v132, v132
    v_exp_f32 v133, v133
    v_smfmac_f32_32x32x32_bf16 v[176:191], a[76:79], v[120:127], v231
    v_exp_f32 v134, v134
    v_exp_f32 v135, v135
    v_exp_f32 v136, v136
    v_smfmac_f32_16x16x64_bf16 a[136:139], a[144:147], v[120:127], v231
    buffer_load_dwordx4 v214, s[16:19], s74 offen offset:0 lds
    v_exp_f32 v137, v137
    v_smfmac_f32_32x32x32_bf16 v[192:207], a[72:75], v[128:135], v231
    v_exp_f32 v138, v138
    v_exp_f32 v139, v139
    v_exp_f32 v140, v140
    v_smfmac_f32_16x16x64_bf16 a[140:143], a[144:147], v[128:135], v231
    buffer_load_dwordx4 a[124:127], v4, s[12:15], s69 offen offset:3072 sc1
    v_exp_f32 v141, v141
    v_exp_f32 v142, v142
    v_exp_f32 v143, v143
    v_mfma_f32_32x32x16_bf16 v[96:111], a[80:83], a[40:43], v[32:47]
    s_add_u32 s68, s68, 1
    v_exp_f32 v80, v80
    v_exp_f32 v81, v81
    v_exp_f32 v82, v82
    v_mfma_f32_32x32x16_bf16 v[96:111], a[84:87], a[44:47], v[96:111]
    s_cmp_eq_u32 s68, s37
    v_exp_f32 v83, v83
    v_exp_f32 v84, v84
    v_exp_f32 v85, v85
    v_smfmac_f32_32x32x32_bf16 v[192:207], a[76:79], v[136:143], v231
    s_addc_u32 s68, s68, 0
    s_lshl_b32 s69, s68, 13
    v_exp_f32 v86, v86
    v_exp_f32 v87, v87
    v_exp_f32 v88, v88
    v_smfmac_f32_16x16x64_bf16 a[140:143], a[144:147], v[136:143], v231
    s_xor_b32 s69, s69, s36
    v_exp_f32 v89, v89
    v_smfmac_f32_32x32x32_bf16 v[144:159], a[88:91], v[80:87], v231
L_pg5:
    s_cbranch_execz L_main
    s_andn2_b32 s55, s43, s71
    s_cbranch_scc1 L_kv6_spin
L_kv6_ok:
    v_exp_f32 v90, v90
    v_exp_f32 v91, v91
    v_exp_f32 v92, v92
    v_smfmac_f32_16x16x64_bf16 a[128:131], a[144:147], v[80:87], v231
    buffer_load_dwordx4 a[64:67], v4, s[12:15], s69 offen offset:0 sc1
    v_exp_f32 v93, v93
    v_exp_f32 v94, v94
    v_exp_f32 v95, v95
    v_mfma_f32_32x32x16_bf16 v[112:127], a[80:83], a[48:51], v[48:63]
    v_exp_f32 v96, v96
    v_exp_f32 v97, v97
    v_exp_f32 v98, v98
    v_mfma_f32_32x32x16_bf16 v[112:127], a[84:87], a[52:55], v[112:127]
    v_exp_f32 v99, v99
    v_exp_f32 v100, v100
    v_exp_f32 v101, v101
    v_smfmac_f32_32x32x32_bf16 v[144:159], a[92:95], v[88:95], v231
    v_exp_f32 v102, v102
    v_exp_f32 v103, v103
    v_exp_f32 v104, v104
    v_smfmac_f32_16x16x64_bf16 a[128:131], a[144:147], v[88:95], v231
    ds_read_b128 v[220:223], v209 offset:1024
    v_exp_f32 v105, v105
    v_smfmac_f32_32x32x32_bf16 v[160:175], a[88:91], v[96:103], v231
    v_exp_f32 v106, v106
    v_exp_f32 v107, v107
    v_exp_f32 v108, v108
    v_smfmac_f32_16x16x64_bf16 a[132:135], a[144:147], v[96:103], v231
    buffer_load_dwordx4 a[68:71], v4, s[12:15], s69 offen offset:1024 sc1
    v_exp_f32 v109, v109
    v_exp_f32 v110, v110
    v_exp_f32 v111, v111
    v_mfma_f32_32x32x16_bf16 v[128:143], a[80:83], a[56:59], v[64:79]
    v_exp_f32 v112, v112
    v_exp_f32 v113, v113
    v_exp_f32 v114, v114
    v_mfma_f32_32x32x16_bf16 v[128:143], a[84:87], a[60:63], v[128:143]
    v_exp_f32 v115, v115
    v_exp_f32 v116, v116
    v_exp_f32 v117, v117
    v_smfmac_f32_32x32x32_bf16 v[160:175], a[92:95], v[104:111], v231
    s_waitcnt lgkmcnt(0)
    v_exp_f32 v118, v118
    v_exp_f32 v119, v119
    v_exp_f32 v120, v120
    v_smfmac_f32_16x16x64_bf16 a[132:135], a[144:147], v[104:111], v231
    buffer_store_dwordx4 v[220:223], v4, s[12:15], s76 offen offset:1024 sc1
    v_exp_f32 v121, v121
    v_smfmac_f32_32x32x32_bf16 v[176:191], a[88:91], v[112:119], v231
    s_waitcnt vmcnt(9)
    v_exp_f32 v122, v122
    v_exp_f32 v123, v123
    v_exp_f32 v124, v124
    v_smfmac_f32_16x16x64_bf16 a[136:139], a[144:147], v[112:119], v231
    buffer_load_dwordx4 a[72:75], v4, s[12:15], s69 offen offset:2048 sc1
    v_exp_f32 v125, v125
    v_exp_f32 v126, v126
    v_exp_f32 v127, v127
    v_mfma_f32_32x32x16_bf16 v[80:95], a[96:99], a[32:35], v[16:31]
    v_exp_f32 v128, v128
    v_exp_f32 v129, v129
    v_exp_f32 v130, v130
    v_mfma_f32_32x32x16_bf16 v[80:95], a[100:103], a[36:39], v[80:95]
    v_exp_f32 v131, v131
    v_exp_f32 v132, v132
    v_exp_f32 v133, v133
    v_smfmac_f32_32x32x32_bf16 v[176:191], a[92:95], v[120:127], v231
    v_exp_f32 v134, v134
    v_exp_f32 v135, v135
    v_exp_f32 v136, v136
    v_smfmac_f32_16x16x64_bf16 a[136:139], a[144:147], v[120:127], v231
    buffer_load_dwordx4 v215, s[16:19], s74 offen offset:1024 lds
    v_exp_f32 v137, v137
    v_smfmac_f32_32x32x32_bf16 v[192:207], a[88:91], v[128:135], v231
    v_exp_f32 v138, v138
    v_exp_f32 v139, v139
    v_exp_f32 v140, v140
    v_smfmac_f32_16x16x64_bf16 a[140:143], a[144:147], v[128:135], v231
    buffer_load_dwordx4 a[76:79], v4, s[12:15], s69 offen offset:3072 sc1
    v_exp_f32 v141, v141
    v_exp_f32 v142, v142
    v_exp_f32 v143, v143
    v_mfma_f32_32x32x16_bf16 v[96:111], a[96:99], a[40:43], v[32:47]
    s_add_u32 s69, s69, 4096
    v_exp_f32 v80, v80
    v_exp_f32 v81, v81
    v_exp_f32 v82, v82
    v_mfma_f32_32x32x16_bf16 v[96:111], a[100:103], a[44:47], v[96:111]
    v_exp_f32 v83, v83
    v_exp_f32 v84, v84
    v_exp_f32 v85, v85
    v_smfmac_f32_32x32x32_bf16 v[192:207], a[92:95], v[136:143], v231
    v_exp_f32 v86, v86
    v_exp_f32 v87, v87
    v_exp_f32 v88, v88
    v_smfmac_f32_16x16x64_bf16 a[140:143], a[144:147], v[136:143], v231
    v_exp_f32 v89, v89
    v_smfmac_f32_32x32x32_bf16 v[144:159], a[104:107], v[80:87], v231
    v_exp_f32 v90, v90
    v_exp_f32 v91, v91
    v_exp_f32 v92, v92
    v_smfmac_f32_16x16x64_bf16 a[128:131], a[144:147], v[80:87], v231
    buffer_load_dwordx4 a[80:83], v4, s[12:15], s69 offen offset:0 sc1
    v_exp_f32 v93, v93
    v_exp_f32 v94, v94
    v_exp_f32 v95, v95
    v_mfma_f32_32x32x16_bf16 v[112:127], a[96:99], a[48:51], v[48:63]
    s_sub_u32 s70, s70, 1
    v_exp_f32 v96, v96
    v_exp_f32 v97, v97
    v_exp_f32 v98, v98
    v_mfma_f32_32x32x16_bf16 v[112:127], a[100:103], a[52:55], v[112:127]
    v_exp_f32 v99, v99
    v_exp_f32 v100, v100
    v_exp_f32 v101, v101
    v_smfmac_f32_32x32x32_bf16 v[144:159], a[108:111], v[88:95], v231
    v_exp_f32 v102, v102
    v_exp_f32 v103, v103
    v_exp_f32 v104, v104
    v_smfmac_f32_16x16x64_bf16 a[128:131], a[144:147], v[88:95], v231
    v_exp_f32 v105, v105
    v_smfmac_f32_32x32x32_bf16 v[160:175], a[104:107], v[96:103], v231
    v_exp_f32 v106, v106
    v_exp_f32 v107, v107
    v_exp_f32 v108, v108
    v_smfmac_f32_16x16x64_bf16 a[132:135], a[144:147], v[96:103], v231
    buffer_load_dwordx4 a[84:87], v4, s[12:15], s69 offen offset:1024 sc1
    v_exp_f32 v109, v109
    v_exp_f32 v110, v110
    v_exp_f32 v111, v111
    v_mfma_f32_32x32x16_bf16 v[128:143], a[96:99], a[56:59], v[64:79]
    v_add_u32 v208, s59, v208
    v_exp_f32 v112, v112
    v_exp_f32 v113, v113
    v_exp_f32 v114, v114
    v_mfma_f32_32x32x16_bf16 v[128:143], a[100:103], a[60:63], v[128:143]
    v_add_u32 v209, s59, v209
    v_exp_f32 v115, v115
    v_exp_f32 v116, v116
    v_exp_f32 v117, v117
    v_smfmac_f32_32x32x32_bf16 v[160:175], a[108:111], v[104:111], v231
    v_exp_f32 v118, v118
    v_exp_f32 v119, v119
    v_exp_f32 v120, v120
    v_smfmac_f32_16x16x64_bf16 a[132:135], a[144:147], v[104:111], v231
    buffer_load_dword v212, v213, s[32:35], s67 offen sc1
    v_exp_f32 v121, v121
    v_smfmac_f32_32x32x32_bf16 v[176:191], a[104:107], v[112:119], v231
    s_waitcnt vmcnt(9)
    v_exp_f32 v122, v122
    v_exp_f32 v123, v123
    v_exp_f32 v124, v124
    v_smfmac_f32_16x16x64_bf16 a[136:139], a[144:147], v[112:119], v231
    buffer_load_dwordx4 a[88:91], v4, s[12:15], s69 offen offset:2048 sc1
    v_exp_f32 v125, v125
    v_exp_f32 v126, v126
    v_exp_f32 v127, v127
    v_mfma_f32_32x32x16_bf16 v[80:95], a[112:115], a[32:35], v[16:31]
    s_xor_b32 s59, s59, 0x3000
    v_exp_f32 v128, v128
    v_exp_f32 v129, v129
    v_exp_f32 v130, v130
    v_mfma_f32_32x32x16_bf16 v[80:95], a[116:119], a[36:39], v[80:95]
    v_exp_f32 v131, v131
    v_exp_f32 v132, v132
    v_exp_f32 v133, v133
    v_smfmac_f32_32x32x32_bf16 v[176:191], a[108:111], v[120:127], v231
    v_exp_f32 v134, v134
    v_exp_f32 v135, v135
    v_exp_f32 v136, v136
    v_smfmac_f32_16x16x64_bf16 a[136:139], a[144:147], v[120:127], v231
    buffer_load_dwordx4 v216, s[16:19], s74 offen offset:2048 lds
    v_exp_f32 v137, v137
    v_smfmac_f32_32x32x32_bf16 v[192:207], a[104:107], v[128:135], v231
    v_exp_f32 v138, v138
    v_exp_f32 v139, v139
    v_exp_f32 v140, v140
    v_smfmac_f32_16x16x64_bf16 a[140:143], a[144:147], v[128:135], v231
    buffer_load_dwordx4 a[92:95], v4, s[12:15], s69 offen offset:3072 sc1
    v_exp_f32 v141, v141
    v_exp_f32 v142, v142
    v_exp_f32 v143, v143
    v_mfma_f32_32x32x16_bf16 v[96:111], a[112:115], a[40:43], v[32:47]
    s_add_u32 s68, s68, 1
    v_exp_f32 v80, v80
    v_exp_f32 v81, v81
    v_exp_f32 v82, v82
    v_mfma_f32_32x32x16_bf16 v[96:111], a[116:119], a[44:47], v[96:111]
    s_cmp_eq_u32 s68, s37
    v_exp_f32 v83, v83
    v_exp_f32 v84, v84
    v_exp_f32 v85, v85
    v_smfmac_f32_32x32x32_bf16 v[192:207], a[108:111], v[136:143], v231
    s_addc_u32 s68, s68, 0
    s_lshl_b32 s69, s68, 13
    v_exp_f32 v86, v86
    v_exp_f32 v87, v87
    v_exp_f32 v88, v88
    v_smfmac_f32_16x16x64_bf16 a[140:143], a[144:147], v[136:143], v231
    s_xor_b32 s69, s69, s36
    v_exp_f32 v89, v89
    v_smfmac_f32_32x32x32_bf16 v[144:159], a[120:123], v[80:87], v231
    s_mov_b32 s43, 0xffff
    v_exp_f32 v90, v90
    v_exp_f32 v91, v91
    v_exp_f32 v92, v92
    v_smfmac_f32_16x16x64_bf16 a[128:131], a[144:147], v[80:87], v231
    buffer_load_dwordx4 a[96:99], v4, s[12:15], s69 offen offset:0 sc1
    v_exp_f32 v93, v93
    v_exp_f32 v94, v94
    v_exp_f32 v95, v95
    v_mfma_f32_32x32x16_bf16 v[112:127], a[112:115], a[48:51], v[48:63]
    s_mov_b32 s76, s77
    v_exp_f32 v96, v96
    v_exp_f32 v97, v97
    v_exp_f32 v98, v98
    v_mfma_f32_32x32x16_bf16 v[112:127], a[116:119], a[52:55], v[112:127]
    s_mov_b32 s77, s78
    v_exp_f32 v99, v99
    v_exp_f32 v100, v100
    v_exp_f32 v101, v101
    v_smfmac_f32_32x32x32_bf16 v[144:159], a[124:127], v[88:95], v231
    s_mov_b32 s78, s79
    v_exp_f32 v102, v102
    v_exp_f32 v103, v103
    v_exp_f32 v104, v104
    v_smfmac_f32_16x16x64_bf16 a[128:131], a[144:147], v[88:95], v231
    v_exp_f32 v105, v105
    v_smfmac_f32_32x32x32_bf16 v[160:175], a[120:123], v[96:103], v231
    v_exp_f32 v106, v106
    v_exp_f32 v107, v107
    v_exp_f32 v108, v108
    v_smfmac_f32_16x16x64_bf16 a[132:135], a[144:147], v[96:103], v231
    buffer_load_dwordx4 a[100:103], v4, s[12:15], s69 offen offset:1024 sc1
    v_exp_f32 v109, v109
    v_exp_f32 v110, v110
    v_exp_f32 v111, v111
    v_mfma_f32_32x32x16_bf16 v[128:143], a[112:115], a[56:59], v[64:79]
    v_exp_f32 v112, v112
    v_exp_f32 v113, v113
    v_exp_f32 v114, v114
    v_mfma_f32_32x32x16_bf16 v[128:143], a[116:119], a[60:63], v[128:143]
    v_exp_f32 v115, v115
    v_exp_f32 v116, v116
    v_exp_f32 v117, v117
    v_smfmac_f32_32x32x32_bf16 v[160:175], a[124:127], v[104:111], v231
    v_exp_f32 v118, v118
    v_exp_f32 v119, v119
    v_exp_f32 v120, v120
    v_smfmac_f32_16x16x64_bf16 a[132:135], a[144:147], v[104:111], v231
    v_exp_f32 v121, v121
    v_smfmac_f32_32x32x32_bf16 v[176:191], a[120:123], v[112:119], v231
    s_waitcnt vmcnt(8)
    v_exp_f32 v122, v122
    v_exp_f32 v123, v123
    v_exp_f32 v124, v124
    v_smfmac_f32_16x16x64_bf16 a[136:139], a[144:147], v[112:119], v231
    buffer_load_dwordx4 a[104:107], v4, s[12:15], s69 offen offset:2048 sc1
    v_exp_f32 v125, v125
    v_exp_f32 v126, v126
    v_exp_f32 v127, v127
    v_mfma_f32_32x32x16_bf16 v[80:95], a[64:67], a[32:35], v[16:31]
    s_cmp_lg_u32 s70, 0
    v_exp_f32 v128, v128
    v_exp_f32 v129, v129
    v_exp_f32 v130, v130
    v_mfma_f32_32x32x16_bf16 v[80:95], a[68:71], a[36:39], v[80:95]
    s_waitcnt vmcnt(6)
    v_cmp_ne_u32 vcc, 0, v212
    v_exp_f32 v131, v131
    v_exp_f32 v132, v132
    v_exp_f32 v133, v133
    v_smfmac_f32_32x32x32_bf16 v[176:191], a[124:127], v[120:127], v231
    s_mov_b32 s71, vcc_lo
    v_exp_f32 v134, v134
    v_exp_f32 v135, v135
    v_exp_f32 v136, v136
    v_smfmac_f32_16x16x64_bf16 a[136:139], a[144:147], v[120:127], v231
    buffer_load_dwordx4 v217, s[16:19], s74 offen offset:3072 lds
    v_exp_f32 v137, v137
    v_smfmac_f32_32x32x32_bf16 v[192:207], a[120:123], v[128:135], v231
    v_exp_f32 v138, v138
    v_exp_f32 v139, v139
    v_exp_f32 v140, v140
    v_smfmac_f32_16x16x64_bf16 a[140:143], a[144:147], v[128:135], v231
    buffer_load_dwordx4 a[108:111], v4, s[12:15], s69 offen offset:3072 sc1
    v_exp_f32 v141, v141
    v_exp_f32 v142, v142
    v_exp_f32 v143, v143
    s_cbranch_scc1 L_att_loop
    v_mfma_f32_32x32x16_bf16 v[96:111], a[64:67], a[48:51], v[48:63]
    s_add_u32 s69, s69, 4096
    v_exp_f32 v80, v80
    v_exp_f32 v81, v81
    v_exp_f32 v82, v82
    v_mfma_f32_32x32x16_bf16 v[96:111], a[68:71], a[52:55], v[96:111]
    v_exp_f32 v83, v83
    v_exp_f32 v84, v84
    v_exp_f32 v85, v85
    v_smfmac_f32_32x32x32_bf16 v[192:207], a[124:127], v[136:143], v231
    v_exp_f32 v86, v86
    v_exp_f32 v87, v87
    v_exp_f32 v88, v88
    v_smfmac_f32_16x16x64_bf16 a[140:143], a[144:147], v[136:143], v231
    buffer_load_dwordx4 a[112:115], v4, s[12:15], s69 offen offset:0 sc1
    v_exp_f32 v89, v89
    v_smfmac_f32_32x32x32_bf16 v[144:159], a[72:75], v[80:87], v231
    v_exp_f32 v90, v90
    v_exp_f32 v91, v91
    v_exp_f32 v92, v92
    v_smfmac_f32_16x16x64_bf16 a[128:131], a[144:147], v[80:87], v231
    buffer_load_dwordx4 a[116:119], v4, s[12:15], s69 offen offset:1024 sc1
    v_exp_f32 v93, v93
    v_exp_f32 v94, v94
    v_exp_f32 v95, v95
    v_mfma_f32_32x32x16_bf16 v[112:127], a[80:83], a[32:35], v[16:31]
    v_exp_f32 v96, v96
    v_exp_f32 v97, v97
    v_exp_f32 v98, v98
    v_mfma_f32_32x32x16_bf16 v[112:127], a[84:87], a[36:39], v[112:127]
    buffer_store_dword v210, v211, s[32:35], s80 offen sc1
    v_exp_f32 v99, v99
    v_exp_f32 v100, v100
    v_exp_f32 v101, v101
    v_smfmac_f32_32x32x32_bf16 v[144:159], a[76:79], v[88:95], v231
    v_exp_f32 v102, v102
    v_exp_f32 v103, v103
    v_exp_f32 v104, v104
    v_smfmac_f32_16x16x64_bf16 a[128:131], a[144:147], v[88:95], v231
    buffer_load_dwordx4 a[120:123], v4, s[12:15], s69 offen offset:2048 sc1
    v_exp_f32 v105, v105
    v_smfmac_f32_32x32x32_bf16 v[176:191], a[72:75], v[96:103], v231
    v_exp_f32 v106, v106
    v_exp_f32 v107, v107
    v_exp_f32 v108, v108
    v_smfmac_f32_16x16x64_bf16 a[136:139], a[144:147], v[96:103], v231
    buffer_load_dwordx4 a[124:127], v4, s[12:15], s69 offen offset:3072 sc1
    v_exp_f32 v109, v109
    v_exp_f32 v110, v110
    v_exp_f32 v111, v111
    v_mfma_f32_32x32x16_bf16 v[128:143], a[80:83], a[48:51], v[48:63]
    s_add_u32 s68, s68, 1
    v_exp_f32 v112, v112
    v_exp_f32 v113, v113
    v_exp_f32 v114, v114
    v_mfma_f32_32x32x16_bf16 v[128:143], a[84:87], a[52:55], v[128:143]
    s_cmp_eq_u32 s68, s37
    s_waitcnt vmcnt(10)
    v_exp_f32 v115, v115
    v_exp_f32 v116, v116
    v_exp_f32 v117, v117
    v_smfmac_f32_32x32x32_bf16 v[176:191], a[76:79], v[104:111], v231
    s_addc_u32 s68, s68, 0
    s_lshl_b32 s69, s68, 13
    s_xor_b32 s69, s69, s36
    v_exp_f32 v118, v118
    v_exp_f32 v119, v119
    v_exp_f32 v120, v120
    v_smfmac_f32_16x16x64_bf16 a[136:139], a[144:147], v[104:111], v231
    buffer_load_dwordx4 a[192:195], v4, s[12:15], s69 offen offset:0 sc1
    v_exp_f32 v121, v121
    v_smfmac_f32_32x32x32_bf16 v[144:159], a[88:91], v[112:119], v231
    s_waitcnt vmcnt(9)
    v_exp_f32 v122, v122
    v_exp_f32 v123, v123
    v_exp_f32 v124, v124
    v_smfmac_f32_16x16x64_bf16 a[128:131], a[144:147], v[112:119], v231
    buffer_load_dwordx4 a[196:199], v4, s[12:15], s69 offen offset:1024 sc1
    v_exp_f32 v125, v125
    v_exp_f32 v126, v126
    v_exp_f32 v127, v127
    v_mfma_f32_32x32x16_bf16 v[80:95], a[96:99], a[32:35], v[16:31]
    v_exp_f32 v128, v128
    v_exp_f32 v129, v129
    v_exp_f32 v130, v130
    v_mfma_f32_32x32x16_bf16 v[80:95], a[100:103], a[36:39], v[80:95]
    v_exp_f32 v131, v131
    v_exp_f32 v132, v132
    v_exp_f32 v133, v133
    v_smfmac_f32_32x32x32_bf16 v[144:159], a[92:95], v[120:127], v231
    v_exp_f32 v134, v134
    v_exp_f32 v135, v135
    v_exp_f32 v136, v136
    v_smfmac_f32_16x16x64_bf16 a[128:131], a[144:147], v[120:127], v231
    buffer_load_dwordx4 a[200:203], v4, s[12:15], s69 offen offset:2048 sc1
    v_exp_f32 v137, v137
    v_smfmac_f32_32x32x32_bf16 v[176:191], a[88:91], v[128:135], v231
    v_exp_f32 v138, v138
    v_exp_f32 v139, v139
    v_exp_f32 v140, v140
    v_smfmac_f32_16x16x64_bf16 a[136:139], a[144:147], v[128:135], v231
    buffer_load_dwordx4 a[204:207], v4, s[12:15], s69 offen offset:3072 sc1
    v_exp_f32 v141, v141
    v_exp_f32 v142, v142
    v_exp_f32 v143, v143
    v_mfma_f32_32x32x16_bf16 v[96:111], a[96:99], a[48:51], v[48:63]
    s_add_u32 s69, s69, 4096
    v_exp_f32 v80, v80
    v_exp_f32 v81, v81
    v_exp_f32 v82, v82
    v_mfma_f32_32x32x16_bf16 v[96:111], a[100:103], a[52:55], v[96:111]
    s_waitcnt vmcnt(9)
    v_exp_f32 v83, v83
    v_exp_f32 v84, v84
    v_exp_f32 v85, v85
    v_smfmac_f32_32x32x32_bf16 v[176:191], a[92:95], v[136:143], v231
    v_exp_f32 v86, v86
    v_exp_f32 v87, v87
    v_exp_f32 v88, v88
    v_smfmac_f32_16x16x64_bf16 a[136:139], a[144:147], v[136:143], v231
    buffer_load_dwordx4 a[208:211], v4, s[12:15], s69 offen offset:0 sc1
    v_exp_f32 v89, v89
    v_smfmac_f32_32x32x32_bf16 v[144:159], a[104:107], v[80:87], v231
    s_waitcnt vmcnt(8)
    v_exp_f32 v90, v90
    v_exp_f32 v91, v91
    v_exp_f32 v92, v92
    v_smfmac_f32_16x16x64_bf16 a[128:131], a[144:147], v[80:87], v231
    buffer_load_dwordx4 a[212:215], v4, s[12:15], s69 offen offset:1024 sc1
    v_exp_f32 v93, v93
    v_exp_f32 v94, v94
    v_exp_f32 v95, v95
    v_mfma_f32_32x32x16_bf16 v[112:127], a[112:115], a[32:35], v[16:31]
    v_exp_f32 v96, v96
    v_exp_f32 v97, v97
    v_exp_f32 v98, v98
    v_mfma_f32_32x32x16_bf16 v[112:127], a[116:119], a[36:39], v[112:127]
    v_exp_f32 v99, v99
    v_exp_f32 v100, v100
    v_exp_f32 v101, v101
    v_smfmac_f32_32x32x32_bf16 v[144:159], a[108:111], v[88:95], v231
    v_exp_f32 v102, v102
    v_exp_f32 v103, v103
    v_exp_f32 v104, v104
    v_smfmac_f32_16x16x64_bf16 a[128:131], a[144:147], v[88:95], v231
    buffer_load_dwordx4 a[216:219], v4, s[12:15], s69 offen offset:2048 sc1
    v_exp_f32 v105, v105
    v_smfmac_f32_32x32x32_bf16 v[176:191], a[104:107], v[96:103], v231
    v_exp_f32 v106, v106
    v_exp_f32 v107, v107
    v_exp_f32 v108, v108
    v_smfmac_f32_16x16x64_bf16 a[136:139], a[144:147], v[96:103], v231
    buffer_load_dwordx4 a[220:223], v4, s[12:15], s69 offen offset:3072 sc1
    v_exp_f32 v109, v109
    v_exp_f32 v110, v110
    v_exp_f32 v111, v111
    v_mfma_f32_32x32x16_bf16 v[128:143], a[112:115], a[48:51], v[48:63]
    s_add_u32 s68, s68, 1
    v_exp_f32 v112, v112
    v_exp_f32 v113, v113
    v_exp_f32 v114, v114
    v_mfma_f32_32x32x16_bf16 v[128:143], a[116:119], a[52:55], v[128:143]
    s_cmp_eq_u32 s68, s37
    s_waitcnt vmcnt(8)
    v_exp_f32 v115, v115
    v_exp_f32 v116, v116
    v_exp_f32 v117, v117
    v_smfmac_f32_32x32x32_bf16 v[176:191], a[108:111], v[104:111], v231
    s_addc_u32 s68, s68, 0
    s_lshl_b32 s69, s68, 13
    s_xor_b32 s69, s69, s36
    v_exp_f32 v118, v118
    v_exp_f32 v119, v119
    v_exp_f32 v120, v120
    v_smfmac_f32_16x16x64_bf16 a[136:139], a[144:147], v[104:111], v231
    buffer_load_dwordx4 a[224:227], v4, s[12:15], s69 offen offset:0 sc1
    v_exp_f32 v121, v121
    v_smfmac_f32_32x32x32_bf16 v[144:159], a[120:123], v[112:119], v231
    s_waitcnt vmcnt(7)
    v_exp_f32 v122, v122
    v_exp_f32 v123, v123
    v_exp_f32 v124, v124
    v_smfmac_f32_16x16x64_bf16 a[128:131], a[144:147], v[112:119], v231
    buffer_load_dwordx4 a[228:231], v4, s[12:15], s69 offen offset:1024 sc1
    v_exp_f32 v125, v125
    v_exp_f32 v126, v126
    v_exp_f32 v127, v127
    v_mfma_f32_32x32x16_bf16 v[80:95], a[192:195], a[32:35], v[16:31]
    v_exp_f32 v128, v128
    v_exp_f32 v129, v129
    v_exp_f32 v130, v130
    v_mfma_f32_32x32x16_bf16 v[80:95], a[196:199], a[36:39], v[80:95]
    v_exp_f32 v131, v131
    v_exp_f32 v132, v132
    v_exp_f32 v133, v133
    v_smfmac_f32_32x32x32_bf16 v[144:159], a[124:127], v[120:127], v231
    v_exp_f32 v134, v134
    v_exp_f32 v135, v135
    v_exp_f32 v136, v136
    v_smfmac_f32_16x16x64_bf16 a[128:131], a[144:147], v[120:127], v231
    buffer_load_dwordx4 a[232:235], v4, s[12:15], s69 offen offset:2048 sc1
    v_exp_f32 v137, v137
    v_smfmac_f32_32x32x32_bf16 v[176:191], a[120:123], v[128:135], v231
    v_exp_f32 v138, v138
    v_exp_f32 v139, v139
    v_exp_f32 v140, v140
    v_smfmac_f32_16x16x64_bf16 a[136:139], a[144:147], v[128:135], v231
    buffer_load_dwordx4 a[236:239], v4, s[12:15], s69 offen offset:3072 sc1
    v_exp_f32 v141, v141
    v_exp_f32 v142, v142
    v_exp_f32 v143, v143
    v_mfma_f32_32x32x16_bf16 v[96:111], a[192:195], a[48:51], v[48:63]
    s_add_u32 s69, s69, 4096
    v_exp_f32 v80, v80
    v_exp_f32 v81, v81
    v_exp_f32 v82, v82
    v_mfma_f32_32x32x16_bf16 v[96:111], a[196:199], a[52:55], v[96:111]
    s_waitcnt vmcnt(8)
    v_exp_f32 v83, v83
    v_exp_f32 v84, v84
    v_exp_f32 v85, v85
    v_smfmac_f32_32x32x32_bf16 v[176:191], a[124:127], v[136:143], v231
    v_exp_f32 v86, v86
    v_exp_f32 v87, v87
    v_exp_f32 v88, v88
    v_smfmac_f32_16x16x64_bf16 a[136:139], a[144:147], v[136:143], v231
    buffer_load_dwordx4 a[240:243], v4, s[12:15], s69 offen offset:0 sc1
    v_exp_f32 v89, v89
    v_smfmac_f32_32x32x32_bf16 v[144:159], a[200:203], v[80:87], v231
    s_waitcnt vmcnt(7)
    v_exp_f32 v90, v90
    v_exp_f32 v91, v91
    v_exp_f32 v92, v92
    v_smfmac_f32_16x16x64_bf16 a[128:131], a[144:147], v[80:87], v231
    buffer_load_dwordx4 a[244:247], v4, s[12:15], s69 offen offset:1024 sc1
    v_exp_f32 v93, v93
    v_exp_f32 v94, v94
    v_exp_f32 v95, v95
    v_mfma_f32_32x32x16_bf16 v[112:127], a[208:211], a[32:35], v[16:31]
    v_exp_f32 v96, v96
    v_exp_f32 v97, v97
    v_exp_f32 v98, v98
    v_mfma_f32_32x32x16_bf16 v[112:127], a[212:215], a[36:39], v[112:127]
    v_exp_f32 v99, v99
    v_exp_f32 v100, v100
    v_exp_f32 v101, v101
    v_smfmac_f32_32x32x32_bf16 v[144:159], a[204:207], v[88:95], v231
    v_exp_f32 v102, v102
    v_exp_f32 v103, v103
    v_exp_f32 v104, v104
    v_smfmac_f32_16x16x64_bf16 a[128:131], a[144:147], v[88:95], v231
    buffer_load_dwordx4 a[248:251], v4, s[12:15], s69 offen offset:2048 sc1
    v_exp_f32 v105, v105
    v_smfmac_f32_32x32x32_bf16 v[176:191], a[200:203], v[96:103], v231
    v_exp_f32 v106, v106
    v_exp_f32 v107, v107
    v_exp_f32 v108, v108
    v_smfmac_f32_16x16x64_bf16 a[136:139], a[144:147], v[96:103], v231
    buffer_load_dwordx4 a[252:255], v4, s[12:15], s69 offen offset:3072 sc1
    v_exp_f32 v109, v109
    v_exp_f32 v110, v110
    v_exp_f32 v111, v111
    v_mfma_f32_32x32x16_bf16 v[128:143], a[208:211], a[48:51], v[48:63]
    s_add_u32 s73, s73, 16384
    v_exp_f32 v112, v112
    v_exp_f32 v113, v113
    v_exp_f32 v114, v114
    v_mfma_f32_32x32x16_bf16 v[128:143], a[212:215], a[52:55], v[128:143]
    s_waitcnt vmcnt(8)
    s_xor_b32 s55, s73, s72
    v_exp_f32 v115, v115
    v_exp_f32 v116, v116
    v_exp_f32 v117, v117
    v_smfmac_f32_32x32x32_bf16 v[176:191], a[204:207], v[104:111], v231
    s_lshl_b32 s74, s55, 4
    s_mov_b32 m0, s73
    v_exp_f32 v118, v118
    v_exp_f32 v119, v119
    v_exp_f32 v120, v120
    v_smfmac_f32_16x16x64_bf16 a[136:139], a[144:147], v[104:111], v231
    buffer_load_dwordx4 v217, s[16:19], s74 offen offset:3072 lds
    v_exp_f32 v121, v121
    v_smfmac_f32_32x32x32_bf16 v[144:159], a[216:219], v[112:119], v231
    s_waitcnt vmcnt(7)
    v_exp_f32 v122, v122
    v_exp_f32 v123, v123
    v_exp_f32 v124, v124
    v_smfmac_f32_16x16x64_bf16 a[128:131], a[144:147], v[112:119], v231
    buffer_load_dwordx4 v216, s[16:19], s74 offen offset:2048 lds
    v_exp_f32 v125, v125
    v_exp_f32 v126, v126
    v_exp_f32 v127, v127
    v_mfma_f32_32x32x16_bf16 v[80:95], a[224:227], a[32:35], v[16:31]
    v_exp_f32 v128, v128
    v_exp_f32 v129, v129
    v_exp_f32 v130, v130
    v_mfma_f32_32x32x16_bf16 v[80:95], a[228:231], a[36:39], v[80:95]
    v_exp_f32 v131, v131
    v_exp_f32 v132, v132
    v_exp_f32 v133, v133
    v_smfmac_f32_32x32x32_bf16 v[144:159], a[220:223], v[120:127], v231
    v_exp_f32 v134, v134
    v_exp_f32 v135, v135
    v_exp_f32 v136, v136
    v_smfmac_f32_16x16x64_bf16 a[128:131], a[144:147], v[120:127], v231
    v_exp_f32 v137, v137
    v_smfmac_f32_32x32x32_bf16 v[176:191], a[216:219], v[128:135], v231
    s_waitcnt vmcnt(4)
    v_exp_f32 v138, v138
    v_exp_f32 v139, v139
    v_exp_f32 v140, v140
    v_smfmac_f32_16x16x64_bf16 a[136:139], a[144:147], v[128:135], v231
    buffer_load_dwordx4 v215, s[16:19], s74 offen offset:1024 lds
    v_exp_f32 v141, v141
    v_exp_f32 v142, v142
    v_exp_f32 v143, v143
    v_mfma_f32_32x32x16_bf16 v[96:111], a[240:243], a[32:35], v[16:31]
    v_exp_f32 v80, v80
    v_exp_f32 v81, v81
    v_exp_f32 v82, v82
    v_mfma_f32_32x32x16_bf16 v[96:111], a[244:247], a[36:39], v[96:111]
    v_exp_f32 v83, v83
    v_exp_f32 v84, v84
    v_exp_f32 v85, v85
    v_smfmac_f32_32x32x32_bf16 v[176:191], a[220:223], v[136:143], v231
    v_exp_f32 v86, v86
    v_exp_f32 v87, v87
    v_exp_f32 v88, v88
    v_smfmac_f32_16x16x64_bf16 a[136:139], a[144:147], v[136:143], v231
    buffer_load_dwordx4 v214, s[16:19], s74 offen offset:0 lds
    v_exp_f32 v89, v89
    v_smfmac_f32_32x32x32_bf16 v[144:159], a[232:235], v[80:87], v231
    s_sub_u32 m0, s73, 16384
    s_xor_b32 s57, s74, 786432
    v_exp_f32 v90, v90
    v_exp_f32 v91, v91
    v_exp_f32 v92, v92
    v_smfmac_f32_16x16x64_bf16 a[128:131], a[144:147], v[80:87], v231
    buffer_load_dwordx4 v214, s[16:19], s57 offen offset:0 lds
    v_exp_f32 v93, v93
    v_exp_f32 v94, v94
    v_exp_f32 v95, v95
    v_mfma_f32_32x32x16_bf16 v[112:127], a[224:227], a[48:51], v[48:63]
    v_exp_f32 v96, v96
    v_exp_f32 v97, v97
    v_exp_f32 v98, v98
    v_mfma_f32_32x32x16_bf16 v[112:127], a[228:231], a[52:55], v[112:127]
    s_waitcnt vmcnt(5)
    v_exp_f32 v99, v99
    v_exp_f32 v100, v100
    v_exp_f32 v101, v101
    v_smfmac_f32_32x32x32_bf16 v[144:159], a[236:239], v[88:95], v231
    v_exp_f32 v102, v102
    v_exp_f32 v103, v103
    v_exp_f32 v104, v104
    v_smfmac_f32_16x16x64_bf16 a[128:131], a[144:147], v[88:95], v231
    buffer_load_dwordx4 v215, s[16:19], s57 offen offset:1024 lds
    v_exp_f32 v105, v105
    v_smfmac_f32_32x32x32_bf16 v[144:159], a[248:251], v[96:103], v231
    v_exp_f32 v106, v106
    v_exp_f32 v107, v107
    v_exp_f32 v108, v108
    v_smfmac_f32_16x16x64_bf16 a[128:131], a[144:147], v[96:103], v231
    buffer_load_dwordx4 v216, s[16:19], s57 offen offset:2048 lds
    v_exp_f32 v109, v109
    v_exp_f32 v110, v110
    v_exp_f32 v111, v111
    v_mfma_f32_32x32x16_bf16 v[128:143], a[240:243], a[48:51], v[48:63]
    v_exp_f32 v112, v112
    v_exp_f32 v113, v113
    v_exp_f32 v114, v114
    v_mfma_f32_32x32x16_bf16 v[128:143], a[244:247], a[52:55], v[128:143]
    v_exp_f32 v115, v115
    v_exp_f32 v116, v116
    v_exp_f32 v117, v117
    v_smfmac_f32_32x32x32_bf16 v[144:159], a[252:255], v[104:111], v231
    v_exp_f32 v118, v118
    v_exp_f32 v119, v119
    v_exp_f32 v120, v120
    v_smfmac_f32_16x16x64_bf16 a[128:131], a[144:147], v[104:111], v231
    buffer_load_dwordx4 v217, s[16:19], s57 offen offset:3072 lds
    v_exp_f32 v121, v121
    v_smfmac_f32_32x32x32_bf16 v[176:191], a[232:235], v[112:119], v231
    v_exp_f32 v122, v122
    v_exp_f32 v123, v123
    v_exp_f32 v124, v124
    v_smfmac_f32_16x16x64_bf16 a[136:139], a[144:147], v[112:119], v231
    buffer_load_dword v234, v235, s[32:35], s81 offen sc1
    v_exp_f32 v125, v125
    v_exp_f32 v126, v126
    v_exp_f32 v127, v127
    v_mfma_f32_32x32x16_bf16 v[80:95], a[64:67], a[40:43], v[32:47]
    v_accvgpr_read_b32 v9, a128
    v_mov_b32 v8, v16
    v_subrev_u32 v1, 394264576, v9
    v_cmp_le_u32 vcc, 1207959552, v1
    v_exp_f32 v128, v128
    v_exp_f32 v129, v129
    v_exp_f32 v130, v130
    v_mfma_f32_32x32x16_bf16 v[80:95], a[68:71], a[44:47], v[80:95]
    ds_write_b128 v240, v[144:147] offset:0
    v_exp_f32 v131, v131
    v_exp_f32 v132, v132
    v_exp_f32 v133, v133
    v_smfmac_f32_32x32x32_bf16 v[176:191], a[236:239], v[120:127], v231
    v_exp_f32 v134, v134
    v_exp_f32 v135, v135
    v_exp_f32 v136, v136
    v_smfmac_f32_16x16x64_bf16 a[136:139], a[144:147], v[120:127], v231
    ds_write_b128 v240, v[148:151] offset:1024
    v_exp_f32 v137, v137
    v_smfmac_f32_32x32x32_bf16 v[176:191], a[248:251], v[128:135], v231
    v_exp_f32 v138, v138
    v_exp_f32 v139, v139
    v_exp_f32 v140, v140
    v_smfmac_f32_16x16x64_bf16 a[136:139], a[144:147], v[128:135], v231
    ds_write_b128 v240, v[152:155] offset:2048
    v_exp_f32 v141, v141
    v_exp_f32 v142, v142
    v_exp_f32 v143, v143
    s_cbranch_vccnz L_slow0
L_safe0:
    v_mfma_f32_32x32x16_bf16 v[96:111], a[80:83], a[40:43], v[32:47]
    s_waitcnt vmcnt(8)
    ds_write_b64 v218, v[8:9] offset:0
    v_exp_f32 v80, v80
    v_exp_f32 v81, v81
    v_exp_f32 v82, v82
    v_mfma_f32_32x32x16_bf16 v[96:111], a[84:87], a[44:47], v[96:111]
    ds_write_b128 v240, v[156:159] offset:3072
    v_exp_f32 v83, v83
    v_exp_f32 v84, v84
    v_exp_f32 v85, v85
    v_smfmac_f32_32x32x32_bf16 v[176:191], a[252:255], v[136:143], v231
    v_exp_f32 v86, v86
    v_exp_f32 v87, v87
    v_exp_f32 v88, v88
    v_smfmac_f32_16x16x64_bf16 a[136:139], a[144:147], v[136:143], v231
    buffer_load_dword v232, v229, s[32:35], s3 offen sc1
    v_exp_f32 v89, v89
    v_smfmac_f32_32x32x32_bf16 v[160:175], a[72:75], v[80:87], v231
    s_waitcnt lgkmcnt(0)
    s_barrier
    v_exp_f32 v90, v90
    v_exp_f32 v91, v91
    v_exp_f32 v92, v92
    v_smfmac_f32_16x16x64_bf16 a[132:135], a[144:147], v[80:87], v231
    ds_read_b64 v[10:11], v219 offset:0
    v_exp_f32 v93, v93
    v_exp_f32 v94, v94
    v_exp_f32 v95, v95
    v_mfma_f32_32x32x16_bf16 v[112:127], a[96:99], a[40:43], v[32:47]
    ds_read_b128 v[144:147], v241 offset:0
    v_accvgpr_read_b32 v12, a136
    v_subrev_u32 v1, 394264576, v12
    v_cmp_le_u32 vcc, 1207959552, v1
    v_exp_f32 v96, v96
    v_exp_f32 v97, v97
    v_exp_f32 v98, v98
    v_mfma_f32_32x32x16_bf16 v[112:127], a[100:103], a[44:47], v[112:127]
    ds_read_b128 v[148:151], v241 offset:1024
    v_exp_f32 v99, v99
    v_exp_f32 v100, v100
    v_exp_f32 v101, v101
    v_smfmac_f32_32x32x32_bf16 v[160:175], a[76:79], v[88:95], v231
    ds_read_b128 v[152:155], v241 offset:2048
    v_exp_f32 v102, v102
    v_exp_f32 v103, v103
    v_exp_f32 v104, v104
    v_smfmac_f32_16x16x64_bf16 a[132:135], a[144:147], v[88:95], v231
    ds_read_b128 v[156:159], v241 offset:3072
    v_exp_f32 v105, v105
    v_smfmac_f32_32x32x32_bf16 v[160:175], a[88:91], v[96:103], v231
    s_waitcnt lgkmcnt(4)
    v_min_f32 v13, v48, v10
    v_sub_f32 v6, v13, v48
    v_sub_f32 v13, v13, v10
    v_exp_f32 v6, v6
    v_exp_f32 v13, v13
    v_exp_f32 v106, v106
    v_exp_f32 v107, v107
    v_exp_f32 v108, v108
    v_smfmac_f32_16x16x64_bf16 a[132:135], a[144:147], v[96:103], v231
L_pg6:
    s_cbranch_execz L_main
    v_mul_f32 v12, v12, v6
    v_fmac_f32 v12, v11, v13
    v_rcp_f32 v12, v12
    v_exp_f32 v109, v109
    v_exp_f32 v110, v110
    v_exp_f32 v111, v111
    s_cbranch_vccnz L_slow2
L_safe2:
    v_mul_f32 v6, v6, v12
    v_mul_f32 v10, v13, v12
    s_waitcnt lgkmcnt(0)
    v_pk_mul_f32 v[144:145], v[144:145], v[10:11] op_sel_hi:[1,0]
    v_pk_mul_f32 v[146:147], v[146:147], v[10:11] op_sel_hi:[1,0]
    v_pk_mul_f32 v[148:149], v[148:149], v[10:11] op_sel_hi:[1,0]
    v_pk_mul_f32 v[150:151], v[150:151], v[10:11] op_sel_hi:[1,0]
    v_pk_fma_f32 v[144:145], v[176:177], v[6:7], v[144:145] op_sel_hi:[1,0,1]
    v_pk_fma_f32 v[146:147], v[178:179], v[6:7], v[146:147] op_sel_hi:[1,0,1]
    v_pk_fma_f32 v[148:149], v[180:181], v[6:7], v[148:149] op_sel_hi:[1,0,1]
    v_pk_fma_f32 v[150:151], v[182:183], v[6:7], v[150:151] op_sel_hi:[1,0,1]
    v_cvt_pk_bf16_f32 v16, v144, v145
    v_cvt_pk_bf16_f32 v17, v146, v147
    v_cvt_pk_bf16_f32 v18, v148, v149
    v_cvt_pk_bf16_f32 v19, v150, v151
    buffer_store_dwordx4 v[16:19], v242, s[12:15], s85 offen offset:0 sc1
    v_pk_mul_f32 v[152:153], v[152:153], v[10:11] op_sel_hi:[1,0]
    v_pk_mul_f32 v[154:155], v[154:155], v[10:11] op_sel_hi:[1,0]
    v_pk_mul_f32 v[156:157], v[156:157], v[10:11] op_sel_hi:[1,0]
    v_pk_mul_f32 v[158:159], v[158:159], v[10:11] op_sel_hi:[1,0]
    v_pk_fma_f32 v[152:153], v[184:185], v[6:7], v[152:153] op_sel_hi:[1,0,1]
    v_pk_fma_f32 v[154:155], v[186:187], v[6:7], v[154:155] op_sel_hi:[1,0,1]
    v_pk_fma_f32 v[156:157], v[188:189], v[6:7], v[156:157] op_sel_hi:[1,0,1]
    v_pk_fma_f32 v[158:159], v[190:191], v[6:7], v[158:159] op_sel_hi:[1,0,1]
    v_cvt_pk_bf16_f32 v20, v152, v153
    v_cvt_pk_bf16_f32 v21, v154, v155
    v_cvt_pk_bf16_f32 v22, v156, v157
    v_cvt_pk_bf16_f32 v23, v158, v159
    v_mfma_f32_32x32x16_bf16 v[128:143], a[112:115], a[40:43], v[32:47]
    v_exp_f32 v112, v112
    v_exp_f32 v113, v113
    v_exp_f32 v114, v114
    v_mfma_f32_32x32x16_bf16 v[128:143], a[116:119], a[44:47], v[128:143]
    v_exp_f32 v115, v115
    v_exp_f32 v116, v116
    v_exp_f32 v117, v117
    v_smfmac_f32_32x32x32_bf16 v[160:175], a[92:95], v[104:111], v231
    v_exp_f32 v118, v118
    v_exp_f32 v119, v119
    v_exp_f32 v120, v120
    v_smfmac_f32_16x16x64_bf16 a[132:135], a[144:147], v[104:111], v231
    buffer_store_dwordx4 v[20:23], v242, s[12:15], s85 offen offset:512 sc1
    v_exp_f32 v121, v121
    v_smfmac_f32_32x32x32_bf16 v[160:175], a[104:107], v[112:119], v231
    v_exp_f32 v122, v122
    v_exp_f32 v123, v123
    v_exp_f32 v124, v124
    v_smfmac_f32_16x16x64_bf16 a[132:135], a[144:147], v[112:119], v231
    v_exp_f32 v125, v125
    v_exp_f32 v126, v126
    v_exp_f32 v127, v127
    v_mfma_f32_32x32x16_bf16 v[80:95], a[192:195], a[40:43], v[32:47]
    s_waitcnt vmcnt(2)
    v_cmp_ne_u32 vcc, 0, v234
    v_cmp_gt_i32 s[98:99], 0, v232
    v_exp_f32 v128, v128
    v_exp_f32 v129, v129
    v_exp_f32 v130, v130
    v_mfma_f32_32x32x16_bf16 v[80:95], a[196:199], a[44:47], v[80:95]
    s_and_b32 s98, s98, vcc_lo
    v_exp_f32 v131, v131
    v_exp_f32 v132, v132
    v_exp_f32 v133, v133
    v_smfmac_f32_32x32x32_bf16 v[160:175], a[108:111], v[120:127], v231
    s_and_b32 s98, s98, vcc_hi
    s_cmp_eq_u32 s98, -1
    v_exp_f32 v134, v134
    v_exp_f32 v135, v135
    v_exp_f32 v136, v136
    v_smfmac_f32_16x16x64_bf16 a[132:135], a[144:147], v[120:127], v231
    s_cbranch_scc0 L_u_spin
L_u_ok:
    v_exp_f32 v137, v137
    v_smfmac_f32_32x32x32_bf16 v[160:175], a[120:123], v[128:135], v231
    s_add_u32 m0, s84, 0
    v_exp_f32 v138, v138
    v_exp_f32 v139, v139
    v_exp_f32 v140, v140
    v_smfmac_f32_16x16x64_bf16 a[132:135], a[144:147], v[128:135], v231
    buffer_load_dwordx4 v236, s[12:15], s82 offen offset:0 sc1 lds
    v_exp_f32 v141, v141
    v_exp_f32 v142, v142
    v_exp_f32 v143, v143
    v_mfma_f32_32x32x16_bf16 v[96:111], a[208:211], a[40:43], v[32:47]
    v_lshlrev_b32 v14, 7, v0
    v_lshl_add_u32 v14, v5, 20, v14
    v_exp_f32 v80, v80
    v_exp_f32 v81, v81
    v_exp_f32 v82, v82
    v_mfma_f32_32x32x16_bf16 v[96:111], a[212:215], a[44:47], v[96:111]
    v_exp_f32 v83, v83
    v_exp_f32 v84, v84
    v_exp_f32 v85, v85
    v_smfmac_f32_32x32x32_bf16 v[160:175], a[124:127], v[136:143], v231
    v_exp_f32 v86, v86
    v_exp_f32 v87, v87
    v_exp_f32 v88, v88
    v_smfmac_f32_16x16x64_bf16 a[132:135], a[144:147], v[136:143], v231
    buffer_load_dwordx4 v237, s[12:15], s82 offen offset:1024 sc1 lds
    v_exp_f32 v89, v89
    v_smfmac_f32_32x32x32_bf16 v[160:175], a[200:203], v[80:87], v231
    v_exp_f32 v90, v90
    v_exp_f32 v91, v91
    v_exp_f32 v92, v92
    v_smfmac_f32_16x16x64_bf16 a[132:135], a[144:147], v[80:87], v231
    buffer_load_dwordx4 v238, s[12:15], s82 offen offset:2048 sc1 lds
    v_exp_f32 v93, v93
    v_exp_f32 v94, v94
    v_exp_f32 v95, v95
    v_mfma_f32_32x32x16_bf16 v[112:127], a[224:227], a[40:43], v[32:47]
    v_add_u32 v56, s89, v243
    v_exp_f32 v96, v96
    v_exp_f32 v97, v97
    v_exp_f32 v98, v98
    v_mfma_f32_32x32x16_bf16 v[112:127], a[228:231], a[44:47], v[112:127]
    v_exp_f32 v99, v99
    v_exp_f32 v100, v100
    v_exp_f32 v101, v101
    v_smfmac_f32_32x32x32_bf16 v[160:175], a[204:207], v[88:95], v231
    v_xor_b32 v57, 32, v56
    v_exp_f32 v102, v102
    v_exp_f32 v103, v103
    v_exp_f32 v104, v104
    v_smfmac_f32_16x16x64_bf16 a[132:135], a[144:147], v[88:95], v231
    buffer_load_dwordx4 v239, s[12:15], s82 offen offset:3072 sc1 lds
    v_exp_f32 v105, v105
    v_smfmac_f32_32x32x32_bf16 v[160:175], a[216:219], v[96:103], v231
    s_add_u32 m0, s84, 4096
    v_exp_f32 v106, v106
    v_exp_f32 v107, v107
    v_exp_f32 v108, v108
    v_smfmac_f32_16x16x64_bf16 a[132:135], a[144:147], v[96:103], v231
    buffer_load_dwordx4 v236, s[12:15], s83 offen offset:0 sc1 lds
    v_exp_f32 v109, v109
    v_exp_f32 v110, v110
    v_exp_f32 v111, v111
    v_mfma_f32_32x32x16_bf16 v[128:143], a[240:243], a[40:43], v[32:47]
    v_xor_b32 v58, 64, v56
    v_exp_f32 v112, v112
    v_exp_f32 v113, v113
    v_exp_f32 v114, v114
    v_mfma_f32_32x32x16_bf16 v[128:143], a[244:247], a[44:47], v[128:143]
    v_xor_b32 v48, 0, v244
    v_exp_f32 v115, v115
    v_exp_f32 v116, v116
    v_exp_f32 v117, v117
    v_smfmac_f32_32x32x32_bf16 v[160:175], a[220:223], v[104:111], v231
    v_xor_b32 v59, 96, v56
    v_exp_f32 v118, v118
    v_exp_f32 v119, v119
    v_exp_f32 v120, v120
    v_smfmac_f32_16x16x64_bf16 a[132:135], a[144:147], v[104:111], v231
    s_waitcnt vmcnt(5)
    buffer_store_dword v210, v211, s[32:35], s86 offen sc1
    v_exp_f32 v121, v121
    v_smfmac_f32_32x32x32_bf16 v[160:175], a[232:235], v[112:119], v231
    v_exp_f32 v122, v122
    v_exp_f32 v123, v123
    v_exp_f32 v124, v124
    v_smfmac_f32_16x16x64_bf16 a[132:135], a[144:147], v[112:119], v231
    buffer_load_dwordx4 v237, s[12:15], s83 offen offset:1024 sc1 lds
    v_exp_f32 v125, v125
    v_exp_f32 v126, v126
    v_exp_f32 v127, v127
    v_mfma_f32_32x32x16_bf16 v[80:95], a[64:67], a[56:59], v[64:79]
    v_add_u32 v60, s90, v243
    v_exp_f32 v128, v128
    v_exp_f32 v129, v129
    v_exp_f32 v130, v130
    v_mfma_f32_32x32x16_bf16 v[80:95], a[68:71], a[60:63], v[80:95]
    v_xor_b32 v49, 32, v244
    v_exp_f32 v131, v131
    v_exp_f32 v132, v132
    v_exp_f32 v133, v133
    v_smfmac_f32_32x32x32_bf16 v[160:175], a[236:239], v[120:127], v231
    v_xor_b32 v61, 32, v60
    v_exp_f32 v134, v134
    v_exp_f32 v135, v135
    v_exp_f32 v136, v136
    v_smfmac_f32_16x16x64_bf16 a[132:135], a[144:147], v[120:127], v231
    buffer_load_dwordx4 v238, s[12:15], s83 offen offset:2048 sc1 lds
    v_exp_f32 v137, v137
    v_smfmac_f32_32x32x32_bf16 v[160:175], a[248:251], v[128:135], v231
    v_exp_f32 v138, v138
    v_exp_f32 v139, v139
    v_exp_f32 v140, v140
    v_smfmac_f32_16x16x64_bf16 a[132:135], a[144:147], v[128:135], v231
    buffer_load_dwordx4 v239, s[12:15], s83 offen offset:3072 sc1 lds
    v_exp_f32 v141, v141
    v_exp_f32 v142, v142
    v_exp_f32 v143, v143
    v_mfma_f32_32x32x16_bf16 v[96:111], a[80:83], a[56:59], v[64:79]
    v_xor_b32 v62, 64, v60
    v_exp_f32 v80, v80
    v_exp_f32 v81, v81
    v_exp_f32 v82, v82
    v_mfma_f32_32x32x16_bf16 v[96:111], a[84:87], a[60:63], v[96:111]
    v_xor_b32 v50, 64, v244
    v_exp_f32 v83, v83
    v_exp_f32 v84, v84
    v_exp_f32 v85, v85
    v_smfmac_f32_32x32x32_bf16 v[160:175], a[252:255], v[136:143], v231
    v_xor_b32 v63, 96, v60
    v_exp_f32 v86, v86
    v_exp_f32 v87, v87
    v_exp_f32 v88, v88
    v_smfmac_f32_16x16x64_bf16 a[132:135], a[144:147], v[136:143], v231
    v_exp_f32 v89, v89
    v_smfmac_f32_32x32x32_bf16 v[192:207], a[72:75], v[80:87], v231
    v_exp_f32 v90, v90
    v_exp_f32 v91, v91
    v_exp_f32 v92, v92
    v_smfmac_f32_16x16x64_bf16 a[140:143], a[144:147], v[80:87], v231
    v_exp_f32 v93, v93
    v_exp_f32 v94, v94
    v_exp_f32 v95, v95
    v_mfma_f32_32x32x16_bf16 v[112:127], a[96:99], a[56:59], v[64:79]
    s_add_u32 s86, s86, 8192
    v_exp_f32 v96, v96
    v_exp_f32 v97, v97
    v_exp_f32 v98, v98
    v_mfma_f32_32x32x16_bf16 v[112:127], a[100:103], a[60:63], v[112:127]
    v_accvgpr_read_b32 v9, a132
    v_mov_b32 v8, v32
    v_subrev_u32 v1, 394264576, v9
    v_cmp_le_u32 vcc, 1207959552, v1
    v_xor_b32 v51, 96, v244
    v_exp_f32 v99, v99
    v_exp_f32 v100, v100
    v_exp_f32 v101, v101
    v_smfmac_f32_32x32x32_bf16 v[192:207], a[76:79], v[88:95], v231
    v_exp_f32 v102, v102
    v_exp_f32 v103, v103
    v_exp_f32 v104, v104
    v_smfmac_f32_16x16x64_bf16 a[140:143], a[144:147], v[88:95], v231
    ds_write_b128 v241, v[160:163] offset:0
    v_exp_f32 v105, v105
    v_smfmac_f32_32x32x32_bf16 v[192:207], a[88:91], v[96:103], v231
    v_exp_f32 v106, v106
    v_exp_f32 v107, v107
    v_exp_f32 v108, v108
    v_smfmac_f32_16x16x64_bf16 a[140:143], a[144:147], v[96:103], v231
    ds_write_b128 v241, v[164:167] offset:1024
    v_exp_f32 v109, v109
    v_exp_f32 v110, v110
    v_exp_f32 v111, v111
    s_cbranch_vccnz L_slow1
L_safe1:
    v_mfma_f32_32x32x16_bf16 v[128:143], a[112:115], a[56:59], v[64:79]
    v_exp_f32 v112, v112
    v_exp_f32 v113, v113
    v_exp_f32 v114, v114
    v_mfma_f32_32x32x16_bf16 v[128:143], a[116:119], a[60:63], v[128:143]
    v_exp_f32 v115, v115
    v_exp_f32 v116, v116
    v_exp_f32 v117, v117
    v_smfmac_f32_32x32x32_bf16 v[192:207], a[92:95], v[104:111], v231
    v_exp_f32 v118, v118
    v_exp_f32 v119, v119
    v_exp_f32 v120, v120
    v_smfmac_f32_16x16x64_bf16 a[140:143], a[144:147], v[104:111], v231
    ds_write_b128 v241, v[168:171] offset:2048
    v_exp_f32 v121, v121
    v_smfmac_f32_32x32x32_bf16 v[192:207], a[104:107], v[112:119], v231
    v_exp_f32 v122, v122
    v_exp_f32 v123, v123
    v_exp_f32 v124, v124
    v_smfmac_f32_16x16x64_bf16 a[140:143], a[144:147], v[112:119], v231
    ds_write_b128 v241, v[172:175] offset:3072
    v_exp_f32 v125, v125
    v_exp_f32 v126, v126
    v_exp_f32 v127, v127
    v_mfma_f32_32x32x16_bf16 v[80:95], a[192:195], a[56:59], v[64:79]
    ds_write_b64 v219, v[8:9] offset:512
    v_exp_f32 v128, v128
    v_exp_f32 v129, v129
    v_exp_f32 v130, v130
    v_mfma_f32_32x32x16_bf16 v[80:95], a[196:199], a[60:63], v[80:95]
    v_exp_f32 v131, v131
    v_exp_f32 v132, v132
    v_exp_f32 v133, v133
    v_smfmac_f32_32x32x32_bf16 v[192:207], a[108:111], v[120:127], v231
    s_waitcnt vmcnt(0) lgkmcnt(0)
    s_barrier
    v_exp_f32 v134, v134
    v_exp_f32 v135, v135
    v_exp_f32 v136, v136
    v_smfmac_f32_16x16x64_bf16 a[140:143], a[144:147], v[120:127], v231
    ds_read_b64 v[10:11], v218 offset:512
    v_exp_f32 v137, v137
    v_smfmac_f32_32x32x32_bf16 v[192:207], a[120:123], v[128:135], v231
    ds_read_b128 v[160:163], v240 offset:0
    v_exp_f32 v138, v138
    v_exp_f32 v139, v139
    v_exp_f32 v140, v140
    v_smfmac_f32_16x16x64_bf16 a[140:143], a[144:147], v[128:135], v231
    buffer_load_dword v15, v14, s[32:35], s87 offen sc1
    v_exp_f32 v141, v141
    v_exp_f32 v142, v142
    v_exp_f32 v143, v143
    v_mfma_f32_32x32x16_bf16 v[96:111], a[208:211], a[56:59], v[64:79]
    v_exp_f32 v80, v80
    v_exp_f32 v81, v81
    v_exp_f32 v82, v82
    v_mfma_f32_32x32x16_bf16 v[96:111], a[212:215], a[60:63], v[96:111]
    ds_read_b128 v[164:167], v240 offset:1024
    v_exp_f32 v83, v83
    v_exp_f32 v84, v84
    v_exp_f32 v85, v85
    v_smfmac_f32_32x32x32_bf16 v[192:207], a[124:127], v[136:143], v231
    v_exp_f32 v86, v86
    v_exp_f32 v87, v87
    v_exp_f32 v88, v88
    v_smfmac_f32_16x16x64_bf16 a[140:143], a[144:147], v[136:143], v231
    ds_read_b128 v[168:171], v240 offset:2048
    v_exp_f32 v89, v89
    v_smfmac_f32_32x32x32_bf16 v[192:207], a[200:203], v[80:87], v231
    v_exp_f32 v90, v90
    v_exp_f32 v91, v91
    v_exp_f32 v92, v92
    v_smfmac_f32_16x16x64_bf16 a[140:143], a[144:147], v[80:87], v231
    ds_read_b128 v[172:175], v240 offset:3072
    v_exp_f32 v93, v93
    v_exp_f32 v94, v94
    v_exp_f32 v95, v95
    v_mfma_f32_32x32x16_bf16 v[112:127], a[224:227], a[56:59], v[64:79]
    s_mov_b32 m0, s73
    v_exp_f32 v96, v96
    v_exp_f32 v97, v97
    v_exp_f32 v98, v98
    v_mfma_f32_32x32x16_bf16 v[112:127], a[228:231], a[60:63], v[112:127]
    s_add_u32 s73, s73, 16384
    v_exp_f32 v99, v99
    v_exp_f32 v100, v100
    v_exp_f32 v101, v101
    v_smfmac_f32_32x32x32_bf16 v[192:207], a[204:207], v[88:95], v231
    s_waitcnt lgkmcnt(0)
    v_exp_f32 v102, v102
    v_exp_f32 v103, v103
    v_exp_f32 v104, v104
    v_smfmac_f32_16x16x64_bf16 a[140:143], a[144:147], v[88:95], v231
    buffer_load_dwordx4 v217, s[16:19], s74 offen offset:3072 lds
    v_exp_f32 v105, v105
    v_smfmac_f32_32x32x32_bf16 v[192:207], a[216:219], v[96:103], v231
    s_xor_b32 s55, s73, s72
    s_lshl_b32 s74, s55, 4
    s_mov_b32 m0, s73
    v_exp_f32 v106, v106
    v_exp_f32 v107, v107
    v_exp_f32 v108, v108
    v_smfmac_f32_16x16x64_bf16 a[140:143], a[144:147], v[96:103], v231
    buffer_load_dwordx4 v214, s[16:19], s74 offen offset:0 lds
    v_exp_f32 v109, v109
    v_exp_f32 v110, v110
    v_exp_f32 v111, v111
    v_mfma_f32_32x32x16_bf16 v[128:143], a[240:243], a[56:59], v[64:79]
    v_exp_f32 v112, v112
    v_exp_f32 v113, v113
    v_exp_f32 v114, v114
    v_mfma_f32_32x32x16_bf16 v[128:143], a[244:247], a[60:63], v[128:143]
    buffer_load_dwordx4 v215, s[16:19], s74 offen offset:1024 lds
    v_exp_f32 v115, v115
    v_exp_f32 v116, v116
    v_exp_f32 v117, v117
    v_smfmac_f32_32x32x32_bf16 v[192:207], a[220:223], v[104:111], v231
    s_waitcnt vmcnt(3)
    v_cmp_ne_u32 vcc, 0, v15
    v_exp_f32 v118, v118
    v_exp_f32 v119, v119
    v_exp_f32 v120, v120
    v_smfmac_f32_16x16x64_bf16 a[140:143], a[144:147], v[104:111], v231
    buffer_load_dwordx4 v216, s[16:19], s74 offen offset:2048 lds
    v_exp_f32 v121, v121
    v_smfmac_f32_32x32x32_bf16 v[192:207], a[232:235], v[112:119], v231
    buffer_load_dwordx4 v217, s[16:19], s74 offen offset:3072 lds
    s_cmp_eq_u32 vcc_lo, 0xffff
    s_cbranch_scc0 L_oa_spin
L_oa_ok:
    v_exp_f32 v122, v122
    v_exp_f32 v123, v123
    v_exp_f32 v124, v124
    v_smfmac_f32_16x16x64_bf16 a[140:143], a[144:147], v[112:119], v231
    s_xor_b32 s68, s88, 0
    buffer_load_dwordx4 a[64:67], v245, s[12:15], s68 offen offset:0 sc1
    v_exp_f32 v125, v125
    v_exp_f32 v126, v126
    v_exp_f32 v127, v127
    v_exp_f32 v128, v128
    v_exp_f32 v129, v129
    v_exp_f32 v130, v130
    v_exp_f32 v131, v131
    v_exp_f32 v132, v132
    v_exp_f32 v133, v133
    v_smfmac_f32_32x32x32_bf16 v[192:207], a[236:239], v[120:127], v231
    buffer_load_dwordx4 a[68:71], v246, s[12:15], s68 offen offset:0 sc1
    v_exp_f32 v134, v134
    v_exp_f32 v135, v135
    v_exp_f32 v136, v136
    v_smfmac_f32_16x16x64_bf16 a[140:143], a[144:147], v[120:127], v231
    s_xor_b32 s68, s88, 8192
    buffer_load_dwordx4 a[72:75], v245, s[12:15], s68 offen offset:0 sc1
    v_exp_f32 v137, v137
    v_smfmac_f32_32x32x32_bf16 v[192:207], a[248:251], v[128:135], v231
    buffer_load_dwordx4 a[76:79], v246, s[12:15], s68 offen offset:0 sc1
    v_exp_f32 v138, v138
    v_exp_f32 v139, v139
    v_exp_f32 v140, v140
    v_smfmac_f32_16x16x64_bf16 a[140:143], a[144:147], v[128:135], v231
    s_xor_b32 s68, s88, 16384
    buffer_load_dwordx4 a[80:83], v245, s[12:15], s68 offen offset:0 sc1
    v_exp_f32 v141, v141
    v_exp_f32 v142, v142
    v_exp_f32 v143, v143
    s_nop 1
    v_smfmac_f32_16x16x64_bf16 a[140:143], a[144:147], v[136:143], v231
    v_smfmac_f32_32x32x32_bf16 v[192:207], a[252:255], v[136:143], v231
    buffer_load_dwordx4 a[84:87], v246, s[12:15], s68 offen offset:0 sc1
    s_add_u32 s87, s87, 8192
    ds_read_b64_tr_b16 v[16:17], v56 offset:0
    ds_read_b64_tr_b16 v[18:19], v56 offset:512
    ds_read_b64_tr_b16 v[20:21], v57 offset:0
    ds_read_b64_tr_b16 v[22:23], v57 offset:512
    ds_read_b64_tr_b16 v[24:25], v58 offset:0
    ds_read_b64_tr_b16 v[26:27], v58 offset:512
    ds_read_b64_tr_b16 v[28:29], v59 offset:0
    ds_read_b64_tr_b16 v[30:31], v59 offset:512
    v_accvgpr_read_b32 v12, a140
    v_subrev_u32 v1, 394264576, v12
    v_cmp_le_u32 vcc, 1207959552, v1
L_redo3:
    v_min_f32 v13, v64, v10
    v_sub_f32 v6, v13, v64
    v_sub_f32 v13, v13, v10
    v_exp_f32 v6, v6
    v_exp_f32 v13, v13
    s_cbranch_vccnz L_slow3
    v_mul_f32 v12, v12, v6
    v_fmac_f32 v12, v11, v13
    v_rcp_f32 v12, v12
    s_nop 0
    v_mul_f32 v6, v6, v12
    v_mul_f32 v10, v13, v12
    v_pk_mul_f32 v[160:161], v[160:161], v[10:11] op_sel_hi:[1,0]
    v_pk_mul_f32 v[162:163], v[162:163], v[10:11] op_sel_hi:[1,0]
    v_pk_mul_f32 v[164:165], v[164:165], v[10:11] op_sel_hi:[1,0]
    v_pk_mul_f32 v[166:167], v[166:167], v[10:11] op_sel_hi:[1,0]
    v_pk_fma_f32 v[160:161], v[192:193], v[6:7], v[160:161] op_sel_hi:[1,0,1]
    v_pk_fma_f32 v[162:163], v[194:195], v[6:7], v[162:163] op_sel_hi:[1,0,1]
    v_pk_fma_f32 v[164:165], v[196:197], v[6:7], v[164:165] op_sel_hi:[1,0,1]
    v_pk_fma_f32 v[166:167], v[198:199], v[6:7], v[166:167] op_sel_hi:[1,0,1]
    v_cvt_pk_bf16_f32 v32, v160, v161
    v_cvt_pk_bf16_f32 v33, v162, v163
    v_cvt_pk_bf16_f32 v34, v164, v165
    v_cvt_pk_bf16_f32 v35, v166, v167
    buffer_store_dwordx4 v[32:35], v242, s[12:15], s85 offen offset:2048 sc1
    v_pk_mul_f32 v[168:169], v[168:169], v[10:11] op_sel_hi:[1,0]
    v_pk_mul_f32 v[170:171], v[170:171], v[10:11] op_sel_hi:[1,0]
    v_pk_mul_f32 v[172:173], v[172:173], v[10:11] op_sel_hi:[1,0]
    v_pk_mul_f32 v[174:175], v[174:175], v[10:11] op_sel_hi:[1,0]
    v_pk_fma_f32 v[168:169], v[200:201], v[6:7], v[168:169] op_sel_hi:[1,0,1]
    v_pk_fma_f32 v[170:171], v[202:203], v[6:7], v[170:171] op_sel_hi:[1,0,1]
    v_pk_fma_f32 v[172:173], v[204:205], v[6:7], v[172:173] op_sel_hi:[1,0,1]
    v_pk_fma_f32 v[174:175], v[206:207], v[6:7], v[174:175] op_sel_hi:[1,0,1]
    v_cvt_pk_bf16_f32 v36, v168, v169
    v_cvt_pk_bf16_f32 v37, v170, v171
    v_cvt_pk_bf16_f32 v38, v172, v173
    v_cvt_pk_bf16_f32 v39, v174, v175
    buffer_store_dwordx4 v[36:39], v242, s[12:15], s85 offen offset:2560 sc1
    s_waitcnt lgkmcnt(6)
    v_mfma_f32_16x16x32_bf16 v[64:67], v[16:19], a[160:163], 0
    ds_read_b64_tr_b16 v[32:33], v56 offset:4096
    v_mfma_f32_16x16x32_bf16 v[80:83], v[16:19], a[176:179], 0
    s_waitcnt lgkmcnt(5)
    s_xor_b32 s68, s88, 24576
    ds_read_b64_tr_b16 v[34:35], v56 offset:4608
    v_and_b32 v6, 0x7fffffff, v232
    v_mfma_f32_16x16x32_bf16 v[68:71], v[20:23], a[160:163], 0
    buffer_load_dwordx4 a[88:91], v245, s[12:15], s68 offen offset:0 sc1
    ds_read_b64_tr_b16 v[36:37], v57 offset:4096
    v_mfma_f32_16x16x32_bf16 v[84:87], v[20:23], a[176:179], 0
    s_waitcnt lgkmcnt(5)
    ds_read_b64_tr_b16 v[38:39], v57 offset:4608
    v_mov_b32 v8, v6
    v_mfma_f32_16x16x32_bf16 v[72:75], v[24:27], a[160:163], 0
    ds_read_b64_tr_b16 v[40:41], v58 offset:4096
    v_mfma_f32_16x16x32_bf16 v[88:91], v[24:27], a[176:179], 0
    s_waitcnt lgkmcnt(5)
    ds_read_b64_tr_b16 v[42:43], v58 offset:4608
    v_add_u32 v52, 16384, v240
    v_mfma_f32_16x16x32_bf16 v[76:79], v[28:31], a[160:163], 0
    buffer_load_dwordx4 a[92:95], v246, s[12:15], s68 offen offset:0 sc1
    ds_read_b64_tr_b16 v[44:45], v59 offset:4096
    v_mfma_f32_16x16x32_bf16 v[92:95], v[28:31], a[176:179], 0
    s_waitcnt lgkmcnt(5)
    ds_read_b64_tr_b16 v[46:47], v59 offset:4608
    v_permlane32_swap_b32 v6, v8
    v_mfma_f32_16x16x32_bf16 v[64:67], v[32:35], a[164:167], v[64:67]
    ds_read_b64_tr_b16 v[16:17], v60 offset:0
    v_mfma_f32_16x16x32_bf16 v[80:83], v[32:35], a[180:183], v[80:83]
    s_waitcnt lgkmcnt(5)
    s_xor_b32 s68, s88, 32768
    ds_read_b64_tr_b16 v[18:19], v60 offset:512
    v_xor_b32 v53, 4096, v52
    v_mfma_f32_16x16x32_bf16 v[68:71], v[36:39], a[164:167], v[68:71]
    buffer_load_dwordx4 a[96:99], v245, s[12:15], s68 offen offset:0 sc1
    ds_read_b64_tr_b16 v[20:21], v61 offset:0
    v_mfma_f32_16x16x32_bf16 v[84:87], v[36:39], a[180:183], v[84:87]
    s_waitcnt lgkmcnt(5)
    ds_read_b64_tr_b16 v[22:23], v61 offset:512
    v_mov_b32 v8, v6
    v_mfma_f32_16x16x32_bf16 v[72:75], v[40:43], a[164:167], v[72:75]
    ds_read_b64_tr_b16 v[24:25], v62 offset:0
    v_mfma_f32_16x16x32_bf16 v[88:91], v[40:43], a[180:183], v[88:91]
    s_waitcnt lgkmcnt(5)
    ds_read_b64_tr_b16 v[26:27], v62 offset:512
    s_nop 0
    v_mfma_f32_16x16x32_bf16 v[76:79], v[44:47], a[164:167], v[76:79]
    buffer_load_dwordx4 a[100:103], v246, s[12:15], s68 offen offset:0 sc1
    ds_read_b64_tr_b16 v[28:29], v63 offset:0
    v_mfma_f32_16x16x32_bf16 v[92:95], v[44:47], a[180:183], v[92:95]
    s_waitcnt lgkmcnt(5)
    ds_read_b64_tr_b16 v[30:31], v63 offset:512
    v_permlane16_swap_b32 v6, v8
    v_mfma_f32_16x16x32_bf16 v[64:67], v[16:19], a[168:171], v[64:67]
    ds_read_b64_tr_b16 v[32:33], v60 offset:4096
    v_mfma_f32_16x16x32_bf16 v[80:83], v[16:19], a[184:187], v[80:83]
    s_waitcnt lgkmcnt(5)
    s_xor_b32 s68, s88, 40960
    ds_read_b64_tr_b16 v[34:35], v60 offset:4608
    s_nop 0
    v_mfma_f32_16x16x32_bf16 v[68:71], v[20:23], a[168:171], v[68:71]
    buffer_load_dwordx4 a[104:107], v245, s[12:15], s68 offen offset:0 sc1
    ds_read_b64_tr_b16 v[36:37], v61 offset:4096
    v_mfma_f32_16x16x32_bf16 v[84:87], v[20:23], a[184:187], v[84:87]
    s_waitcnt lgkmcnt(5)
    ds_read_b64_tr_b16 v[38:39], v61 offset:4608
    v_sub_f32 v10, 1.0, v6
    v_mfma_f32_16x16x32_bf16 v[72:75], v[24:27], a[168:171], v[72:75]
    ds_read_b64_tr_b16 v[40:41], v62 offset:4096
    v_mfma_f32_16x16x32_bf16 v[88:91], v[24:27], a[184:187], v[88:91]
    s_waitcnt lgkmcnt(5)
    ds_read_b64_tr_b16 v[42:43], v62 offset:4608
    v_sub_f32 v12, 1.0, v8
    v_mfma_f32_16x16x32_bf16 v[76:79], v[28:31], a[168:171], v[76:79]
    buffer_load_dwordx4 a[108:111], v246, s[12:15], s68 offen offset:0 sc1
    ds_read_b64_tr_b16 v[44:45], v63 offset:4096
    v_mfma_f32_16x16x32_bf16 v[92:95], v[28:31], a[184:187], v[92:95]
    s_waitcnt lgkmcnt(5)
    ds_read_b64_tr_b16 v[46:47], v63 offset:4608
    v_mul_f32 v10, s93, v10
    v_mfma_f32_16x16x32_bf16 v[64:67], v[32:35], a[172:175], v[64:67]
    ds_read_b64_tr_b16 v[16:17], v48 offset:0
    v_mfma_f32_16x16x32_bf16 v[80:83], v[32:35], a[188:191], v[80:83]
    s_waitcnt lgkmcnt(5)
    s_xor_b32 s68, s88, 49152
    ds_read_b64_tr_b16 v[18:19], v48 offset:1024
    v_mul_f32 v12, s93, v12
    v_mfma_f32_16x16x32_bf16 v[68:71], v[36:39], a[172:175], v[68:71]
    buffer_load_dwordx4 a[112:115], v245, s[12:15], s68 offen offset:0 sc1
    ds_read_b64_tr_b16 v[20:21], v49 offset:0
    v_mfma_f32_16x16x32_bf16 v[84:87], v[36:39], a[188:191], v[84:87]
    s_waitcnt lgkmcnt(5)
    ds_read_b64_tr_b16 v[22:23], v49 offset:1024
    v_mfma_f32_16x16x32_bf16 v[72:75], v[40:43], a[172:175], v[72:75]
    ds_read_b64_tr_b16 v[24:25], v50 offset:0
    v_mfma_f32_16x16x32_bf16 v[88:91], v[40:43], a[188:191], v[88:91]
    s_waitcnt lgkmcnt(5)
    ds_read_b64_tr_b16 v[26:27], v50 offset:1024
    v_mfma_f32_16x16x32_bf16 v[76:79], v[44:47], a[172:175], v[76:79]
    buffer_load_dwordx4 a[116:119], v246, s[12:15], s68 offen offset:0 sc1
    ds_read_b64_tr_b16 v[28:29], v51 offset:0
    v_mfma_f32_16x16x32_bf16 v[92:95], v[44:47], a[188:191], v[92:95]
    ds_read_b64_tr_b16 v[30:31], v51 offset:1024
    s_cmp_lg_u32 s45, 0
    s_cbranch_scc1 L_fin_wo
    v_add_u32 v56, s91, v243
    v_xor_b32 v57, 32, v56
    v_xor_b32 v58, 64, v56
    v_xor_b32 v59, 96, v56
    v_add_u32 v60, s92, v243
    v_xor_b32 v61, 32, v60
    v_xor_b32 v62, 64, v60
    v_xor_b32 v63, 96, v60
    ds_read_b64_tr_b16 v[16:17], v56 offset:0
    ds_read_b64_tr_b16 v[18:19], v56 offset:512
    ds_read_b64_tr_b16 v[20:21], v57 offset:0
    ds_read_b64_tr_b16 v[22:23], v57 offset:512
    ds_read_b64_tr_b16 v[24:25], v58 offset:0
    ds_read_b64_tr_b16 v[26:27], v58 offset:512
    ds_read_b64_tr_b16 v[28:29], v59 offset:0
    ds_read_b64_tr_b16 v[30:31], v59 offset:512
    s_waitcnt lgkmcnt(6)
    v_mfma_f32_16x16x32_bf16 v[128:131], v[16:19], a[160:163], 0
    ds_read_b64_tr_b16 v[32:33], v56 offset:4096
    v_mfma_f32_16x16x32_bf16 v[144:147], v[16:19], a[176:179], 0
    s_waitcnt lgkmcnt(5)
    ds_read_b64_tr_b16 v[34:35], v56 offset:4608
    v_mfma_f32_16x16x32_bf16 v[132:135], v[20:23], a[160:163], 0
    ds_read_b64_tr_b16 v[36:37], v57 offset:4096
    v_mfma_f32_16x16x32_bf16 v[148:151], v[20:23], a[176:179], 0
    s_waitcnt lgkmcnt(5)
    ds_read_b64_tr_b16 v[38:39], v57 offset:4608
    v_mfma_f32_16x16x32_bf16 v[136:139], v[24:27], a[160:163], 0
    ds_read_b64_tr_b16 v[40:41], v58 offset:4096
    v_mfma_f32_16x16x32_bf16 v[152:155], v[24:27], a[176:179], 0
    s_waitcnt lgkmcnt(5)
    ds_read_b64_tr_b16 v[42:43], v58 offset:4608
    v_mfma_f32_16x16x32_bf16 v[140:143], v[28:31], a[160:163], 0
    ds_read_b64_tr_b16 v[44:45], v59 offset:4096
    v_mfma_f32_16x16x32_bf16 v[156:159], v[28:31], a[176:179], 0
    s_waitcnt lgkmcnt(5)
    ds_read_b64_tr_b16 v[46:47], v59 offset:4608
    v_mfma_f32_16x16x32_bf16 v[128:131], v[32:35], a[164:167], v[128:131]
    ds_read_b64_tr_b16 v[16:17], v60 offset:0
    v_mfma_f32_16x16x32_bf16 v[144:147], v[32:35], a[180:183], v[144:147]
    s_waitcnt lgkmcnt(5)
    ds_read_b64_tr_b16 v[18:19], v60 offset:512
    v_mfma_f32_16x16x32_bf16 v[132:135], v[36:39], a[164:167], v[132:135]
    ds_read_b64_tr_b16 v[20:21], v61 offset:0
    v_mfma_f32_16x16x32_bf16 v[148:151], v[36:39], a[180:183], v[148:151]
    s_waitcnt lgkmcnt(5)
    ds_read_b64_tr_b16 v[22:23], v61 offset:512
    v_mfma_f32_16x16x32_bf16 v[136:139], v[40:43], a[164:167], v[136:139]
    ds_read_b64_tr_b16 v[24:25], v62 offset:0
    v_mfma_f32_16x16x32_bf16 v[152:155], v[40:43], a[180:183], v[152:155]
    s_waitcnt lgkmcnt(5)
    ds_read_b64_tr_b16 v[26:27], v62 offset:512
    v_mfma_f32_16x16x32_bf16 v[140:143], v[44:47], a[164:167], v[140:143]
    ds_read_b64_tr_b16 v[28:29], v63 offset:0
    v_mfma_f32_16x16x32_bf16 v[156:159], v[44:47], a[180:183], v[156:159]
    s_waitcnt lgkmcnt(5)
    ds_read_b64_tr_b16 v[30:31], v63 offset:512
    v_mfma_f32_16x16x32_bf16 v[128:131], v[16:19], a[168:171], v[128:131]
    ds_read_b64_tr_b16 v[32:33], v60 offset:4096
    v_mfma_f32_16x16x32_bf16 v[144:147], v[16:19], a[184:187], v[144:147]
    s_waitcnt lgkmcnt(5)
    ds_read_b64_tr_b16 v[34:35], v60 offset:4608
    v_mfma_f32_16x16x32_bf16 v[132:135], v[20:23], a[168:171], v[132:135]
    ds_read_b64_tr_b16 v[36:37], v61 offset:4096
    v_mfma_f32_16x16x32_bf16 v[148:151], v[20:23], a[184:187], v[148:151]
    s_waitcnt lgkmcnt(5)
    ds_read_b64_tr_b16 v[38:39], v61 offset:4608
    v_mfma_f32_16x16x32_bf16 v[136:139], v[24:27], a[168:171], v[136:139]
    ds_read_b64_tr_b16 v[40:41], v62 offset:4096
    v_mfma_f32_16x16x32_bf16 v[152:155], v[24:27], a[184:187], v[152:155]
    s_waitcnt lgkmcnt(5)
    ds_read_b64_tr_b16 v[42:43], v62 offset:4608
    v_mfma_f32_16x16x32_bf16 v[140:143], v[28:31], a[168:171], v[140:143]
    ds_read_b64_tr_b16 v[44:45], v63 offset:4096
    v_mfma_f32_16x16x32_bf16 v[156:159], v[28:31], a[184:187], v[156:159]
    s_waitcnt lgkmcnt(5)
    ds_read_b64_tr_b16 v[46:47], v63 offset:4608
    v_mfma_f32_16x16x32_bf16 v[128:131], v[32:35], a[172:175], v[128:131]
    ds_read_b64_tr_b16 v[16:17], v48 offset:0
    v_mfma_f32_16x16x32_bf16 v[144:147], v[32:35], a[188:191], v[144:147]
    s_waitcnt lgkmcnt(5)
    ds_read_b64_tr_b16 v[18:19], v48 offset:1024
    v_mfma_f32_16x16x32_bf16 v[132:135], v[36:39], a[172:175], v[132:135]
    ds_read_b64_tr_b16 v[20:21], v49 offset:0
    v_mfma_f32_16x16x32_bf16 v[148:151], v[36:39], a[188:191], v[148:151]
    s_waitcnt lgkmcnt(5)
    ds_read_b64_tr_b16 v[22:23], v49 offset:1024
    v_mfma_f32_16x16x32_bf16 v[136:139], v[40:43], a[172:175], v[136:139]
    ds_read_b64_tr_b16 v[24:25], v50 offset:0
    v_mfma_f32_16x16x32_bf16 v[152:155], v[40:43], a[188:191], v[152:155]
    s_waitcnt lgkmcnt(5)
    ds_read_b64_tr_b16 v[26:27], v50 offset:1024
    v_mfma_f32_16x16x32_bf16 v[140:143], v[44:47], a[172:175], v[140:143]
    ds_read_b64_tr_b16 v[28:29], v51 offset:0
    v_mfma_f32_16x16x32_bf16 v[156:159], v[44:47], a[188:191], v[156:159]
    ds_read_b64_tr_b16 v[30:31], v51 offset:1024
L_pg7:
    s_cbranch_execz L_main
    v_mov_b32 v2, s94
    v_add_f32 v2, v2, v2
    s_nop 5
    v_pk_fma_f32 v[64:65], v[128:129], v[2:3], v[64:65] op_sel_hi:[1,0,1]
    v_pk_fma_f32 v[66:67], v[130:131], v[2:3], v[66:67] op_sel_hi:[1,0,1]
    v_pk_fma_f32 v[68:69], v[132:133], v[2:3], v[68:69] op_sel_hi:[1,0,1]
    v_pk_fma_f32 v[70:71], v[134:135], v[2:3], v[70:71] op_sel_hi:[1,0,1]
    v_pk_fma_f32 v[72:73], v[136:137], v[2:3], v[72:73] op_sel_hi:[1,0,1]
    v_pk_fma_f32 v[74:75], v[138:139], v[2:3], v[74:75] op_sel_hi:[1,0,1]
    v_pk_fma_f32 v[76:77], v[140:141], v[2:3], v[76:77] op_sel_hi:[1,0,1]
    v_pk_fma_f32 v[78:79], v[142:143], v[2:3], v[78:79] op_sel_hi:[1,0,1]
    v_pk_fma_f32 v[80:81], v[144:145], v[2:3], v[80:81] op_sel_hi:[1,0,1]
    v_pk_fma_f32 v[82:83], v[146:147], v[2:3], v[82:83] op_sel_hi:[1,0,1]
    v_pk_fma_f32 v[84:85], v[148:149], v[2:3], v[84:85] op_sel_hi:[1,0,1]
    v_pk_fma_f32 v[86:87], v[150:151], v[2:3], v[86:87] op_sel_hi:[1,0,1]
    v_pk_fma_f32 v[88:89], v[152:153], v[2:3], v[88:89] op_sel_hi:[1,0,1]
    v_pk_fma_f32 v[90:91], v[154:155], v[2:3], v[90:91] op_sel_hi:[1,0,1]
    v_pk_fma_f32 v[92:93], v[156:157], v[2:3], v[92:93] op_sel_hi:[1,0,1]
    v_pk_fma_f32 v[94:95], v[158:159], v[2:3], v[94:95] op_sel_hi:[1,0,1]
L_fin_wo:
    s_waitcnt vmcnt(14) lgkmcnt(6)
    v_mfma_f32_16x16x32_bf16 v[96:99], v[16:19], a[64:67], 0
    s_waitcnt vmcnt(8)
    buffer_store_dword v210, v211, s[32:35], s86 offen sc1
    ds_read_b64_tr_b16 v[32:33], v48 offset:4096
    v_mfma_f32_16x16x32_bf16 v[112:115], v[16:19], a[68:71], 0
    s_waitcnt lgkmcnt(5)
    s_xor_b32 s68, s88, 57344
    ds_read_b64_tr_b16 v[34:35], v48 offset:5120
    v_mfma_f32_16x16x32_bf16 v[100:103], v[20:23], a[64:67], 0
    buffer_load_dwordx4 a[120:123], v245, s[12:15], s68 offen offset:0 sc1
    ds_read_b64_tr_b16 v[36:37], v49 offset:4096
    v_mfma_f32_16x16x32_bf16 v[116:119], v[20:23], a[68:71], 0
    s_waitcnt lgkmcnt(5)
    ds_read_b64_tr_b16 v[38:39], v49 offset:5120
    v_mfma_f32_16x16x32_bf16 v[104:107], v[24:27], a[64:67], 0
    ds_read_b64_tr_b16 v[40:41], v50 offset:4096
    v_mfma_f32_16x16x32_bf16 v[120:123], v[24:27], a[68:71], 0
    s_waitcnt lgkmcnt(5)
    ds_read_b64_tr_b16 v[42:43], v50 offset:5120
    v_mfma_f32_16x16x32_bf16 v[108:111], v[28:31], a[64:67], 0
    buffer_load_dwordx4 a[124:127], v246, s[12:15], s68 offen offset:0 sc1
    ds_read_b64_tr_b16 v[44:45], v51 offset:4096
    v_mfma_f32_16x16x32_bf16 v[124:127], v[28:31], a[68:71], 0
    s_waitcnt lgkmcnt(5)
    ds_read_b64_tr_b16 v[46:47], v51 offset:5120
    v_mfma_f32_16x16x32_bf16 v[96:99], v[32:35], a[72:75], v[96:99]
    ds_read_b64_tr_b16 v[176:177], v48 offset:8192
    v_mul_f32 v64, v64, v10
    v_mfma_f32_16x16x32_bf16 v[112:115], v[32:35], a[76:79], v[112:115]
    s_waitcnt lgkmcnt(5)
    s_xor_b32 s68, s88, 65536
    ds_read_b64_tr_b16 v[178:179], v48 offset:9216
    v_mul_f32 v65, v65, v10
    v_mfma_f32_16x16x32_bf16 v[100:103], v[36:39], a[72:75], v[100:103]
    buffer_load_dwordx4 a[64:67], v245, s[12:15], s68 offen offset:0 sc1
    ds_read_b64_tr_b16 v[180:181], v49 offset:8192
    v_mfma_f32_16x16x32_bf16 v[116:119], v[36:39], a[76:79], v[116:119]
    s_waitcnt lgkmcnt(5)
    ds_read_b64_tr_b16 v[182:183], v49 offset:9216
    v_mul_f32 v66, v66, v10
    v_mfma_f32_16x16x32_bf16 v[104:107], v[40:43], a[72:75], v[104:107]
    ds_read_b64_tr_b16 v[184:185], v50 offset:8192
    v_mul_f32 v67, v67, v10
    v_mfma_f32_16x16x32_bf16 v[120:123], v[40:43], a[76:79], v[120:123]
    s_waitcnt lgkmcnt(5)
    ds_read_b64_tr_b16 v[186:187], v50 offset:9216
    v_mul_f32 v68, v68, v10
    v_mfma_f32_16x16x32_bf16 v[108:111], v[44:47], a[72:75], v[108:111]
    buffer_load_dwordx4 a[68:71], v246, s[12:15], s68 offen offset:0 sc1
    ds_read_b64_tr_b16 v[188:189], v51 offset:8192
    v_mfma_f32_16x16x32_bf16 v[124:127], v[44:47], a[76:79], v[124:127]
    s_waitcnt lgkmcnt(5)
    ds_read_b64_tr_b16 v[190:191], v51 offset:9216
    v_mul_f32 v69, v69, v10
    v_mfma_f32_16x16x32_bf16 v[96:99], v[176:179], a[80:83], v[96:99]
    ds_read_b64_tr_b16 v[192:193], v48 offset:12288
    v_mul_f32 v70, v70, v10
    v_mfma_f32_16x16x32_bf16 v[112:115], v[176:179], a[84:87], v[112:115]
    s_waitcnt lgkmcnt(5)
    s_xor_b32 s68, s88, 73728
    ds_read_b64_tr_b16 v[194:195], v48 offset:13312
    v_mul_f32 v71, v71, v10
    v_mfma_f32_16x16x32_bf16 v[100:103], v[180:183], a[80:83], v[100:103]
    buffer_load_dwordx4 a[72:75], v245, s[12:15], s68 offen offset:0 sc1
    ds_read_b64_tr_b16 v[196:197], v49 offset:12288
    v_mfma_f32_16x16x32_bf16 v[116:119], v[180:183], a[84:87], v[116:119]
    s_waitcnt lgkmcnt(5)
    ds_read_b64_tr_b16 v[198:199], v49 offset:13312
    v_mul_f32 v72, v72, v10
    v_mfma_f32_16x16x32_bf16 v[104:107], v[184:187], a[80:83], v[104:107]
    ds_read_b64_tr_b16 v[200:201], v50 offset:12288
    v_mul_f32 v73, v73, v10
    v_mfma_f32_16x16x32_bf16 v[120:123], v[184:187], a[84:87], v[120:123]
    s_waitcnt lgkmcnt(5)
    ds_read_b64_tr_b16 v[202:203], v50 offset:13312
    v_mul_f32 v74, v74, v10
    v_mfma_f32_16x16x32_bf16 v[108:111], v[188:191], a[80:83], v[108:111]
    buffer_load_dwordx4 a[76:79], v246, s[12:15], s68 offen offset:0 sc1
    ds_read_b64_tr_b16 v[204:205], v51 offset:12288
    v_mfma_f32_16x16x32_bf16 v[124:127], v[188:191], a[84:87], v[124:127]
    s_waitcnt vmcnt(13) lgkmcnt(5)
    ds_read_b64_tr_b16 v[206:207], v51 offset:13312
    v_mul_f32 v75, v75, v10
    v_mfma_f32_16x16x32_bf16 v[96:99], v[192:195], a[88:91], v[96:99]
    ds_read_b64_tr_b16 a[0:1], v48 offset:16384
    v_mul_f32 v76, v76, v10
    v_mfma_f32_16x16x32_bf16 v[112:115], v[192:195], a[92:95], v[112:115]
    s_waitcnt lgkmcnt(5)
    s_xor_b32 s68, s88, 81920
    ds_read_b64_tr_b16 a[2:3], v48 offset:17408
    v_mul_f32 v77, v77, v10
    v_mfma_f32_16x16x32_bf16 v[100:103], v[196:199], a[88:91], v[100:103]
    buffer_load_dwordx4 a[80:83], v245, s[12:15], s68 offen offset:0 sc1
    ds_read_b64_tr_b16 a[4:5], v49 offset:16384
    v_mfma_f32_16x16x32_bf16 v[116:119], v[196:199], a[92:95], v[116:119]
    s_waitcnt lgkmcnt(5)
    ds_read_b64_tr_b16 a[6:7], v49 offset:17408
    v_mul_f32 v78, v78, v10
    v_mfma_f32_16x16x32_bf16 v[104:107], v[200:203], a[88:91], v[104:107]
    ds_read_b64_tr_b16 a[8:9], v50 offset:16384
    v_mul_f32 v79, v79, v10
    v_mfma_f32_16x16x32_bf16 v[120:123], v[200:203], a[92:95], v[120:123]
    s_waitcnt lgkmcnt(5)
    ds_read_b64_tr_b16 a[10:11], v50 offset:17408
    v_mul_f32 v80, v80, v12
    v_mfma_f32_16x16x32_bf16 v[108:111], v[204:207], a[88:91], v[108:111]
    buffer_load_dwordx4 a[84:87], v246, s[12:15], s68 offen offset:0 sc1
    ds_read_b64_tr_b16 a[12:13], v51 offset:16384
    v_mfma_f32_16x16x32_bf16 v[124:127], v[204:207], a[92:95], v[124:127]
    s_waitcnt vmcnt(13) lgkmcnt(5)
    ds_read_b64_tr_b16 a[14:15], v51 offset:17408
    v_mul_f32 v81, v81, v12
    v_mfma_f32_16x16x32_bf16 v[96:99], a[0:3], a[96:99], v[96:99]
    ds_read_b64_tr_b16 a[16:17], v48 offset:20480
    v_mul_f32 v82, v82, v12
    v_mfma_f32_16x16x32_bf16 v[112:115], a[0:3], a[100:103], v[112:115]
    s_waitcnt lgkmcnt(5)
    s_xor_b32 s68, s88, 90112
    ds_read_b64_tr_b16 a[18:19], v48 offset:21504
    v_mul_f32 v83, v83, v12
    v_mfma_f32_16x16x32_bf16 v[100:103], a[4:7], a[96:99], v[100:103]
    buffer_load_dwordx4 a[88:91], v245, s[12:15], s68 offen offset:0 sc1
    ds_read_b64_tr_b16 a[20:21], v49 offset:20480
    v_mfma_f32_16x16x32_bf16 v[116:119], a[4:7], a[100:103], v[116:119]
    s_waitcnt lgkmcnt(5)
    ds_read_b64_tr_b16 a[22:23], v49 offset:21504
    v_mul_f32 v84, v84, v12
    v_mfma_f32_16x16x32_bf16 v[104:107], a[8:11], a[96:99], v[104:107]
    s_barrier
    ds_read_b64_tr_b16 a[24:25], v50 offset:20480
    v_mfma_f32_16x16x32_bf16 v[120:123], a[8:11], a[100:103], v[120:123]
    s_waitcnt lgkmcnt(5)
    ds_read_b64_tr_b16 a[26:27], v50 offset:21504
    v_mul_f32 v85, v85, v12
    v_mfma_f32_16x16x32_bf16 v[108:111], a[12:15], a[96:99], v[108:111]
    buffer_load_dwordx4 a[92:95], v246, s[12:15], s68 offen offset:0 sc1
    ds_read_b64_tr_b16 a[28:29], v51 offset:20480
    v_mfma_f32_16x16x32_bf16 v[124:127], a[12:15], a[100:103], v[124:127]
    s_waitcnt vmcnt(13) lgkmcnt(5)
    ds_read_b64_tr_b16 a[30:31], v51 offset:21504
    v_mul_f32 v86, v86, v12
    v_mfma_f32_16x16x32_bf16 v[96:99], a[16:19], a[104:107], v[96:99]
    ds_read_b64_tr_b16 a[32:33], v48 offset:24576
    v_mul_f32 v87, v87, v12
    v_mfma_f32_16x16x32_bf16 v[112:115], a[16:19], a[108:111], v[112:115]
    s_waitcnt lgkmcnt(5)
    s_xor_b32 s68, s88, 98304
    ds_read_b64_tr_b16 a[34:35], v48 offset:25600
    v_mul_f32 v88, v88, v12
    v_mfma_f32_16x16x32_bf16 v[100:103], a[20:23], a[104:107], v[100:103]
    buffer_load_dwordx4 a[96:99], v245, s[12:15], s68 offen offset:0 sc1
    ds_read_b64_tr_b16 a[36:37], v49 offset:24576
    v_mfma_f32_16x16x32_bf16 v[116:119], a[20:23], a[108:111], v[116:119]
    s_waitcnt lgkmcnt(5)
    ds_read_b64_tr_b16 a[38:39], v49 offset:25600
    v_mul_f32 v89, v89, v12
    v_mfma_f32_16x16x32_bf16 v[104:107], a[24:27], a[104:107], v[104:107]
    ds_read_b64_tr_b16 a[40:41], v50 offset:24576
    v_mul_f32 v90, v90, v12
    v_mfma_f32_16x16x32_bf16 v[120:123], a[24:27], a[108:111], v[120:123]
    s_waitcnt lgkmcnt(5)
    ds_read_b64_tr_b16 a[42:43], v50 offset:25600
    v_mul_f32 v91, v91, v12
    v_mfma_f32_16x16x32_bf16 v[108:111], a[28:31], a[104:107], v[108:111]
    buffer_load_dwordx4 a[100:103], v246, s[12:15], s68 offen offset:0 sc1
    ds_read_b64_tr_b16 a[44:45], v51 offset:24576
    v_mfma_f32_16x16x32_bf16 v[124:127], a[28:31], a[108:111], v[124:127]
    s_waitcnt vmcnt(13) lgkmcnt(5)
    ds_read_b64_tr_b16 a[46:47], v51 offset:25600
    v_mul_f32 v92, v92, v12
    v_mfma_f32_16x16x32_bf16 v[96:99], a[32:35], a[112:115], v[96:99]
    ds_read_b64_tr_b16 a[48:49], v48 offset:28672
    v_mul_f32 v93, v93, v12
    v_mfma_f32_16x16x32_bf16 v[112:115], a[32:35], a[116:119], v[112:115]
    s_waitcnt lgkmcnt(5)
    s_xor_b32 s68, s88, 106496
    ds_read_b64_tr_b16 a[50:51], v48 offset:29696
    v_mul_f32 v94, v94, v12
    v_mfma_f32_16x16x32_bf16 v[100:103], a[36:39], a[112:115], v[100:103]
    buffer_load_dwordx4 a[104:107], v245, s[12:15], s68 offen offset:0 sc1
    ds_read_b64_tr_b16 a[52:53], v49 offset:28672
    v_mfma_f32_16x16x32_bf16 v[116:119], a[36:39], a[116:119], v[116:119]
    s_waitcnt lgkmcnt(5)
    ds_read_b64_tr_b16 a[54:55], v49 offset:29696
    v_mul_f32 v95, v95, v12
    v_mfma_f32_16x16x32_bf16 v[104:107], a[40:43], a[112:115], v[104:107]
    ds_read_b64_tr_b16 a[56:57], v50 offset:28672
    v_mfma_f32_16x16x32_bf16 v[120:123], a[40:43], a[116:119], v[120:123]
    s_waitcnt lgkmcnt(5)
    ds_read_b64_tr_b16 a[58:59], v50 offset:29696
    v_mfma_f32_16x16x32_bf16 v[108:111], a[44:47], a[112:115], v[108:111]
    buffer_load_dwordx4 a[108:111], v246, s[12:15], s68 offen offset:0 sc1
    ds_read_b64_tr_b16 a[60:61], v51 offset:28672
    v_mfma_f32_16x16x32_bf16 v[124:127], a[44:47], a[116:119], v[124:127]
    s_waitcnt vmcnt(12) lgkmcnt(5)
    ds_read_b64_tr_b16 a[62:63], v51 offset:29696
    v_mfma_f32_16x16x32_bf16 v[96:99], a[48:51], a[120:123], v[96:99]
    ds_read_b64_tr_b16 a[128:129], v48 offset:32768
    v_mfma_f32_16x16x32_bf16 v[112:115], a[48:51], a[124:127], v[112:115]
    s_waitcnt lgkmcnt(5)
    s_xor_b32 s68, s88, 114688
    ds_read_b64_tr_b16 a[130:131], v48 offset:33792
    v_mfma_f32_16x16x32_bf16 v[100:103], a[52:55], a[120:123], v[100:103]
    buffer_load_dwordx4 a[112:115], v245, s[12:15], s68 offen offset:0 sc1
    ds_read_b64_tr_b16 a[132:133], v49 offset:32768
    v_mfma_f32_16x16x32_bf16 v[116:119], a[52:55], a[124:127], v[116:119]
    s_waitcnt lgkmcnt(5)
    ds_read_b64_tr_b16 a[134:135], v49 offset:33792
    v_mfma_f32_16x16x32_bf16 v[104:107], a[56:59], a[120:123], v[104:107]
    buffer_load_dword v15, v14, s[32:35], s87 offen sc1
    ds_read_b64_tr_b16 a[136:137], v50 offset:32768
    v_mfma_f32_16x16x32_bf16 v[120:123], a[56:59], a[124:127], v[120:123]
    s_waitcnt lgkmcnt(5)
    ds_read_b64_tr_b16 a[138:139], v50 offset:33792
    v_mfma_f32_16x16x32_bf16 v[108:111], a[60:63], a[120:123], v[108:111]
    buffer_load_dwordx4 a[116:119], v246, s[12:15], s68 offen offset:0 sc1
    ds_read_b64_tr_b16 a[140:141], v51 offset:32768
    v_mfma_f32_16x16x32_bf16 v[124:127], a[60:63], a[124:127], v[124:127]
    s_waitcnt vmcnt(13) lgkmcnt(5)
    ds_read_b64_tr_b16 a[142:143], v51 offset:33792
    v_mfma_f32_16x16x32_bf16 v[96:99], a[128:131], a[64:67], v[96:99]
    ds_read_b64_tr_b16 a[144:145], v48 offset:36864
    v_mfma_f32_16x16x32_bf16 v[112:115], a[128:131], a[68:71], v[112:115]
    s_waitcnt lgkmcnt(5)
    s_xor_b32 s68, s88, 122880
    ds_read_b64_tr_b16 a[146:147], v48 offset:37888
    v_mfma_f32_16x16x32_bf16 v[100:103], a[132:135], a[64:67], v[100:103]
    buffer_load_dwordx4 a[120:123], v245, s[12:15], s68 offen offset:0 sc1
    ds_read_b64_tr_b16 a[148:149], v49 offset:36864
    v_mfma_f32_16x16x32_bf16 v[116:119], a[132:135], a[68:71], v[116:119]
    s_waitcnt lgkmcnt(5)
    ds_read_b64_tr_b16 a[150:151], v49 offset:37888
    v_mfma_f32_16x16x32_bf16 v[104:107], a[136:139], a[64:67], v[104:107]
    ds_read_b64_tr_b16 a[152:153], v50 offset:36864
    v_mfma_f32_16x16x32_bf16 v[120:123], a[136:139], a[68:71], v[120:123]
    s_waitcnt lgkmcnt(5)
    ds_read_b64_tr_b16 a[154:155], v50 offset:37888
    v_mfma_f32_16x16x32_bf16 v[108:111], a[140:143], a[64:67], v[108:111]
    buffer_load_dwordx4 a[124:127], v246, s[12:15], s68 offen offset:0 sc1
    ds_read_b64_tr_b16 a[156:157], v51 offset:36864
    v_mfma_f32_16x16x32_bf16 v[124:127], a[140:143], a[68:71], v[124:127]
    s_waitcnt vmcnt(13) lgkmcnt(5)
    ds_read_b64_tr_b16 a[158:159], v51 offset:37888
    v_mfma_f32_16x16x32_bf16 v[96:99], a[144:147], a[72:75], v[96:99]
    ds_read_b64_tr_b16 a[160:161], v48 offset:40960
    v_mfma_f32_16x16x32_bf16 v[112:115], a[144:147], a[76:79], v[112:115]
    s_waitcnt lgkmcnt(5)
    ds_read_b64_tr_b16 a[162:163], v48 offset:41984
    v_mfma_f32_16x16x32_bf16 v[100:103], a[148:151], a[72:75], v[100:103]
    ds_read_b64_tr_b16 a[164:165], v49 offset:40960
    v_mfma_f32_16x16x32_bf16 v[116:119], a[148:151], a[76:79], v[116:119]
    s_waitcnt lgkmcnt(5)
    ds_read_b64_tr_b16 a[166:167], v49 offset:41984
    v_mfma_f32_16x16x32_bf16 v[104:107], a[152:155], a[72:75], v[104:107]
    ds_read_b64_tr_b16 a[168:169], v50 offset:40960
    v_mfma_f32_16x16x32_bf16 v[120:123], a[152:155], a[76:79], v[120:123]
    s_waitcnt lgkmcnt(5)
    ds_read_b64_tr_b16 a[170:171], v50 offset:41984
    v_mfma_f32_16x16x32_bf16 v[108:111], a[156:159], a[72:75], v[108:111]
    ds_read_b64_tr_b16 a[172:173], v51 offset:40960
    v_mfma_f32_16x16x32_bf16 v[124:127], a[156:159], a[76:79], v[124:127]
    s_waitcnt vmcnt(11) lgkmcnt(5)
    ds_read_b64_tr_b16 a[174:175], v51 offset:41984
    v_mfma_f32_16x16x32_bf16 v[96:99], a[160:163], a[80:83], v[96:99]
    ds_read_b64_tr_b16 a[176:177], v48 offset:45056
    v_mfma_f32_16x16x32_bf16 v[112:115], a[160:163], a[84:87], v[112:115]
    s_waitcnt lgkmcnt(5)
    ds_read_b64_tr_b16 a[178:179], v48 offset:46080
    v_mfma_f32_16x16x32_bf16 v[100:103], a[164:167], a[80:83], v[100:103]
    ds_read_b64_tr_b16 a[180:181], v49 offset:45056
    v_mfma_f32_16x16x32_bf16 v[116:119], a[164:167], a[84:87], v[116:119]
    s_waitcnt lgkmcnt(5)
    ds_read_b64_tr_b16 a[182:183], v49 offset:46080
    v_mfma_f32_16x16x32_bf16 v[104:107], a[168:171], a[80:83], v[104:107]
    ds_read_b64_tr_b16 a[184:185], v50 offset:45056
    v_mfma_f32_16x16x32_bf16 v[120:123], a[168:171], a[84:87], v[120:123]
    s_waitcnt lgkmcnt(5)
    ds_read_b64_tr_b16 a[186:187], v50 offset:46080
    v_mfma_f32_16x16x32_bf16 v[108:111], a[172:175], a[80:83], v[108:111]
    ds_read_b64_tr_b16 a[188:189], v51 offset:45056
    v_mfma_f32_16x16x32_bf16 v[124:127], a[172:175], a[84:87], v[124:127]
    s_waitcnt vmcnt(9) lgkmcnt(5)
    ds_read_b64_tr_b16 a[190:191], v51 offset:46080
    v_mfma_f32_16x16x32_bf16 v[96:99], a[176:179], a[88:91], v[96:99]
    ds_read_b64_tr_b16 a[192:193], v48 offset:49152
    v_mfma_f32_16x16x32_bf16 v[112:115], a[176:179], a[92:95], v[112:115]
    s_waitcnt lgkmcnt(5)
    ds_read_b64_tr_b16 a[194:195], v48 offset:50176
    v_mfma_f32_16x16x32_bf16 v[100:103], a[180:183], a[88:91], v[100:103]
    ds_read_b64_tr_b16 a[196:197], v49 offset:49152
    v_mfma_f32_16x16x32_bf16 v[116:119], a[180:183], a[92:95], v[116:119]
    s_waitcnt lgkmcnt(5)
    ds_read_b64_tr_b16 a[198:199], v49 offset:50176
    v_mfma_f32_16x16x32_bf16 v[104:107], a[184:187], a[88:91], v[104:107]
    s_waitcnt vmcnt(3)
    v_cmp_ne_u32 vcc, 0, v15
    ds_read_b64_tr_b16 a[200:201], v50 offset:49152
    v_mfma_f32_16x16x32_bf16 v[120:123], a[184:187], a[92:95], v[120:123]
    s_waitcnt lgkmcnt(5)
    ds_read_b64_tr_b16 a[202:203], v50 offset:50176
    v_mfma_f32_16x16x32_bf16 v[108:111], a[188:191], a[88:91], v[108:111]
    ds_read_b64_tr_b16 a[204:205], v51 offset:49152
    v_mfma_f32_16x16x32_bf16 v[124:127], a[188:191], a[92:95], v[124:127]
    s_waitcnt lgkmcnt(5)
    s_cmp_eq_u32 vcc_lo, 0xffff
    s_cbranch_scc0 L_ob_spin
L_ob_ok:
    ds_read_b64_tr_b16 a[206:207], v51 offset:50176
    v_mfma_f32_16x16x32_bf16 v[96:99], a[192:195], a[96:99], v[96:99]
    ds_read_b64_tr_b16 a[208:209], v48 offset:53248
    v_mfma_f32_16x16x32_bf16 v[112:115], a[192:195], a[100:103], v[112:115]
    s_waitcnt lgkmcnt(5)
    s_xor_b32 s68, s88, 0
    ds_read_b64_tr_b16 a[210:211], v48 offset:54272
    v_mfma_f32_16x16x32_bf16 v[100:103], a[196:199], a[96:99], v[100:103]
    buffer_load_dwordx4 a[64:67], v246, s[12:15], s68 offen offset:2048 sc1
    ds_read_b64_tr_b16 a[212:213], v49 offset:53248
    v_mfma_f32_16x16x32_bf16 v[116:119], a[196:199], a[100:103], v[116:119]
    s_waitcnt lgkmcnt(5)
    s_xor_b32 s68, s88, 8192
    ds_read_b64_tr_b16 a[214:215], v49 offset:54272
    v_mfma_f32_16x16x32_bf16 v[104:107], a[200:203], a[96:99], v[104:107]
    buffer_load_dwordx4 a[68:71], v246, s[12:15], s68 offen offset:2048 sc1
    ds_read_b64_tr_b16 a[216:217], v50 offset:53248
    v_mfma_f32_16x16x32_bf16 v[120:123], a[200:203], a[100:103], v[120:123]
    s_waitcnt lgkmcnt(5)
    s_xor_b32 s68, s88, 16384
    ds_read_b64_tr_b16 a[218:219], v50 offset:54272
    v_mfma_f32_16x16x32_bf16 v[108:111], a[204:207], a[96:99], v[108:111]
    buffer_load_dwordx4 a[72:75], v246, s[12:15], s68 offen offset:2048 sc1
    ds_read_b64_tr_b16 a[220:221], v51 offset:53248
    v_mfma_f32_16x16x32_bf16 v[124:127], a[204:207], a[100:103], v[124:127]
    s_waitcnt lgkmcnt(5)
    ds_read_b64_tr_b16 a[222:223], v51 offset:54272
    v_mfma_f32_16x16x32_bf16 v[96:99], a[208:211], a[104:107], v[96:99]
    ds_read_b64_tr_b16 a[224:225], v48 offset:57344
    v_mfma_f32_16x16x32_bf16 v[112:115], a[208:211], a[108:111], v[112:115]
    s_waitcnt lgkmcnt(5)
    s_xor_b32 s68, s88, 24576
    ds_read_b64_tr_b16 a[226:227], v48 offset:58368
    v_mfma_f32_16x16x32_bf16 v[100:103], a[212:215], a[104:107], v[100:103]
    buffer_load_dwordx4 a[76:79], v246, s[12:15], s68 offen offset:2048 sc1
    ds_read_b64_tr_b16 a[228:229], v49 offset:57344
    v_mfma_f32_16x16x32_bf16 v[116:119], a[212:215], a[108:111], v[116:119]
    s_waitcnt lgkmcnt(5)
    ds_read_b64_tr_b16 a[230:231], v49 offset:58368
    v_mfma_f32_16x16x32_bf16 v[104:107], a[216:219], a[104:107], v[104:107]
    ds_read_b64_tr_b16 a[232:233], v50 offset:57344
    v_mfma_f32_16x16x32_bf16 v[120:123], a[216:219], a[108:111], v[120:123]
    s_waitcnt lgkmcnt(5)
    s_xor_b32 s68, s88, 32768
    ds_read_b64_tr_b16 a[234:235], v50 offset:58368
    v_mfma_f32_16x16x32_bf16 v[108:111], a[220:223], a[104:107], v[108:111]
    buffer_load_dwordx4 a[80:83], v246, s[12:15], s68 offen offset:2048 sc1
    ds_read_b64_tr_b16 a[236:237], v51 offset:57344
    v_mfma_f32_16x16x32_bf16 v[124:127], a[220:223], a[108:111], v[124:127]
    s_waitcnt vmcnt(7) lgkmcnt(5)
    ds_read_b64_tr_b16 a[238:239], v51 offset:58368
    v_mfma_f32_16x16x32_bf16 v[96:99], a[224:227], a[112:115], v[96:99]
    ds_read_b64_tr_b16 a[240:241], v48 offset:61440
    v_mfma_f32_16x16x32_bf16 v[112:115], a[224:227], a[116:119], v[112:115]
    s_waitcnt lgkmcnt(5)
    s_xor_b32 s68, s88, 40960
    ds_read_b64_tr_b16 a[242:243], v48 offset:62464
    v_mfma_f32_16x16x32_bf16 v[100:103], a[228:231], a[112:115], v[100:103]
    buffer_load_dwordx4 a[84:87], v246, s[12:15], s68 offen offset:2048 sc1
    ds_read_b64_tr_b16 a[244:245], v49 offset:61440
    v_mfma_f32_16x16x32_bf16 v[116:119], a[228:231], a[116:119], v[116:119]
    s_waitcnt lgkmcnt(5)
    ds_read_b64_tr_b16 a[246:247], v49 offset:62464
    v_mfma_f32_16x16x32_bf16 v[104:107], a[232:235], a[112:115], v[104:107]
    ds_read_b64_tr_b16 a[248:249], v50 offset:61440
    v_mfma_f32_16x16x32_bf16 v[120:123], a[232:235], a[116:119], v[120:123]
    s_waitcnt lgkmcnt(5)
    s_xor_b32 s68, s88, 49152
    ds_read_b64_tr_b16 a[250:251], v50 offset:62464
    v_mfma_f32_16x16x32_bf16 v[108:111], a[236:239], a[112:115], v[108:111]
    buffer_load_dwordx4 a[88:91], v246, s[12:15], s68 offen offset:2048 sc1
    ds_read_b64_tr_b16 a[252:253], v51 offset:61440
    v_mfma_f32_16x16x32_bf16 v[124:127], a[236:239], a[116:119], v[124:127]
    s_waitcnt vmcnt(7) lgkmcnt(5)
    ds_read_b64_tr_b16 a[254:255], v51 offset:62464
    v_mfma_f32_16x16x32_bf16 v[96:99], a[240:243], a[120:123], v[96:99]
    v_mfma_f32_16x16x32_bf16 v[112:115], a[240:243], a[124:127], v[112:115]
    s_waitcnt lgkmcnt(4)
    s_xor_b32 s68, s88, 57344
    v_mfma_f32_16x16x32_bf16 v[100:103], a[244:247], a[120:123], v[100:103]
    buffer_load_dwordx4 a[92:95], v246, s[12:15], s68 offen offset:2048 sc1
    v_mfma_f32_16x16x32_bf16 v[116:119], a[244:247], a[124:127], v[116:119]
    s_waitcnt lgkmcnt(2)
    v_mfma_f32_16x16x32_bf16 v[104:107], a[248:251], a[120:123], v[104:107]
    v_mfma_f32_16x16x32_bf16 v[120:123], a[248:251], a[124:127], v[120:123]
    s_waitcnt lgkmcnt(0)
    s_xor_b32 s68, s88, 65536
    v_mfma_f32_16x16x32_bf16 v[108:111], a[252:255], a[120:123], v[108:111]
    buffer_load_dwordx4 a[96:99], v246, s[12:15], s68 offen offset:2048 sc1
    v_mfma_f32_16x16x32_bf16 v[124:127], a[252:255], a[124:127], v[124:127]
    s_xor_b32 s68, s88, 73728
    buffer_load_dwordx4 a[100:103], v246, s[12:15], s68 offen offset:2048 sc1
    ds_write_b128 v52, v[112:115] offset:0
    s_xor_b32 s68, s88, 81920
    buffer_load_dwordx4 a[104:107], v246, s[12:15], s68 offen offset:2048 sc1
    ds_write_b128 v52, v[116:119] offset:1024
    s_xor_b32 s68, s88, 90112
    buffer_load_dwordx4 a[108:111], v246, s[12:15], s68 offen offset:2048 sc1
    ds_write_b128 v52, v[120:123] offset:2048
    s_xor_b32 s68, s88, 98304
    buffer_load_dwordx4 a[112:115], v246, s[12:15], s68 offen offset:2048 sc1
    ds_write_b128 v52, v[124:127] offset:3072
    s_waitcnt vmcnt(12)
    v_mfma_f32_16x16x32_bf16 v[144:147], v[16:19], a[64:67], 0
    s_xor_b32 s68, s88, 106496
    v_mfma_f32_16x16x32_bf16 v[148:151], v[20:23], a[64:67], 0
    buffer_load_dwordx4 a[116:119], v246, s[12:15], s68 offen offset:2048 sc1
    v_mfma_f32_16x16x32_bf16 v[152:155], v[24:27], a[64:67], 0
    s_waitcnt lgkmcnt(0)
    s_barrier
    v_mfma_f32_16x16x32_bf16 v[156:159], v[28:31], a[64:67], 0
    s_waitcnt vmcnt(12)
    ds_read_b128 v[112:115], v53 offset:0
    v_mfma_f32_16x16x32_bf16 v[144:147], v[32:35], a[68:71], v[144:147]
    s_xor_b32 s68, s88, 114688
    ds_read_b128 v[116:119], v53 offset:1024
    v_mfma_f32_16x16x32_bf16 v[148:151], v[36:39], a[68:71], v[148:151]
    buffer_load_dwordx4 a[120:123], v246, s[12:15], s68 offen offset:2048 sc1
    v_mfma_f32_16x16x32_bf16 v[152:155], v[40:43], a[68:71], v[152:155]
    ds_read_b128 v[120:123], v53 offset:2048
    v_mfma_f32_16x16x32_bf16 v[156:159], v[44:47], a[68:71], v[156:159]
    s_waitcnt vmcnt(12)
    ds_read_b128 v[124:127], v53 offset:3072
    v_mfma_f32_16x16x32_bf16 v[144:147], v[176:179], a[72:75], v[144:147]
    s_xor_b32 s68, s88, 122880
    v_mfma_f32_16x16x32_bf16 v[148:151], v[180:183], a[72:75], v[148:151]
    buffer_load_dwordx4 a[124:127], v246, s[12:15], s68 offen offset:2048 sc1
    v_mfma_f32_16x16x32_bf16 v[152:155], v[184:187], a[72:75], v[152:155]
    v_mfma_f32_16x16x32_bf16 v[156:159], v[188:191], a[72:75], v[156:159]
    s_waitcnt vmcnt(12)
    v_mfma_f32_16x16x32_bf16 v[144:147], v[192:195], a[76:79], v[144:147]
    s_xor_b32 s68, s88, 0
    s_waitcnt lgkmcnt(0)
    v_mfma_f32_16x16x32_bf16 v[148:151], v[196:199], a[76:79], v[148:151]
    buffer_load_dwordx4 a[64:67], v245, s[12:15], s68 offen offset:2048 sc1
    v_mfma_f32_16x16x32_bf16 v[152:155], v[200:203], a[76:79], v[152:155]
    v_add_f32 v96, v96, v112
    v_add_f32 v97, v97, v113
    v_mfma_f32_16x16x32_bf16 v[156:159], v[204:207], a[76:79], v[156:159]
    s_waitcnt vmcnt(12)
    v_add_f32 v98, v98, v114
    v_add_f32 v99, v99, v115
    v_mfma_f32_16x16x32_bf16 v[144:147], a[0:3], a[80:83], v[144:147]
    s_xor_b32 s68, s88, 8192
    v_add_f32 v100, v100, v116
    v_add_f32 v101, v101, v117
    v_mfma_f32_16x16x32_bf16 v[148:151], a[4:7], a[80:83], v[148:151]
    buffer_load_dwordx4 a[68:71], v245, s[12:15], s68 offen offset:2048 sc1
    v_mfma_f32_16x16x32_bf16 v[152:155], a[8:11], a[80:83], v[152:155]
    v_add_f32 v102, v102, v118
    v_add_f32 v103, v103, v119
    v_mfma_f32_16x16x32_bf16 v[156:159], a[12:15], a[80:83], v[156:159]
    s_waitcnt vmcnt(12)
    v_add_f32 v104, v104, v120
    v_add_f32 v105, v105, v121
    v_mfma_f32_16x16x32_bf16 v[144:147], a[16:19], a[84:87], v[144:147]
    s_xor_b32 s68, s88, 16384
    v_add_f32 v106, v106, v122
    v_add_f32 v107, v107, v123
    v_mfma_f32_16x16x32_bf16 v[148:151], a[20:23], a[84:87], v[148:151]
    buffer_load_dwordx4 a[72:75], v245, s[12:15], s68 offen offset:2048 sc1
    v_mfma_f32_16x16x32_bf16 v[152:155], a[24:27], a[84:87], v[152:155]
    v_add_f32 v108, v108, v124
    v_add_f32 v109, v109, v125
    v_mfma_f32_16x16x32_bf16 v[156:159], a[28:31], a[84:87], v[156:159]
    s_waitcnt vmcnt(12)
    v_add_f32 v110, v110, v126
    v_add_f32 v111, v111, v127
    v_mfma_f32_16x16x32_bf16 v[144:147], a[32:35], a[88:91], v[144:147]
    s_xor_b32 s68, s88, 24576
    v_fmac_f32 v64, v96, v6
    v_fmac_f32 v65, v97, v6
    v_mfma_f32_16x16x32_bf16 v[148:151], a[36:39], a[88:91], v[148:151]
    buffer_load_dwordx4 a[76:79], v245, s[12:15], s68 offen offset:2048 sc1
    v_mfma_f32_16x16x32_bf16 v[152:155], a[40:43], a[88:91], v[152:155]
    v_fmac_f32 v66, v98, v6
    v_fmac_f32 v67, v99, v6
    v_mfma_f32_16x16x32_bf16 v[156:159], a[44:47], a[88:91], v[156:159]
    s_waitcnt vmcnt(12)
    v_fmac_f32 v68, v100, v6
    v_fmac_f32 v69, v101, v6
    v_mfma_f32_16x16x32_bf16 v[144:147], a[48:51], a[92:95], v[144:147]
    s_xor_b32 s68, s88, 32768
    v_fmac_f32 v70, v102, v6
    v_fmac_f32 v71, v103, v6
    v_mfma_f32_16x16x32_bf16 v[148:151], a[52:55], a[92:95], v[148:151]
    buffer_load_dwordx4 a[80:83], v245, s[12:15], s68 offen offset:2048 sc1
    v_mfma_f32_16x16x32_bf16 v[152:155], a[56:59], a[92:95], v[152:155]
    v_fmac_f32 v72, v104, v6
    v_fmac_f32 v73, v105, v6
    v_mfma_f32_16x16x32_bf16 v[156:159], a[60:63], a[92:95], v[156:159]
    s_waitcnt vmcnt(12)
    v_fmac_f32 v74, v106, v6
    v_fmac_f32 v75, v107, v6
    v_mfma_f32_16x16x32_bf16 v[144:147], a[128:131], a[96:99], v[144:147]
    s_xor_b32 s68, s88, 40960
    v_fmac_f32 v76, v108, v6
    v_fmac_f32 v77, v109, v6
    v_mfma_f32_16x16x32_bf16 v[148:151], a[132:135], a[96:99], v[148:151]
    buffer_load_dwordx4 a[84:87], v245, s[12:15], s68 offen offset:2048 sc1
    v_mfma_f32_16x16x32_bf16 v[152:155], a[136:139], a[96:99], v[152:155]
    v_fmac_f32 v78, v110, v6
    v_fmac_f32 v79, v111, v6
    v_mfma_f32_16x16x32_bf16 v[156:159], a[140:143], a[96:99], v[156:159]
    s_waitcnt vmcnt(12)
    v_cvt_pk_bf16_f32 v160, v64, v65
    v_cvt_pk_bf16_f32 v161, v66, v67
    v_mfma_f32_16x16x32_bf16 v[144:147], a[144:147], a[100:103], v[144:147]
    s_xor_b32 s68, s88, 49152
    v_cvt_pk_bf16_f32 v162, v68, v69
    v_cvt_pk_bf16_f32 v163, v70, v71
    v_mfma_f32_16x16x32_bf16 v[148:151], a[148:151], a[100:103], v[148:151]
    buffer_load_dwordx4 a[88:91], v245, s[12:15], s68 offen offset:2048 sc1
    v_mfma_f32_16x16x32_bf16 v[152:155], a[152:155], a[100:103], v[152:155]
    v_cvt_pk_bf16_f32 v164, v72, v73
    v_cvt_pk_bf16_f32 v165, v74, v75
    v_mfma_f32_16x16x32_bf16 v[156:159], a[156:159], a[100:103], v[156:159]
    s_waitcnt vmcnt(12)
    v_cvt_pk_bf16_f32 v166, v76, v77
    v_cvt_pk_bf16_f32 v167, v78, v79
    v_mfma_f32_16x16x32_bf16 v[144:147], a[160:163], a[104:107], v[144:147]
    s_xor_b32 s68, s88, 57344
    v_permlane16_swap_b32 v160, v162
    v_mfma_f32_16x16x32_bf16 v[148:151], a[164:167], a[104:107], v[148:151]
    buffer_load_dwordx4 a[92:95], v245, s[12:15], s68 offen offset:2048 sc1
    v_mfma_f32_16x16x32_bf16 v[152:155], a[168:171], a[104:107], v[152:155]
    v_permlane16_swap_b32 v161, v163
    v_mfma_f32_16x16x32_bf16 v[156:159], a[172:175], a[104:107], v[156:159]
    s_waitcnt vmcnt(12)
    v_permlane16_swap_b32 v164, v166
    v_mfma_f32_16x16x32_bf16 v[144:147], a[176:179], a[108:111], v[144:147]
    s_xor_b32 s68, s88, 65536
    v_permlane16_swap_b32 v165, v167
    v_mfma_f32_16x16x32_bf16 v[148:151], a[180:183], a[108:111], v[148:151]
    buffer_load_dwordx4 a[96:99], v245, s[12:15], s68 offen offset:2048 sc1
    v_mfma_f32_16x16x32_bf16 v[152:155], a[184:187], a[108:111], v[152:155]
    v_mfma_f32_16x16x32_bf16 v[156:159], a[188:191], a[108:111], v[156:159]
    s_waitcnt vmcnt(12)
    v_mfma_f32_16x16x32_bf16 v[144:147], a[192:195], a[112:115], v[144:147]
    s_xor_b32 s68, s88, 73728
    v_mfma_f32_16x16x32_bf16 v[148:151], a[196:199], a[112:115], v[148:151]
    buffer_load_dwordx4 a[100:103], v245, s[12:15], s68 offen offset:2048 sc1
    v_mfma_f32_16x16x32_bf16 v[152:155], a[200:203], a[112:115], v[152:155]
    v_mfma_f32_16x16x32_bf16 v[156:159], a[204:207], a[112:115], v[156:159]
    s_waitcnt vmcnt(12)
    v_mfma_f32_16x16x32_bf16 v[144:147], a[208:211], a[116:119], v[144:147]
    s_xor_b32 s68, s88, 81920
    v_mfma_f32_16x16x32_bf16 v[148:151], a[212:215], a[116:119], v[148:151]
    buffer_load_dwordx4 a[104:107], v245, s[12:15], s68 offen offset:2048 sc1
    v_mfma_f32_16x16x32_bf16 v[152:155], a[216:219], a[116:119], v[152:155]
    v_mfma_f32_16x16x32_bf16 v[156:159], a[220:223], a[116:119], v[156:159]
    s_waitcnt vmcnt(12)
    v_mfma_f32_16x16x32_bf16 v[144:147], a[224:227], a[120:123], v[144:147]
    s_xor_b32 s68, s88, 90112
    v_mfma_f32_16x16x32_bf16 v[148:151], a[228:231], a[120:123], v[148:151]
    buffer_load_dwordx4 a[108:111], v245, s[12:15], s68 offen offset:2048 sc1
    v_mfma_f32_16x16x32_bf16 v[152:155], a[232:235], a[120:123], v[152:155]
    v_mfma_f32_16x16x32_bf16 v[156:159], a[236:239], a[120:123], v[156:159]
    s_waitcnt vmcnt(12)
    v_mfma_f32_16x16x32_bf16 v[144:147], a[240:243], a[124:127], v[144:147]
    s_xor_b32 s68, s88, 98304
    v_mfma_f32_16x16x32_bf16 v[148:151], a[244:247], a[124:127], v[148:151]
    buffer_load_dwordx4 a[112:115], v245, s[12:15], s68 offen offset:2048 sc1
    v_mfma_f32_16x16x32_bf16 v[152:155], a[248:251], a[124:127], v[152:155]
    v_mfma_f32_16x16x32_bf16 v[156:159], a[252:255], a[124:127], v[156:159]
    s_waitcnt vmcnt(12)
    v_mfma_f32_16x16x32_bf16 v[128:131], v[16:19], a[64:67], 0
L_pg8:
    s_cbranch_execz L_main
    s_xor_b32 s68, s88, 106496
    v_mfma_f32_16x16x32_bf16 v[132:135], v[20:23], a[64:67], 0
    buffer_load_dwordx4 a[116:119], v245, s[12:15], s68 offen offset:2048 sc1
    v_mfma_f32_16x16x32_bf16 v[136:139], v[24:27], a[64:67], 0
    v_mfma_f32_16x16x32_bf16 v[140:143], v[28:31], a[64:67], 0
    s_waitcnt vmcnt(12)
    v_mfma_f32_16x16x32_bf16 v[128:131], v[32:35], a[68:71], v[128:131]
    s_xor_b32 s68, s88, 114688
    v_mfma_f32_16x16x32_bf16 v[132:135], v[36:39], a[68:71], v[132:135]
    buffer_load_dwordx4 a[120:123], v245, s[12:15], s68 offen offset:2048 sc1
    v_mfma_f32_16x16x32_bf16 v[136:139], v[40:43], a[68:71], v[136:139]
    ds_write_b128 v52, v[144:147] offset:16384
    v_mfma_f32_16x16x32_bf16 v[140:143], v[44:47], a[68:71], v[140:143]
    s_waitcnt vmcnt(12)
    v_mfma_f32_16x16x32_bf16 v[128:131], v[176:179], a[72:75], v[128:131]
    s_xor_b32 s68, s88, 122880
    v_mfma_f32_16x16x32_bf16 v[132:135], v[180:183], a[72:75], v[132:135]
    buffer_load_dwordx4 a[124:127], v245, s[12:15], s68 offen offset:2048 sc1
    v_mfma_f32_16x16x32_bf16 v[136:139], v[184:187], a[72:75], v[136:139]
    ds_write_b128 v52, v[148:151] offset:17408
    v_mfma_f32_16x16x32_bf16 v[140:143], v[188:191], a[72:75], v[140:143]
    s_waitcnt vmcnt(12)
    v_mfma_f32_16x16x32_bf16 v[128:131], v[192:195], a[76:79], v[128:131]
    v_mfma_f32_16x16x32_bf16 v[132:135], v[196:199], a[76:79], v[132:135]
    buffer_store_dwordx4 v[160:163], v230, s[24:27], s95 offen offset:0 nt
    v_mfma_f32_16x16x32_bf16 v[136:139], v[200:203], a[76:79], v[136:139]
    ds_write_b128 v52, v[152:155] offset:18432
    v_mfma_f32_16x16x32_bf16 v[140:143], v[204:207], a[76:79], v[140:143]
    s_waitcnt vmcnt(12)
    v_mfma_f32_16x16x32_bf16 v[128:131], a[0:3], a[80:83], v[128:131]
    v_mfma_f32_16x16x32_bf16 v[132:135], a[4:7], a[80:83], v[132:135]
    buffer_store_dwordx4 v[164:167], v230, s[24:27], s95 offen offset:64 nt
    v_mfma_f32_16x16x32_bf16 v[136:139], a[8:11], a[80:83], v[136:139]
    ds_write_b128 v52, v[156:159] offset:19456
    v_mfma_f32_16x16x32_bf16 v[140:143], a[12:15], a[80:83], v[140:143]
    s_waitcnt vmcnt(12)
    v_mfma_f32_16x16x32_bf16 v[128:131], a[16:19], a[84:87], v[128:131]
    v_mfma_f32_16x16x32_bf16 v[132:135], a[20:23], a[84:87], v[132:135]
    v_mfma_f32_16x16x32_bf16 v[136:139], a[24:27], a[84:87], v[136:139]
    v_mfma_f32_16x16x32_bf16 v[140:143], a[28:31], a[84:87], v[140:143]
    s_waitcnt vmcnt(11)
    v_mfma_f32_16x16x32_bf16 v[128:131], a[32:35], a[88:91], v[128:131]
    v_mfma_f32_16x16x32_bf16 v[132:135], a[36:39], a[88:91], v[132:135]
    v_mfma_f32_16x16x32_bf16 v[136:139], a[40:43], a[88:91], v[136:139]
    s_waitcnt lgkmcnt(0)
    s_barrier
    v_mfma_f32_16x16x32_bf16 v[140:143], a[44:47], a[88:91], v[140:143]
    s_waitcnt vmcnt(10)
    v_mfma_f32_16x16x32_bf16 v[128:131], a[48:51], a[92:95], v[128:131]
    ds_read_b128 v[144:147], v53 offset:16384
    v_mfma_f32_16x16x32_bf16 v[132:135], a[52:55], a[92:95], v[132:135]
    v_mfma_f32_16x16x32_bf16 v[136:139], a[56:59], a[92:95], v[136:139]
    ds_read_b128 v[148:151], v53 offset:17408
    v_mfma_f32_16x16x32_bf16 v[140:143], a[60:63], a[92:95], v[140:143]
    s_waitcnt vmcnt(9)
    v_mfma_f32_16x16x32_bf16 v[128:131], a[128:131], a[96:99], v[128:131]
    ds_read_b128 v[152:155], v53 offset:18432
    v_mfma_f32_16x16x32_bf16 v[132:135], a[132:135], a[96:99], v[132:135]
    v_mfma_f32_16x16x32_bf16 v[136:139], a[136:139], a[96:99], v[136:139]
    ds_read_b128 v[156:159], v53 offset:19456
    v_mfma_f32_16x16x32_bf16 v[140:143], a[140:143], a[96:99], v[140:143]
    s_waitcnt vmcnt(8)
    v_mfma_f32_16x16x32_bf16 v[128:131], a[144:147], a[100:103], v[128:131]
    v_mfma_f32_16x16x32_bf16 v[132:135], a[148:151], a[100:103], v[132:135]
    v_mfma_f32_16x16x32_bf16 v[136:139], a[152:155], a[100:103], v[136:139]
    v_mfma_f32_16x16x32_bf16 v[140:143], a[156:159], a[100:103], v[140:143]
    s_waitcnt vmcnt(7)
    v_mfma_f32_16x16x32_bf16 v[128:131], a[160:163], a[104:107], v[128:131]
    s_waitcnt lgkmcnt(0)
    v_mfma_f32_16x16x32_bf16 v[132:135], a[164:167], a[104:107], v[132:135]
    v_fmac_f32 v80, v144, v8
    v_fmac_f32 v81, v145, v8
    v_mfma_f32_16x16x32_bf16 v[136:139], a[168:171], a[104:107], v[136:139]
    v_fmac_f32 v82, v146, v8
    v_fmac_f32 v83, v147, v8
    v_mfma_f32_16x16x32_bf16 v[140:143], a[172:175], a[104:107], v[140:143]
    s_waitcnt vmcnt(6)
    v_fmac_f32 v84, v148, v8
    v_fmac_f32 v85, v149, v8
    v_mfma_f32_16x16x32_bf16 v[128:131], a[176:179], a[108:111], v[128:131]
    v_fmac_f32 v86, v150, v8
    v_fmac_f32 v87, v151, v8
    v_mfma_f32_16x16x32_bf16 v[132:135], a[180:183], a[108:111], v[132:135]
    v_fmac_f32 v88, v152, v8
    v_fmac_f32 v89, v153, v8
    v_mfma_f32_16x16x32_bf16 v[136:139], a[184:187], a[108:111], v[136:139]
    v_fmac_f32 v90, v154, v8
    v_fmac_f32 v91, v155, v8
    v_mfma_f32_16x16x32_bf16 v[140:143], a[188:191], a[108:111], v[140:143]
    s_waitcnt vmcnt(5)
    v_fmac_f32 v92, v156, v8
    v_fmac_f32 v93, v157, v8
    v_mfma_f32_16x16x32_bf16 v[128:131], a[192:195], a[112:115], v[128:131]
    v_fmac_f32 v94, v158, v8
    v_fmac_f32 v95, v159, v8
    v_mfma_f32_16x16x32_bf16 v[132:135], a[196:199], a[112:115], v[132:135]
    v_mfma_f32_16x16x32_bf16 v[136:139], a[200:203], a[112:115], v[136:139]
    v_mfma_f32_16x16x32_bf16 v[140:143], a[204:207], a[112:115], v[140:143]
    s_waitcnt vmcnt(4)
    v_mfma_f32_16x16x32_bf16 v[128:131], a[208:211], a[116:119], v[128:131]
    v_mfma_f32_16x16x32_bf16 v[132:135], a[212:215], a[116:119], v[132:135]
    v_mfma_f32_16x16x32_bf16 v[136:139], a[216:219], a[116:119], v[136:139]
    v_mfma_f32_16x16x32_bf16 v[140:143], a[220:223], a[116:119], v[140:143]
    s_waitcnt vmcnt(3)
    v_mfma_f32_16x16x32_bf16 v[128:131], a[224:227], a[120:123], v[128:131]
    v_mfma_f32_16x16x32_bf16 v[132:135], a[228:231], a[120:123], v[132:135]
    v_mfma_f32_16x16x32_bf16 v[136:139], a[232:235], a[120:123], v[136:139]
    v_mfma_f32_16x16x32_bf16 v[140:143], a[236:239], a[120:123], v[140:143]
    s_waitcnt vmcnt(2)
    v_mfma_f32_16x16x32_bf16 v[128:131], a[240:243], a[124:127], v[128:131]
    v_mfma_f32_16x16x32_bf16 v[132:135], a[244:247], a[124:127], v[132:135]
    v_mfma_f32_16x16x32_bf16 v[136:139], a[248:251], a[124:127], v[136:139]
    v_mfma_f32_16x16x32_bf16 v[140:143], a[252:255], a[124:127], v[140:143]
    s_nop 4
    v_pk_fma_f32 v[80:81], v[128:129], v[8:9], v[80:81] op_sel_hi:[1,0,1]
    v_pk_fma_f32 v[82:83], v[130:131], v[8:9], v[82:83] op_sel_hi:[1,0,1]
    v_pk_fma_f32 v[84:85], v[132:133], v[8:9], v[84:85] op_sel_hi:[1,0,1]
    v_pk_fma_f32 v[86:87], v[134:135], v[8:9], v[86:87] op_sel_hi:[1,0,1]
    v_cvt_pk_bf16_f32 v168, v80, v81
    v_cvt_pk_bf16_f32 v169, v82, v83
    v_cvt_pk_bf16_f32 v170, v84, v85
    v_cvt_pk_bf16_f32 v171, v86, v87
    v_pk_fma_f32 v[88:89], v[136:137], v[8:9], v[88:89] op_sel_hi:[1,0,1]
    v_pk_fma_f32 v[90:91], v[138:139], v[8:9], v[90:91] op_sel_hi:[1,0,1]
    v_permlane16_swap_b32 v168, v170
    v_permlane16_swap_b32 v169, v171
    buffer_store_dwordx4 v[168:171], v230, s[24:27], s96 offen offset:0 nt
    v_pk_fma_f32 v[92:93], v[140:141], v[8:9], v[92:93] op_sel_hi:[1,0,1]
    v_pk_fma_f32 v[94:95], v[142:143], v[8:9], v[94:95] op_sel_hi:[1,0,1]
    v_cvt_pk_bf16_f32 v172, v88, v89
    v_cvt_pk_bf16_f32 v173, v90, v91
    v_cvt_pk_bf16_f32 v174, v92, v93
    v_cvt_pk_bf16_f32 v175, v94, v95
    s_nop 0
    v_permlane16_swap_b32 v172, v174
    v_permlane16_swap_b32 v173, v175
    buffer_store_dwordx4 v[172:175], v230, s[24:27], s96 offen offset:64 nt
    s_endpgm
L_rdy_spin:
    buffer_load_dword v254, v8, s[28:31], 0 offen sc1
    s_waitcnt vmcnt(0)
    v_cmp_ne_u32 vcc, 0, v254
    s_nop 1
    s_bcnt1_i32_b64 s55, vcc
    s_cmp_eq_u32 s55, 52
    s_cbranch_scc1 L_rdy_ok
    s_sub_u32 s97, s97, 1
    s_cbranch_scc0 L_rdy_spin
    s_endpgm
L_u_spin:
    buffer_load_dword v234, v235, s[32:35], s81 offen sc1
    buffer_load_dword v232, v229, s[32:35], s3 offen sc1
    s_waitcnt vmcnt(0)
    v_cmp_ne_u32 vcc, 0, v234
    v_cmp_gt_i32 s[98:99], 0, v232
    s_nop 1
    s_and_b32 s98, s98, vcc_lo
    s_and_b32 s98, s98, vcc_hi
    s_cmp_eq_u32 s98, -1
    s_cbranch_scc1 L_u_ok
    s_sub_u32 s97, s97, 1
    s_cbranch_scc0 L_u_spin
    s_endpgm
L_kv1_spin:
    buffer_load_dword v212, v213, s[32:35], s67 offen sc1
    s_waitcnt vmcnt(0)
    v_cmp_ne_u32 vcc, 0, v212
    s_nop 1
    s_mov_b32 s71, vcc_lo
    s_bitcmp1_b32 s71, s68
    s_cbranch_scc1 L_kv1_ok
    s_sub_u32 s97, s97, 1
    s_cbranch_scc0 L_kv1_spin
    s_endpgm
L_kv2_spin:
    buffer_load_dword v212, v213, s[32:35], s67 offen sc1
    s_waitcnt vmcnt(0)
    v_cmp_ne_u32 vcc, 0, v212
    s_nop 1
    s_mov_b32 s71, vcc_lo
    s_bitcmp1_b32 s71, s68
    s_cbranch_scc1 L_kv2_ok
    s_sub_u32 s97, s97, 1
    s_cbranch_scc0 L_kv2_spin
    s_endpgm
L_kv3_spin:
    buffer_load_dword v212, v213, s[32:35], s67 offen sc1
    s_waitcnt vmcnt(0)
    v_cmp_ne_u32 vcc, 0, v212
    s_nop 1
    s_mov_b32 s71, vcc_lo
    s_bitcmp1_b32 s71, s68
    s_cbranch_scc1 L_kv3_ok
    s_sub_u32 s97, s97, 1
    s_cbranch_scc0 L_kv3_spin
    s_endpgm
L_kv4_spin:
    buffer_load_dword v212, v213, s[32:35], s67 offen sc1
    s_waitcnt vmcnt(0)
    v_cmp_ne_u32 vcc, 0, v212
    s_nop 1
    s_mov_b32 s71, vcc_lo
    s_bitcmp1_b32 s71, s68
    s_cbranch_scc1 L_kv4_ok
    s_sub_u32 s97, s97, 1
    s_cbranch_scc0 L_kv4_spin
    s_endpgm
L_kv5_spin:
    buffer_load_dword v212, v213, s[32:35], s67 offen sc1
    s_waitcnt vmcnt(0)
    v_cmp_ne_u32 vcc, 0, v212
    s_nop 1
    s_mov_b32 s71, vcc_lo
    s_andn2_b32 s55, 255, s71
    s_cmp_eq_u32 s55, 0
    s_cbranch_scc1 L_kv5_ok
    s_sub_u32 s97, s97, 1
    s_cbranch_scc0 L_kv5_spin
    s_endpgm
L_kv6_spin:
    buffer_load_dword v212, v213, s[32:35], s67 offen sc1
    s_waitcnt vmcnt(0)
    v_cmp_ne_u32 vcc, 0, v212
    s_nop 1
    s_mov_b32 s71, vcc_lo
    s_andn2_b32 s55, s43, s71
    s_cmp_eq_u32 s55, 0
    s_cbranch_scc1 L_kv6_ok
    s_sub_u32 s97, s97, 1
    s_cbranch_scc0 L_kv6_spin
    s_endpgm
L_oa_spin:
    s_not_b64 exec, vcc
    buffer_load_dword v15, v14, s[32:35], s87 offen sc1
    s_mov_b64 exec, -1
    s_waitcnt vmcnt(0)
    v_cmp_ne_u32 vcc, 0, v15
    s_nop 1
    s_cmp_eq_u32 vcc_lo, 0xffff
    s_cbranch_scc1 L_oa_ok
    s_sub_u32 s97, s97, 1
    s_cbranch_scc0 L_oa_spin
    s_endpgm
L_slow0:
    s_waitcnt vmcnt(0) lgkmcnt(0)
    v_mov_b32 v1, 0xff800000
    s_mov_b32 s69, s61
    s_add_u32 s55, s61, 131072
L_slow0_max:
    buffer_load_dwordx4 a[0:3], v4, s[12:15], s69 offen offset:0 sc1
    buffer_load_dwordx4 a[4:7], v4, s[12:15], s69 offen offset:1024 sc1
    s_waitcnt vmcnt(0)
    v_mfma_f32_32x32x16_bf16 v[96:111], a[0:3], a[32:35], 0
    v_mfma_f32_32x32x16_bf16 v[96:111], a[4:7], a[36:39], v[96:111]
    s_nop 15
    v_max3_f32 v1, v1, v96, v97
    v_max3_f32 v1, v1, v98, v99
    v_max3_f32 v1, v1, v100, v101
    v_max3_f32 v1, v1, v102, v103
    v_max3_f32 v1, v1, v104, v105
    v_max3_f32 v1, v1, v106, v107
    v_max3_f32 v1, v1, v108, v109
    v_max3_f32 v1, v1, v110, v111
    s_add_u32 s69, s69, 4096
    s_cmp_lt_u32 s69, s55
    s_cbranch_scc1 L_slow0_max
    v_mov_b32 v2, v1
    s_nop 1
    v_permlane32_swap_b32 v1, v2
    v_max_f32 v1, v1, v2
    v_sub_f32 v16, 0, v1
    v_mov_b32 v144, 0
    v_sub_f32 v17, 0, v1
    v_mov_b32 v145, 0
    v_sub_f32 v18, 0, v1
    v_mov_b32 v146, 0
    v_sub_f32 v19, 0, v1
    v_mov_b32 v147, 0
    v_sub_f32 v20, 0, v1
    v_mov_b32 v148, 0
    v_sub_f32 v21, 0, v1
    v_mov_b32 v149, 0
    v_sub_f32 v22, 0, v1
    v_mov_b32 v150, 0
    v_sub_f32 v23, 0, v1
    v_mov_b32 v151, 0
    v_sub_f32 v24, 0, v1
    v_mov_b32 v152, 0
    v_sub_f32 v25, 0, v1
    v_mov_b32 v153, 0
    v_sub_f32 v26, 0, v1
    v_mov_b32 v154, 0
    v_sub_f32 v27, 0, v1
    v_mov_b32 v155, 0
    v_sub_f32 v28, 0, v1
    v_mov_b32 v156, 0
    v_sub_f32 v29, 0, v1
    v_mov_b32 v157, 0
    v_sub_f32 v30, 0, v1
    v_mov_b32 v158, 0
    v_sub_f32 v31, 0, v1
    v_mov_b32 v159, 0
    v_accvgpr_write_b32 a128, 0
    v_accvgpr_write_b32 a129, 0
    v_accvgpr_write_b32 a130, 0
    v_accvgpr_write_b32 a131, 0
    s_mov_b32 s69, s61
L_slow0_sum:
    buffer_load_dwordx4 a[0:3], v4, s[12:15], s69 offen offset:0 sc1
    buffer_load_dwordx4 a[4:7], v4, s[12:15], s69 offen offset:1024 sc1
    buffer_load_dwordx4 a[8:11], v4, s[12:15], s69 offen offset:2048 sc1
    buffer_load_dwordx4 a[12:15], v4, s[12:15], s69 offen offset:3072 sc1
    s_waitcnt vmcnt(0)
    v_mfma_f32_32x32x16_bf16 v[96:111], a[0:3], a[32:35], v[16:31]
    v_mfma_f32_32x32x16_bf16 v[96:111], a[4:7], a[36:39], v[96:111]
    s_nop 15
    v_exp_f32 v96, v96
    v_exp_f32 v97, v97
    v_exp_f32 v98, v98
    v_exp_f32 v99, v99
    v_exp_f32 v100, v100
    v_exp_f32 v101, v101
    v_exp_f32 v102, v102
    v_exp_f32 v103, v103
    v_exp_f32 v104, v104
    v_exp_f32 v105, v105
    v_exp_f32 v106, v106
    v_exp_f32 v107, v107
    v_exp_f32 v108, v108
    v_exp_f32 v109, v109
    v_exp_f32 v110, v110
    v_exp_f32 v111, v111
    s_nop 1
    v_smfmac_f32_32x32x32_bf16 v[144:159], a[8:11], v[96:103], v231
    v_smfmac_f32_16x16x64_bf16 a[128:131], a[144:147], v[96:103], v231
    v_smfmac_f32_32x32x32_bf16 v[144:159], a[12:15], v[104:111], v231
    v_smfmac_f32_16x16x64_bf16 a[128:131], a[144:147], v[104:111], v231
    s_nop 15
    s_add_u32 s69, s69, 4096
    s_cmp_lt_u32 s69, s55
    s_cbranch_scc1 L_slow0_sum
    ds_write_b128 v240, v[144:147] offset:0
    ds_write_b128 v240, v[148:151] offset:1024
    ds_write_b128 v240, v[152:155] offset:2048
    ds_write_b128 v240, v[156:159] offset:3072
    v_accvgpr_read_b32 v9, a128
    v_mov_b32 v8, v16
    s_branch L_safe0
L_slow1:
    s_waitcnt vmcnt(0) lgkmcnt(0)
    v_mov_b32 v1, 0xff800000
    s_mov_b32 s69, s61
    s_add_u32 s55, s61, 131072
L_slow1_max:
    buffer_load_dwordx4 a[0:3], v4, s[12:15], s69 offen offset:0 sc1
    buffer_load_dwordx4 a[4:7], v4, s[12:15], s69 offen offset:1024 sc1
    s_waitcnt vmcnt(0)
    v_mfma_f32_32x32x16_bf16 v[128:143], a[0:3], a[40:43], 0
    v_mfma_f32_32x32x16_bf16 v[128:143], a[4:7], a[44:47], v[128:143]
    s_nop 15
    v_max3_f32 v1, v1, v128, v129
    v_max3_f32 v1, v1, v130, v131
    v_max3_f32 v1, v1, v132, v133
    v_max3_f32 v1, v1, v134, v135
    v_max3_f32 v1, v1, v136, v137
    v_max3_f32 v1, v1, v138, v139
    v_max3_f32 v1, v1, v140, v141
    v_max3_f32 v1, v1, v142, v143
    s_add_u32 s69, s69, 4096
    s_cmp_lt_u32 s69, s55
    s_cbranch_scc1 L_slow1_max
    v_mov_b32 v2, v1
    s_nop 1
    v_permlane32_swap_b32 v1, v2
    v_max_f32 v1, v1, v2
    v_sub_f32 v32, 0, v1
    v_mov_b32 v160, 0
    v_sub_f32 v33, 0, v1
    v_mov_b32 v161, 0
    v_sub_f32 v34, 0, v1
    v_mov_b32 v162, 0
    v_sub_f32 v35, 0, v1
    v_mov_b32 v163, 0
    v_sub_f32 v36, 0, v1
    v_mov_b32 v164, 0
    v_sub_f32 v37, 0, v1
    v_mov_b32 v165, 0
    v_sub_f32 v38, 0, v1
    v_mov_b32 v166, 0
    v_sub_f32 v39, 0, v1
    v_mov_b32 v167, 0
    v_sub_f32 v40, 0, v1
    v_mov_b32 v168, 0
    v_sub_f32 v41, 0, v1
    v_mov_b32 v169, 0
    v_sub_f32 v42, 0, v1
    v_mov_b32 v170, 0
    v_sub_f32 v43, 0, v1
    v_mov_b32 v171, 0
    v_sub_f32 v44, 0, v1
    v_mov_b32 v172, 0
    v_sub_f32 v45, 0, v1
    v_mov_b32 v173, 0
    v_sub_f32 v46, 0, v1
    v_mov_b32 v174, 0
    v_sub_f32 v47, 0, v1
    v_mov_b32 v175, 0
    v_accvgpr_write_b32 a132, 0
    v_accvgpr_write_b32 a133, 0
    v_accvgpr_write_b32 a134, 0
    v_accvgpr_write_b32 a135, 0
    s_mov_b32 s69, s61
L_slow1_sum:
    buffer_load_dwordx4 a[0:3], v4, s[12:15], s69 offen offset:0 sc1
    buffer_load_dwordx4 a[4:7], v4, s[12:15], s69 offen offset:1024 sc1
    buffer_load_dwordx4 a[8:11], v4, s[12:15], s69 offen offset:2048 sc1
    buffer_load_dwordx4 a[12:15], v4, s[12:15], s69 offen offset:3072 sc1
    s_waitcnt vmcnt(0)
    v_mfma_f32_32x32x16_bf16 v[128:143], a[0:3], a[40:43], v[32:47]
    v_mfma_f32_32x32x16_bf16 v[128:143], a[4:7], a[44:47], v[128:143]
    s_nop 15
    v_exp_f32 v128, v128
    v_exp_f32 v129, v129
    v_exp_f32 v130, v130
    v_exp_f32 v131, v131
    v_exp_f32 v132, v132
    v_exp_f32 v133, v133
    v_exp_f32 v134, v134
    v_exp_f32 v135, v135
    v_exp_f32 v136, v136
    v_exp_f32 v137, v137
    v_exp_f32 v138, v138
    v_exp_f32 v139, v139
    v_exp_f32 v140, v140
    v_exp_f32 v141, v141
    v_exp_f32 v142, v142
    v_exp_f32 v143, v143
    s_nop 1
    v_smfmac_f32_32x32x32_bf16 v[160:175], a[8:11], v[128:135], v231
    v_smfmac_f32_16x16x64_bf16 a[132:135], a[144:147], v[128:135], v231
    v_smfmac_f32_32x32x32_bf16 v[160:175], a[12:15], v[136:143], v231
    v_smfmac_f32_16x16x64_bf16 a[132:135], a[144:147], v[136:143], v231
    s_nop 15
    s_add_u32 s69, s69, 4096
    s_cmp_lt_u32 s69, s55
    s_cbranch_scc1 L_slow1_sum
    ds_write_b128 v241, v[160:163] offset:0
    ds_write_b128 v241, v[164:167] offset:1024
    ds_write_b128 v241, v[168:171] offset:2048
    ds_write_b128 v241, v[172:175] offset:3072
    v_accvgpr_read_b32 v9, a132
    v_mov_b32 v8, v32
    s_branch L_safe1
L_slow2:
    s_waitcnt vmcnt(0) lgkmcnt(0)
    v_mov_b32 v1, 0xff800000
    s_mov_b32 s69, s61
    s_add_u32 s55, s61, 131072
L_slow2_max:
    buffer_load_dwordx4 a[0:3], v4, s[12:15], s69 offen offset:0 sc1
    buffer_load_dwordx4 a[4:7], v4, s[12:15], s69 offen offset:1024 sc1
    s_waitcnt vmcnt(0)
    v_mfma_f32_32x32x16_bf16 v[128:143], a[0:3], a[48:51], 0
    v_mfma_f32_32x32x16_bf16 v[128:143], a[4:7], a[52:55], v[128:143]
    s_nop 15
    v_max3_f32 v1, v1, v128, v129
    v_max3_f32 v1, v1, v130, v131
    v_max3_f32 v1, v1, v132, v133
    v_max3_f32 v1, v1, v134, v135
    v_max3_f32 v1, v1, v136, v137
    v_max3_f32 v1, v1, v138, v139
    v_max3_f32 v1, v1, v140, v141
    v_max3_f32 v1, v1, v142, v143
    s_add_u32 s69, s69, 4096
    s_cmp_lt_u32 s69, s55
    s_cbranch_scc1 L_slow2_max
    v_mov_b32 v2, v1
    s_nop 1
    v_permlane32_swap_b32 v1, v2
    v_max_f32 v1, v1, v2
    v_sub_f32 v48, 0, v1
    v_mov_b32 v176, 0
    v_sub_f32 v49, 0, v1
    v_mov_b32 v177, 0
    v_sub_f32 v50, 0, v1
    v_mov_b32 v178, 0
    v_sub_f32 v51, 0, v1
    v_mov_b32 v179, 0
    v_sub_f32 v52, 0, v1
    v_mov_b32 v180, 0
    v_sub_f32 v53, 0, v1
    v_mov_b32 v181, 0
    v_sub_f32 v54, 0, v1
    v_mov_b32 v182, 0
    v_sub_f32 v55, 0, v1
    v_mov_b32 v183, 0
    v_sub_f32 v56, 0, v1
    v_mov_b32 v184, 0
    v_sub_f32 v57, 0, v1
    v_mov_b32 v185, 0
    v_sub_f32 v58, 0, v1
    v_mov_b32 v186, 0
    v_sub_f32 v59, 0, v1
    v_mov_b32 v187, 0
    v_sub_f32 v60, 0, v1
    v_mov_b32 v188, 0
    v_sub_f32 v61, 0, v1
    v_mov_b32 v189, 0
    v_sub_f32 v62, 0, v1
    v_mov_b32 v190, 0
    v_sub_f32 v63, 0, v1
    v_mov_b32 v191, 0
    v_accvgpr_write_b32 a136, 0
    v_accvgpr_write_b32 a137, 0
    v_accvgpr_write_b32 a138, 0
    v_accvgpr_write_b32 a139, 0
    s_mov_b32 s69, s61
L_slow2_sum:
    buffer_load_dwordx4 a[0:3], v4, s[12:15], s69 offen offset:0 sc1
    buffer_load_dwordx4 a[4:7], v4, s[12:15], s69 offen offset:1024 sc1
    buffer_load_dwordx4 a[8:11], v4, s[12:15], s69 offen offset:2048 sc1
    buffer_load_dwordx4 a[12:15], v4, s[12:15], s69 offen offset:3072 sc1
    s_waitcnt vmcnt(0)
    v_mfma_f32_32x32x16_bf16 v[128:143], a[0:3], a[48:51], v[48:63]
    v_mfma_f32_32x32x16_bf16 v[128:143], a[4:7], a[52:55], v[128:143]
    s_nop 15
    v_exp_f32 v128, v128
    v_exp_f32 v129, v129
    v_exp_f32 v130, v130
    v_exp_f32 v131, v131
    v_exp_f32 v132, v132
    v_exp_f32 v133, v133
    v_exp_f32 v134, v134
    v_exp_f32 v135, v135
    v_exp_f32 v136, v136
    v_exp_f32 v137, v137
    v_exp_f32 v138, v138
    v_exp_f32 v139, v139
    v_exp_f32 v140, v140
    v_exp_f32 v141, v141
    v_exp_f32 v142, v142
    v_exp_f32 v143, v143
    s_nop 1
    v_smfmac_f32_32x32x32_bf16 v[176:191], a[8:11], v[128:135], v231
    v_smfmac_f32_16x16x64_bf16 a[136:139], a[144:147], v[128:135], v231
    v_smfmac_f32_32x32x32_bf16 v[176:191], a[12:15], v[136:143], v231
    v_smfmac_f32_16x16x64_bf16 a[136:139], a[144:147], v[136:143], v231
    s_nop 15
    s_add_u32 s69, s69, 4096
    s_cmp_lt_u32 s69, s55
    s_cbranch_scc1 L_slow2_sum
    v_accvgpr_read_b32 v12, a136
    v_min_f32 v13, v48, v10
    v_sub_f32 v6, v13, v48
    v_sub_f32 v13, v13, v10
    v_exp_f32 v6, v6
    v_exp_f32 v13, v13
    v_mul_f32 v12, v12, v6
    v_fmac_f32 v12, v11, v13
    v_rcp_f32 v12, v12
    s_nop 0
    s_branch L_safe2
L_slow3:
    s_waitcnt vmcnt(0) lgkmcnt(0)
    v_mov_b32 v1, 0xff800000
    s_mov_b32 s69, s61
    s_add_u32 s55, s61, 131072
L_slow3_max:
    buffer_load_dwordx4 a[0:3], v4, s[12:15], s69 offen offset:0 sc1
    buffer_load_dwordx4 a[4:7], v4, s[12:15], s69 offen offset:1024 sc1
    s_waitcnt vmcnt(0)
    v_mfma_f32_32x32x16_bf16 v[96:111], a[0:3], a[56:59], 0
    v_mfma_f32_32x32x16_bf16 v[96:111], a[4:7], a[60:63], v[96:111]
    s_nop 15
    v_max3_f32 v1, v1, v96, v97
    v_max3_f32 v1, v1, v98, v99
    v_max3_f32 v1, v1, v100, v101
    v_max3_f32 v1, v1, v102, v103
    v_max3_f32 v1, v1, v104, v105
    v_max3_f32 v1, v1, v106, v107
    v_max3_f32 v1, v1, v108, v109
    v_max3_f32 v1, v1, v110, v111
    s_add_u32 s69, s69, 4096
    s_cmp_lt_u32 s69, s55
    s_cbranch_scc1 L_slow3_max
    v_mov_b32 v2, v1
    s_nop 1
    v_permlane32_swap_b32 v1, v2
    v_max_f32 v1, v1, v2
    v_sub_f32 v64, 0, v1
    v_mov_b32 v192, 0
    v_sub_f32 v65, 0, v1
    v_mov_b32 v193, 0
    v_sub_f32 v66, 0, v1
    v_mov_b32 v194, 0
    v_sub_f32 v67, 0, v1
    v_mov_b32 v195, 0
    v_sub_f32 v68, 0, v1
    v_mov_b32 v196, 0
    v_sub_f32 v69, 0, v1
    v_mov_b32 v197, 0
    v_sub_f32 v70, 0, v1
    v_mov_b32 v198, 0
    v_sub_f32 v71, 0, v1
    v_mov_b32 v199, 0
    v_sub_f32 v72, 0, v1
    v_mov_b32 v200, 0
    v_sub_f32 v73, 0, v1
    v_mov_b32 v201, 0
    v_sub_f32 v74, 0, v1
    v_mov_b32 v202, 0
    v_sub_f32 v75, 0, v1
    v_mov_b32 v203, 0
    v_sub_f32 v76, 0, v1
    v_mov_b32 v204, 0
    v_sub_f32 v77, 0, v1
    v_mov_b32 v205, 0
    v_sub_f32 v78, 0, v1
    v_mov_b32 v206, 0
    v_sub_f32 v79, 0, v1
    v_mov_b32 v207, 0
    v_accvgpr_write_b32 a140, 0
    v_accvgpr_write_b32 a141, 0
    v_accvgpr_write_b32 a142, 0
    v_accvgpr_write_b32 a143, 0
    s_mov_b32 s69, s61
L_slow3_sum:
    buffer_load_dwordx4 a[0:3], v4, s[12:15], s69 offen offset:0 sc1
    buffer_load_dwordx4 a[4:7], v4, s[12:15], s69 offen offset:1024 sc1
    buffer_load_dwordx4 a[8:11], v4, s[12:15], s69 offen offset:2048 sc1
    buffer_load_dwordx4 a[12:15], v4, s[12:15], s69 offen offset:3072 sc1
    s_waitcnt vmcnt(0)
    v_mfma_f32_32x32x16_bf16 v[96:111], a[0:3], a[56:59], v[64:79]
    v_mfma_f32_32x32x16_bf16 v[96:111], a[4:7], a[60:63], v[96:111]
    s_nop 15
    v_exp_f32 v96, v96
    v_exp_f32 v97, v97
    v_exp_f32 v98, v98
    v_exp_f32 v99, v99
    v_exp_f32 v100, v100
    v_exp_f32 v101, v101
    v_exp_f32 v102, v102
    v_exp_f32 v103, v103
    v_exp_f32 v104, v104
    v_exp_f32 v105, v105
    v_exp_f32 v106, v106
    v_exp_f32 v107, v107
    v_exp_f32 v108, v108
    v_exp_f32 v109, v109
    v_exp_f32 v110, v110
    v_exp_f32 v111, v111
    s_nop 1
    v_smfmac_f32_32x32x32_bf16 v[192:207], a[8:11], v[96:103], v231
    v_smfmac_f32_16x16x64_bf16 a[140:143], a[144:147], v[96:103], v231
    v_smfmac_f32_32x32x32_bf16 v[192:207], a[12:15], v[104:111], v231
    v_smfmac_f32_16x16x64_bf16 a[140:143], a[144:147], v[104:111], v231
    s_nop 15
    s_add_u32 s69, s69, 4096
    s_cmp_lt_u32 s69, s55
    s_cbranch_scc1 L_slow3_sum
    v_accvgpr_read_b32 v12, a140
    s_mov_b64 vcc, 0
    s_branch L_redo3
L_ob_spin:
    s_not_b64 exec, vcc
    buffer_load_dword v15, v14, s[32:35], s87 offen sc1
    s_mov_b64 exec, -1
    s_waitcnt vmcnt(0)
    v_cmp_ne_u32 vcc, 0, v15
    s_nop 1
    s_cmp_eq_u32 vcc_lo, 0xffff
    s_cbranch_scc1 L_ob_ok
    s_sub_u32 s97, s97, 1
    s_cbranch_scc0 L_ob_spin
    s_endpgm
L_exit:
    s_endpgm
.fill 64, 4, 0xbf810000
.section .rodata,"a"
.p2align 6
.amdhsa_kernel gated_mix__mha_block__spectral_fnet__prompt_kernel
  .amdhsa_next_free_vgpr 512
  .amdhsa_next_free_sgpr 102
  .amdhsa_accum_offset 256
  .amdhsa_group_segment_fixed_size 0
  .amdhsa_kernarg_size 96
  .amdhsa_user_sgpr_count 2
  .amdhsa_user_sgpr_kernarg_segment_ptr 1
  .amdhsa_system_sgpr_workgroup_id_x 1
  .amdhsa_float_denorm_mode_32 3
.end_amdhsa_kernel
```
